```python
import torch

def _softmax(x, axis=-1):
    return torch.softmax(x, dim=axis)
def _gelu(x):
    return torch.nn.functional.gelu(x, approximate="tanh")
def _silu(x):
    return torch.nn.functional.silu(x)
def _sigmoid(x):
    return torch.sigmoid(x)
def _layernorm(x, axis=-1, eps=1e-5):
    m = x.mean(dim=axis, keepdim=True)
    v = x.var(dim=axis, keepdim=True, unbiased=False)
    return (x - m) / torch.sqrt(v + eps)
def _scatter_add(tgt, idx, src, axis=0):
    return tgt.clone().index_add_(axis, idx, src)
def _segment_sum(src, seg, n):
    out = torch.zeros((n,) + src.shape[1:], dtype=src.dtype)
    return out.index_add_(0, seg, src)
def _pad(x, pw):
    flat = tuple(v for pair in reversed(pw) for v in pair)
    return torch.nn.functional.pad(x, flat)

kernel_name = 'interleave_layers__ssm_conv_h3__swiglu_ffn__prompt'

def setup_inputs():

    _w = (lambda a: (lambda t: t.to(torch.bfloat16) if t.is_floating_point() else t)(torch.as_tensor(a)))
    def _A_setup():
        B, S, D = 1, 2048, 512
        ks = 4
        return {
            "q": _w((lambda *s: torch.randn(*s, dtype=torch.bfloat16) * 0.05)(B, S, D)),
            "k": _w((lambda *s: torch.randn(*s, dtype=torch.bfloat16) * 0.8)(B, S, D)),
            "v": _w((lambda *s: torch.randn(*s, dtype=torch.bfloat16) * 0.8)(B, S, D)),
            "shift_k": _w((lambda *s: torch.randn(*s, dtype=torch.bfloat16) * 0.8)(D, ks) * 0.5),
            "ssm_k": _w((lambda *s: torch.randn(*s, dtype=torch.bfloat16) * 0.8)(D, S) * (1.0 / S ** 0.5)),
            "ssm_D": _w((lambda *s: torch.randn(*s, dtype=torch.bfloat16) * 0.8)(D)),
        }
    _A_in = _A_setup()

    def _B_setup():
        B, S, D, F = 1, 2048, 512, 1376
        return {
            "x": _w((lambda *s: torch.randn(*s, dtype=torch.bfloat16) * 0.05)(B, S, D)),
            "w_gate": _w((lambda *s: torch.randn(*s, dtype=torch.bfloat16) * 0.1)(D, F)),
            "w_up": _w((lambda *s: torch.randn(*s, dtype=torch.bfloat16) * 0.1)(D, F)),
            "w_down": _w((lambda *s: torch.randn(*s, dtype=torch.bfloat16) * 0.1)(F, D)),
        }
    _B_in = _B_setup()

    return {
        "A_q": _A_in["q"],
        "A_k": _A_in["k"],
        "A_v": _A_in["v"],
        "A_shift_k": _A_in["shift_k"],
        "A_ssm_k": _A_in["ssm_k"],
        "A_ssm_D": _A_in["ssm_D"],
        "B_x": _B_in["x"],
        "B_w_gate": _B_in["w_gate"],
        "B_w_up": _B_in["w_up"],
        "B_w_down": _B_in["w_down"],
    }

def reference(A_q, A_k, A_v, A_shift_k, A_ssm_k, A_ssm_D, B_x, B_w_gate, B_w_up, B_w_down):
    def _A_ref(q, k, v, shift_k, ssm_k, ssm_D):
        B, S, D = q.shape
        ks = shift_k.shape[-1]
        k_pad = _pad(k, ((0, 0), (ks - 1, 0), (0, 0)))
        k_shift = torch.zeros_like(k)
        for t in range(ks):
            k_shift = k_shift + k_pad[:, t:t + S, :] * shift_k[:, ks - 1 - t][None, None, :]
        kv = k_shift * v
        L = 2 * S
        kv_pad = _pad(kv, ((0, 0), (0, S), (0, 0)))
        kf_pad = _pad(ssm_k, ((0, 0), (0, S)))
        kv_f = (lambda x, axes=(-2,-1): torch.fft.rfft2(x.float(), dim=axes))(kv_pad[:, None, :, :], axes=(1, 2))
        kf_f = (lambda x, axes=(-2,-1): torch.fft.rfft2(x.float(), dim=axes))(kf_pad[:, None, :], axes=(1, 2))
        kf_f = (lambda x, *d: x.permute(*d))(kf_f, 1, 2, 0)
        y_f = kv_f * kf_f[None, :, :, :]
        y = (lambda x, s, axes=(-2,-1): torch.fft.irfft2(x, s=s, dim=axes).to(torch.bfloat16))(y_f, (1, L), axes=(1, 2))[:, 0, :S, :]
        y = y + kv * ssm_D[None, None, :]
        return q * y

    def _B_ref(x, w_gate, w_up, w_down):
        g = _silu(x @ w_gate)
        u = x @ w_up
        return (g * u) @ w_down

    x = A_q
    x = x + _A_ref(_layernorm(x, axis=-1), A_k, A_v, A_shift_k, A_ssm_k, A_ssm_D)
    x = x + _B_ref(_layernorm(x, axis=-1), B_w_gate, B_w_up, B_w_down)
    x = x + _A_ref(_layernorm(x, axis=-1), A_k, A_v, A_shift_k, A_ssm_k, A_ssm_D)
    x = x + _B_ref(_layernorm(x, axis=-1), B_w_gate, B_w_up, B_w_down)
    return x
```

```asm
; @launch kernel=prep_kernel grid=(1320,1,1) block=(256,1,1) lds=9216
; @launch kernel=conv_kernel grid=(256,1,1) block=(256,1,1) lds=98816
; @launch kernel=ln1_kernel grid=(128,1,1) block=(256,1,1) lds=16640
; @launch kernel=ffn1a_kernel grid=(240,1,1) block=(256,1,1) lds=131072
; @launch kernel=ffn2a_kernel grid=(256,1,1) block=(256,1,1) lds=65536
; @launch kernel=ln2_kernel grid=(128,1,1) block=(256,1,1) lds=16640
; @launch kernel=ffn1b_kernel grid=(240,1,1) block=(256,1,1) lds=131072
; @launch kernel=ffn2b_kernel grid=(256,1,1) block=(256,1,1) lds=65536
.amdgcn_target "amdgcn-amd-amdhsa--gfx950"
.text
.globl prep_kernel
.p2align 8
.type prep_kernel,@function
prep_kernel:
    s_load_dwordx2 s[4:5], s[0:1], 8
    s_load_dwordx2 s[6:7], s[0:1], 16
    s_load_dwordx2 s[8:9], s[0:1], 24
    s_load_dwordx2 s[10:11], s[0:1], 96
    s_load_dwordx2 s[12:13], s[0:1], 56
    s_load_dwordx2 s[14:15], s[0:1], 64
    s_load_dwordx2 s[16:17], s[0:1], 72
    s_waitcnt lgkmcnt(0)
    s_mov_b32 s20, s4
    s_mov_b32 s21, s5
    s_mov_b32 s22, 2097152
    s_mov_b32 s23, 0x00020000
    s_mov_b32 s24, s6
    s_mov_b32 s25, s7
    s_mov_b32 s26, 2097152
    s_mov_b32 s27, 0x00020000
    s_mov_b32 s28, s8
    s_mov_b32 s29, s9
    s_mov_b32 s30, 4096
    s_mov_b32 s31, 0x00020000
    s_mov_b32 s32, s10
    s_mov_b32 s33, s11
    s_mov_b32 s34, 25165824
    s_mov_b32 s35, 0x00020000
    s_mov_b32 s36, s12
    s_mov_b32 s37, s13
    s_mov_b32 s38, 1409024
    s_mov_b32 s39, 0x00020000
    s_mov_b32 s40, s14
    s_mov_b32 s41, s15
    s_mov_b32 s42, 1409024
    s_mov_b32 s43, 0x00020000
    s_mov_b32 s44, s16
    s_mov_b32 s45, s17
    s_mov_b32 s46, 1409024
    s_mov_b32 s47, 0x00020000
    s_cmp_ge_u32 s2, 256
    s_cbranch_scc1 L_prep_partB
    s_lshr_b32 s50, s2, 3
    s_and_b32 s51, s2, 7
    v_and_b32 v1, 7, v0
    v_lshrrev_b32 v2, 3, v0
    s_lshl_b32 s52, s51, 6
    v_lshlrev_b32 v3, 3, v1
    v_add_u32 v3, s52, v3
    v_lshlrev_b32 v4, 3, v3
    buffer_load_dwordx4 v[16:19], v4, s[28:31], 0 offen offset:0
    buffer_load_dwordx4 v[20:23], v4, s[28:31], 0 offen offset:16
    buffer_load_dwordx4 v[24:27], v4, s[28:31], 0 offen offset:32
    buffer_load_dwordx4 v[28:31], v4, s[28:31], 0 offen offset:48
    s_lshl_b32 s53, s50, 6
    v_add_u32 v5, s53, v2
    v_lshlrev_b32 v6, 10, v5
    v_lshl_add_u32 v6, v3, 1, v6
    v_subrev_u32 v7, 3072, v6
    v_mul_u32_u24 v8, 1152, v1
    v_lshl_add_u32 v8, v2, 1, v8
    buffer_load_dwordx4 v[32:35], v7, s[20:23], 0 offen offset:0
    buffer_load_dwordx4 v[36:39], v7, s[20:23], 0 offen offset:1024
    buffer_load_dwordx4 v[40:43], v7, s[20:23], 0 offen offset:2048
    buffer_load_dwordx4 v[44:47], v7, s[20:23], 0 offen offset:3072
    buffer_load_dwordx4 v[48:51], v6, s[24:27], 0 offen
    v_add_u32 v9, 0x8000, v7
    v_add_u32 v10, 0x8000, v6
    s_waitcnt vmcnt(0)
    v_lshlrev_b32 v64, 16, v32
    v_and_b32 v65, 0xffff0000, v32
    v_lshlrev_b32 v66, 16, v33
    v_and_b32 v67, 0xffff0000, v33
    v_lshlrev_b32 v68, 16, v34
    v_and_b32 v69, 0xffff0000, v34
    v_lshlrev_b32 v70, 16, v35
    v_and_b32 v71, 0xffff0000, v35
    v_lshlrev_b32 v72, 16, v36
    v_and_b32 v73, 0xffff0000, v36
    v_lshlrev_b32 v74, 16, v37
    v_and_b32 v75, 0xffff0000, v37
    v_lshlrev_b32 v76, 16, v38
    v_and_b32 v77, 0xffff0000, v38
    v_lshlrev_b32 v78, 16, v39
    v_and_b32 v79, 0xffff0000, v39
    v_lshlrev_b32 v80, 16, v40
    v_and_b32 v81, 0xffff0000, v40
    v_lshlrev_b32 v82, 16, v41
    v_and_b32 v83, 0xffff0000, v41
    v_lshlrev_b32 v84, 16, v42
    v_and_b32 v85, 0xffff0000, v42
    v_lshlrev_b32 v86, 16, v43
    v_and_b32 v87, 0xffff0000, v43
    v_lshlrev_b32 v88, 16, v44
    v_and_b32 v89, 0xffff0000, v44
    v_lshlrev_b32 v90, 16, v45
    v_and_b32 v91, 0xffff0000, v45
    v_lshlrev_b32 v92, 16, v46
    v_and_b32 v93, 0xffff0000, v46
    v_lshlrev_b32 v94, 16, v47
    v_and_b32 v95, 0xffff0000, v47
    v_lshlrev_b32 v96, 16, v48
    v_and_b32 v97, 0xffff0000, v48
    v_lshlrev_b32 v98, 16, v49
    v_and_b32 v99, 0xffff0000, v49
    v_lshlrev_b32 v100, 16, v50
    v_and_b32 v101, 0xffff0000, v50
    v_lshlrev_b32 v102, 16, v51
    v_and_b32 v103, 0xffff0000, v51
    v_lshlrev_b32 v110, 16, v16
    v_and_b32 v111, 0xffff0000, v16
    v_lshlrev_b32 v112, 16, v17
    v_and_b32 v113, 0xffff0000, v17
    v_mul_f32 v114, v64, v113
    v_mul_f32 v115, v72, v112
    v_cvt_pk_bf16_f32 v116, v114, v115
    v_lshlrev_b32 v114, 16, v116
    v_and_b32 v115, 0xffff0000, v116
    v_add_f32 v114, v114, v115
    v_mul_f32 v115, v80, v111
    v_cvt_pk_bf16_f32 v116, v114, v115
    v_lshlrev_b32 v114, 16, v116
    v_and_b32 v115, 0xffff0000, v116
    v_add_f32 v114, v114, v115
    v_mul_f32 v115, v88, v110
    v_cvt_pk_bf16_f32 v116, v114, v115
    v_lshlrev_b32 v114, 16, v116
    v_and_b32 v115, 0xffff0000, v116
    v_add_f32 v114, v114, v115
    v_cvt_pk_bf16_f32 v116, v114, v115
    v_lshlrev_b32 v114, 16, v116
    v_and_b32 v115, 0xffff0000, v116
    v_mul_f32 v114, v114, v96
    v_cvt_pk_bf16_f32 v116, v114, v114
    ds_write_b16 v8, v116 offset:0
    v_lshlrev_b32 v110, 16, v18
    v_and_b32 v111, 0xffff0000, v18
    v_lshlrev_b32 v112, 16, v19
    v_and_b32 v113, 0xffff0000, v19
    v_mul_f32 v114, v65, v113
    v_mul_f32 v115, v73, v112
    v_cvt_pk_bf16_f32 v116, v114, v115
    v_lshlrev_b32 v114, 16, v116
    v_and_b32 v115, 0xffff0000, v116
    v_add_f32 v114, v114, v115
    v_mul_f32 v115, v81, v111
    v_cvt_pk_bf16_f32 v116, v114, v115
    v_lshlrev_b32 v114, 16, v116
    v_and_b32 v115, 0xffff0000, v116
    v_add_f32 v114, v114, v115
    v_mul_f32 v115, v89, v110
    v_cvt_pk_bf16_f32 v116, v114, v115
    v_lshlrev_b32 v114, 16, v116
    v_and_b32 v115, 0xffff0000, v116
    v_add_f32 v114, v114, v115
    v_cvt_pk_bf16_f32 v116, v114, v115
    v_lshlrev_b32 v114, 16, v116
    v_and_b32 v115, 0xffff0000, v116
    v_mul_f32 v114, v114, v97
    v_cvt_pk_bf16_f32 v116, v114, v114
    ds_write_b16 v8, v116 offset:144
    v_lshlrev_b32 v110, 16, v20
    v_and_b32 v111, 0xffff0000, v20
    v_lshlrev_b32 v112, 16, v21
    v_and_b32 v113, 0xffff0000, v21
    v_mul_f32 v114, v66, v113
    v_mul_f32 v115, v74, v112
    v_cvt_pk_bf16_f32 v116, v114, v115
    v_lshlrev_b32 v114, 16, v116
    v_and_b32 v115, 0xffff0000, v116
    v_add_f32 v114, v114, v115
    v_mul_f32 v115, v82, v111
    v_cvt_pk_bf16_f32 v116, v114, v115
    v_lshlrev_b32 v114, 16, v116
    v_and_b32 v115, 0xffff0000, v116
    v_add_f32 v114, v114, v115
    v_mul_f32 v115, v90, v110
    v_cvt_pk_bf16_f32 v116, v114, v115
    v_lshlrev_b32 v114, 16, v116
    v_and_b32 v115, 0xffff0000, v116
    v_add_f32 v114, v114, v115
    v_cvt_pk_bf16_f32 v116, v114, v115
    v_lshlrev_b32 v114, 16, v116
    v_and_b32 v115, 0xffff0000, v116
    v_mul_f32 v114, v114, v98
    v_cvt_pk_bf16_f32 v116, v114, v114
    ds_write_b16 v8, v116 offset:288
    v_lshlrev_b32 v110, 16, v22
    v_and_b32 v111, 0xffff0000, v22
    v_lshlrev_b32 v112, 16, v23
    v_and_b32 v113, 0xffff0000, v23
    v_mul_f32 v114, v67, v113
    v_mul_f32 v115, v75, v112
    v_cvt_pk_bf16_f32 v116, v114, v115
    v_lshlrev_b32 v114, 16, v116
    v_and_b32 v115, 0xffff0000, v116
    v_add_f32 v114, v114, v115
    v_mul_f32 v115, v83, v111
    v_cvt_pk_bf16_f32 v116, v114, v115
    v_lshlrev_b32 v114, 16, v116
    v_and_b32 v115, 0xffff0000, v116
    v_add_f32 v114, v114, v115
    v_mul_f32 v115, v91, v110
    v_cvt_pk_bf16_f32 v116, v114, v115
    v_lshlrev_b32 v114, 16, v116
    v_and_b32 v115, 0xffff0000, v116
    v_add_f32 v114, v114, v115
    v_cvt_pk_bf16_f32 v116, v114, v115
    v_lshlrev_b32 v114, 16, v116
    v_and_b32 v115, 0xffff0000, v116
    v_mul_f32 v114, v114, v99
    v_cvt_pk_bf16_f32 v116, v114, v114
    ds_write_b16 v8, v116 offset:432
    v_lshlrev_b32 v110, 16, v24
    v_and_b32 v111, 0xffff0000, v24
    v_lshlrev_b32 v112, 16, v25
    v_and_b32 v113, 0xffff0000, v25
    v_mul_f32 v114, v68, v113
    v_mul_f32 v115, v76, v112
    v_cvt_pk_bf16_f32 v116, v114, v115
    v_lshlrev_b32 v114, 16, v116
    v_and_b32 v115, 0xffff0000, v116
    v_add_f32 v114, v114, v115
    v_mul_f32 v115, v84, v111
    v_cvt_pk_bf16_f32 v116, v114, v115
    v_lshlrev_b32 v114, 16, v116
    v_and_b32 v115, 0xffff0000, v116
    v_add_f32 v114, v114, v115
    v_mul_f32 v115, v92, v110
    v_cvt_pk_bf16_f32 v116, v114, v115
    v_lshlrev_b32 v114, 16, v116
    v_and_b32 v115, 0xffff0000, v116
    v_add_f32 v114, v114, v115
    v_cvt_pk_bf16_f32 v116, v114, v115
    v_lshlrev_b32 v114, 16, v116
    v_and_b32 v115, 0xffff0000, v116
    v_mul_f32 v114, v114, v100
    v_cvt_pk_bf16_f32 v116, v114, v114
    ds_write_b16 v8, v116 offset:576
    v_lshlrev_b32 v110, 16, v26
    v_and_b32 v111, 0xffff0000, v26
    v_lshlrev_b32 v112, 16, v27
    v_and_b32 v113, 0xffff0000, v27
    v_mul_f32 v114, v69, v113
    v_mul_f32 v115, v77, v112
    v_cvt_pk_bf16_f32 v116, v114, v115
    v_lshlrev_b32 v114, 16, v116
    v_and_b32 v115, 0xffff0000, v116
    v_add_f32 v114, v114, v115
    v_mul_f32 v115, v85, v111
    v_cvt_pk_bf16_f32 v116, v114, v115
    v_lshlrev_b32 v114, 16, v116
    v_and_b32 v115, 0xffff0000, v116
    v_add_f32 v114, v114, v115
    v_mul_f32 v115, v93, v110
    v_cvt_pk_bf16_f32 v116, v114, v115
    v_lshlrev_b32 v114, 16, v116
    v_and_b32 v115, 0xffff0000, v116
    v_add_f32 v114, v114, v115
    v_cvt_pk_bf16_f32 v116, v114, v115
    v_lshlrev_b32 v114, 16, v116
    v_and_b32 v115, 0xffff0000, v116
    v_mul_f32 v114, v114, v101
    v_cvt_pk_bf16_f32 v116, v114, v114
    ds_write_b16 v8, v116 offset:720
    v_lshlrev_b32 v110, 16, v28
    v_and_b32 v111, 0xffff0000, v28
    v_lshlrev_b32 v112, 16, v29
    v_and_b32 v113, 0xffff0000, v29
    v_mul_f32 v114, v70, v113
    v_mul_f32 v115, v78, v112
    v_cvt_pk_bf16_f32 v116, v114, v115
    v_lshlrev_b32 v114, 16, v116
    v_and_b32 v115, 0xffff0000, v116
    v_add_f32 v114, v114, v115
    v_mul_f32 v115, v86, v111
    v_cvt_pk_bf16_f32 v116, v114, v115
    v_lshlrev_b32 v114, 16, v116
    v_and_b32 v115, 0xffff0000, v116
    v_add_f32 v114, v114, v115
    v_mul_f32 v115, v94, v110
    v_cvt_pk_bf16_f32 v116, v114, v115
    v_lshlrev_b32 v114, 16, v116
    v_and_b32 v115, 0xffff0000, v116
    v_add_f32 v114, v114, v115
    v_cvt_pk_bf16_f32 v116, v114, v115
    v_lshlrev_b32 v114, 16, v116
    v_and_b32 v115, 0xffff0000, v116
    v_mul_f32 v114, v114, v102
    v_cvt_pk_bf16_f32 v116, v114, v114
    ds_write_b16 v8, v116 offset:864
    v_lshlrev_b32 v110, 16, v30
    v_and_b32 v111, 0xffff0000, v30
    v_lshlrev_b32 v112, 16, v31
    v_and_b32 v113, 0xffff0000, v31
    v_mul_f32 v114, v71, v113
    v_mul_f32 v115, v79, v112
    v_cvt_pk_bf16_f32 v116, v114, v115
    v_lshlrev_b32 v114, 16, v116
    v_and_b32 v115, 0xffff0000, v116
    v_add_f32 v114, v114, v115
    v_mul_f32 v115, v87, v111
    v_cvt_pk_bf16_f32 v116, v114, v115
    v_lshlrev_b32 v114, 16, v116
    v_and_b32 v115, 0xffff0000, v116
    v_add_f32 v114, v114, v115
    v_mul_f32 v115, v95, v110
    v_cvt_pk_bf16_f32 v116, v114, v115
    v_lshlrev_b32 v114, 16, v116
    v_and_b32 v115, 0xffff0000, v116
    v_add_f32 v114, v114, v115
    v_cvt_pk_bf16_f32 v116, v114, v115
    v_lshlrev_b32 v114, 16, v116
    v_and_b32 v115, 0xffff0000, v116
    v_mul_f32 v114, v114, v103
    v_cvt_pk_bf16_f32 v116, v114, v114
    ds_write_b16 v8, v116 offset:1008
    buffer_load_dwordx4 v[32:35], v9, s[20:23], 0 offen offset:0
    buffer_load_dwordx4 v[36:39], v9, s[20:23], 0 offen offset:1024
    buffer_load_dwordx4 v[40:43], v9, s[20:23], 0 offen offset:2048
    buffer_load_dwordx4 v[44:47], v9, s[20:23], 0 offen offset:3072
    buffer_load_dwordx4 v[48:51], v10, s[24:27], 0 offen
    s_waitcnt vmcnt(0)
    v_lshlrev_b32 v64, 16, v32
    v_and_b32 v65, 0xffff0000, v32
    v_lshlrev_b32 v66, 16, v33
    v_and_b32 v67, 0xffff0000, v33
    v_lshlrev_b32 v68, 16, v34
    v_and_b32 v69, 0xffff0000, v34
    v_lshlrev_b32 v70, 16, v35
    v_and_b32 v71, 0xffff0000, v35
    v_lshlrev_b32 v72, 16, v36
    v_and_b32 v73, 0xffff0000, v36
    v_lshlrev_b32 v74, 16, v37
    v_and_b32 v75, 0xffff0000, v37
    v_lshlrev_b32 v76, 16, v38
    v_and_b32 v77, 0xffff0000, v38
    v_lshlrev_b32 v78, 16, v39
    v_and_b32 v79, 0xffff0000, v39
    v_lshlrev_b32 v80, 16, v40
    v_and_b32 v81, 0xffff0000, v40
    v_lshlrev_b32 v82, 16, v41
    v_and_b32 v83, 0xffff0000, v41
    v_lshlrev_b32 v84, 16, v42
    v_and_b32 v85, 0xffff0000, v42
    v_lshlrev_b32 v86, 16, v43
    v_and_b32 v87, 0xffff0000, v43
    v_lshlrev_b32 v88, 16, v44
    v_and_b32 v89, 0xffff0000, v44
    v_lshlrev_b32 v90, 16, v45
    v_and_b32 v91, 0xffff0000, v45
    v_lshlrev_b32 v92, 16, v46
    v_and_b32 v93, 0xffff0000, v46
    v_lshlrev_b32 v94, 16, v47
    v_and_b32 v95, 0xffff0000, v47
    v_lshlrev_b32 v96, 16, v48
    v_and_b32 v97, 0xffff0000, v48
    v_lshlrev_b32 v98, 16, v49
    v_and_b32 v99, 0xffff0000, v49
    v_lshlrev_b32 v100, 16, v50
    v_and_b32 v101, 0xffff0000, v50
    v_lshlrev_b32 v102, 16, v51
    v_and_b32 v103, 0xffff0000, v51
    v_lshlrev_b32 v110, 16, v16
    v_and_b32 v111, 0xffff0000, v16
    v_lshlrev_b32 v112, 16, v17
    v_and_b32 v113, 0xffff0000, v17
    v_mul_f32 v114, v64, v113
    v_mul_f32 v115, v72, v112
    v_cvt_pk_bf16_f32 v116, v114, v115
    v_lshlrev_b32 v114, 16, v116
    v_and_b32 v115, 0xffff0000, v116
    v_add_f32 v114, v114, v115
    v_mul_f32 v115, v80, v111
    v_cvt_pk_bf16_f32 v116, v114, v115
    v_lshlrev_b32 v114, 16, v116
    v_and_b32 v115, 0xffff0000, v116
    v_add_f32 v114, v114, v115
    v_mul_f32 v115, v88, v110
    v_cvt_pk_bf16_f32 v116, v114, v115
    v_lshlrev_b32 v114, 16, v116
    v_and_b32 v115, 0xffff0000, v116
    v_add_f32 v114, v114, v115
    v_cvt_pk_bf16_f32 v116, v114, v115
    v_lshlrev_b32 v114, 16, v116
    v_and_b32 v115, 0xffff0000, v116
    v_mul_f32 v114, v114, v96
    v_cvt_pk_bf16_f32 v116, v114, v114
    ds_write_b16 v8, v116 offset:64
    v_lshlrev_b32 v110, 16, v18
    v_and_b32 v111, 0xffff0000, v18
    v_lshlrev_b32 v112, 16, v19
    v_and_b32 v113, 0xffff0000, v19
    v_mul_f32 v114, v65, v113
    v_mul_f32 v115, v73, v112
    v_cvt_pk_bf16_f32 v116, v114, v115
    v_lshlrev_b32 v114, 16, v116
    v_and_b32 v115, 0xffff0000, v116
    v_add_f32 v114, v114, v115
    v_mul_f32 v115, v81, v111
    v_cvt_pk_bf16_f32 v116, v114, v115
    v_lshlrev_b32 v114, 16, v116
    v_and_b32 v115, 0xffff0000, v116
    v_add_f32 v114, v114, v115
    v_mul_f32 v115, v89, v110
    v_cvt_pk_bf16_f32 v116, v114, v115
    v_lshlrev_b32 v114, 16, v116
    v_and_b32 v115, 0xffff0000, v116
    v_add_f32 v114, v114, v115
    v_cvt_pk_bf16_f32 v116, v114, v115
    v_lshlrev_b32 v114, 16, v116
    v_and_b32 v115, 0xffff0000, v116
    v_mul_f32 v114, v114, v97
    v_cvt_pk_bf16_f32 v116, v114, v114
    ds_write_b16 v8, v116 offset:208
    v_lshlrev_b32 v110, 16, v20
    v_and_b32 v111, 0xffff0000, v20
    v_lshlrev_b32 v112, 16, v21
    v_and_b32 v113, 0xffff0000, v21
    v_mul_f32 v114, v66, v113
    v_mul_f32 v115, v74, v112
    v_cvt_pk_bf16_f32 v116, v114, v115
    v_lshlrev_b32 v114, 16, v116
    v_and_b32 v115, 0xffff0000, v116
    v_add_f32 v114, v114, v115
    v_mul_f32 v115, v82, v111
    v_cvt_pk_bf16_f32 v116, v114, v115
    v_lshlrev_b32 v114, 16, v116
    v_and_b32 v115, 0xffff0000, v116
    v_add_f32 v114, v114, v115
    v_mul_f32 v115, v90, v110
    v_cvt_pk_bf16_f32 v116, v114, v115
    v_lshlrev_b32 v114, 16, v116
    v_and_b32 v115, 0xffff0000, v116
    v_add_f32 v114, v114, v115
    v_cvt_pk_bf16_f32 v116, v114, v115
    v_lshlrev_b32 v114, 16, v116
    v_and_b32 v115, 0xffff0000, v116
    v_mul_f32 v114, v114, v98
    v_cvt_pk_bf16_f32 v116, v114, v114
    ds_write_b16 v8, v116 offset:352
    v_lshlrev_b32 v110, 16, v22
    v_and_b32 v111, 0xffff0000, v22
    v_lshlrev_b32 v112, 16, v23
    v_and_b32 v113, 0xffff0000, v23
    v_mul_f32 v114, v67, v113
    v_mul_f32 v115, v75, v112
    v_cvt_pk_bf16_f32 v116, v114, v115
    v_lshlrev_b32 v114, 16, v116
    v_and_b32 v115, 0xffff0000, v116
    v_add_f32 v114, v114, v115
    v_mul_f32 v115, v83, v111
    v_cvt_pk_bf16_f32 v116, v114, v115
    v_lshlrev_b32 v114, 16, v116
    v_and_b32 v115, 0xffff0000, v116
    v_add_f32 v114, v114, v115
    v_mul_f32 v115, v91, v110
    v_cvt_pk_bf16_f32 v116, v114, v115
    v_lshlrev_b32 v114, 16, v116
    v_and_b32 v115, 0xffff0000, v116
    v_add_f32 v114, v114, v115
    v_cvt_pk_bf16_f32 v116, v114, v115
    v_lshlrev_b32 v114, 16, v116
    v_and_b32 v115, 0xffff0000, v116
    v_mul_f32 v114, v114, v99
    v_cvt_pk_bf16_f32 v116, v114, v114
    ds_write_b16 v8, v116 offset:496
    v_lshlrev_b32 v110, 16, v24
    v_and_b32 v111, 0xffff0000, v24
    v_lshlrev_b32 v112, 16, v25
    v_and_b32 v113, 0xffff0000, v25
    v_mul_f32 v114, v68, v113
    v_mul_f32 v115, v76, v112
    v_cvt_pk_bf16_f32 v116, v114, v115
    v_lshlrev_b32 v114, 16, v116
    v_and_b32 v115, 0xffff0000, v116
    v_add_f32 v114, v114, v115
    v_mul_f32 v115, v84, v111
    v_cvt_pk_bf16_f32 v116, v114, v115
    v_lshlrev_b32 v114, 16, v116
    v_and_b32 v115, 0xffff0000, v116
    v_add_f32 v114, v114, v115
    v_mul_f32 v115, v92, v110
    v_cvt_pk_bf16_f32 v116, v114, v115
    v_lshlrev_b32 v114, 16, v116
    v_and_b32 v115, 0xffff0000, v116
    v_add_f32 v114, v114, v115
    v_cvt_pk_bf16_f32 v116, v114, v115
    v_lshlrev_b32 v114, 16, v116
    v_and_b32 v115, 0xffff0000, v116
    v_mul_f32 v114, v114, v100
    v_cvt_pk_bf16_f32 v116, v114, v114
    ds_write_b16 v8, v116 offset:640
    v_lshlrev_b32 v110, 16, v26
    v_and_b32 v111, 0xffff0000, v26
    v_lshlrev_b32 v112, 16, v27
    v_and_b32 v113, 0xffff0000, v27
    v_mul_f32 v114, v69, v113
    v_mul_f32 v115, v77, v112
    v_cvt_pk_bf16_f32 v116, v114, v115
    v_lshlrev_b32 v114, 16, v116
    v_and_b32 v115, 0xffff0000, v116
    v_add_f32 v114, v114, v115
    v_mul_f32 v115, v85, v111
    v_cvt_pk_bf16_f32 v116, v114, v115
    v_lshlrev_b32 v114, 16, v116
    v_and_b32 v115, 0xffff0000, v116
    v_add_f32 v114, v114, v115
    v_mul_f32 v115, v93, v110
    v_cvt_pk_bf16_f32 v116, v114, v115
    v_lshlrev_b32 v114, 16, v116
    v_and_b32 v115, 0xffff0000, v116
    v_add_f32 v114, v114, v115
    v_cvt_pk_bf16_f32 v116, v114, v115
    v_lshlrev_b32 v114, 16, v116
    v_and_b32 v115, 0xffff0000, v116
    v_mul_f32 v114, v114, v101
    v_cvt_pk_bf16_f32 v116, v114, v114
    ds_write_b16 v8, v116 offset:784
    v_lshlrev_b32 v110, 16, v28
    v_and_b32 v111, 0xffff0000, v28
    v_lshlrev_b32 v112, 16, v29
    v_and_b32 v113, 0xffff0000, v29
    v_mul_f32 v114, v70, v113
    v_mul_f32 v115, v78, v112
    v_cvt_pk_bf16_f32 v116, v114, v115
    v_lshlrev_b32 v114, 16, v116
    v_and_b32 v115, 0xffff0000, v116
    v_add_f32 v114, v114, v115
    v_mul_f32 v115, v86, v111
    v_cvt_pk_bf16_f32 v116, v114, v115
    v_lshlrev_b32 v114, 16, v116
    v_and_b32 v115, 0xffff0000, v116
    v_add_f32 v114, v114, v115
    v_mul_f32 v115, v94, v110
    v_cvt_pk_bf16_f32 v116, v114, v115
    v_lshlrev_b32 v114, 16, v116
    v_and_b32 v115, 0xffff0000, v116
    v_add_f32 v114, v114, v115
    v_cvt_pk_bf16_f32 v116, v114, v115
    v_lshlrev_b32 v114, 16, v116
    v_and_b32 v115, 0xffff0000, v116
    v_mul_f32 v114, v114, v102
    v_cvt_pk_bf16_f32 v116, v114, v114
    ds_write_b16 v8, v116 offset:928
    v_lshlrev_b32 v110, 16, v30
    v_and_b32 v111, 0xffff0000, v30
    v_lshlrev_b32 v112, 16, v31
    v_and_b32 v113, 0xffff0000, v31
    v_mul_f32 v114, v71, v113
    v_mul_f32 v115, v79, v112
    v_cvt_pk_bf16_f32 v116, v114, v115
    v_lshlrev_b32 v114, 16, v116
    v_and_b32 v115, 0xffff0000, v116
    v_add_f32 v114, v114, v115
    v_mul_f32 v115, v87, v111
    v_cvt_pk_bf16_f32 v116, v114, v115
    v_lshlrev_b32 v114, 16, v116
    v_and_b32 v115, 0xffff0000, v116
    v_add_f32 v114, v114, v115
    v_mul_f32 v115, v95, v110
    v_cvt_pk_bf16_f32 v116, v114, v115
    v_lshlrev_b32 v114, 16, v116
    v_and_b32 v115, 0xffff0000, v116
    v_add_f32 v114, v114, v115
    v_cvt_pk_bf16_f32 v116, v114, v115
    v_lshlrev_b32 v114, 16, v116
    v_and_b32 v115, 0xffff0000, v116
    v_mul_f32 v114, v114, v103
    v_cvt_pk_bf16_f32 v116, v114, v114
    ds_write_b16 v8, v116 offset:1072
    s_waitcnt lgkmcnt(0)
    s_barrier
    v_add_u32 v5, 0, v0
    v_lshrrev_b32 v6, 3, v5
    v_and_b32 v7, 7, v5
    v_mul_u32_u24 v8, 144, v6
    v_lshl_add_u32 v8, v7, 4, v8
    ds_read_b128 v[16:19], v8
    v_add_u32 v6, s52, v6
    v_lshlrev_b32 v6, 12, v6
    v_lshl_add_u32 v6, v7, 4, v6
    s_lshl_b32 s54, s53, 1
    v_add_u32 v6, s54, v6
    s_waitcnt lgkmcnt(0)
    buffer_store_dwordx4 v[16:19], v6, s[32:35], 0 offen offset:0
    s_waitcnt vmcnt(0)
    v_add_u32 v5, 256, v0
    v_lshrrev_b32 v6, 3, v5
    v_and_b32 v7, 7, v5
    v_mul_u32_u24 v8, 144, v6
    v_lshl_add_u32 v8, v7, 4, v8
    ds_read_b128 v[16:19], v8
    v_add_u32 v6, s52, v6
    v_lshlrev_b32 v6, 12, v6
    v_lshl_add_u32 v6, v7, 4, v6
    s_lshl_b32 s54, s53, 1
    v_add_u32 v6, s54, v6
    s_waitcnt lgkmcnt(0)
    buffer_store_dwordx4 v[16:19], v6, s[32:35], 0 offen offset:0
    s_waitcnt vmcnt(0)
    s_endpgm
L_prep_partB:
    s_sub_u32 s50, s2, 256
    s_lshl_b32 s50, s50, 2
    v_lshrrev_b32 v1, 6, v0
    s_nop 0
    v_readfirstlane_b32 s51, v1
    s_nop 3
    s_add_u32 s50, s50, s51
    v_and_b32 v1, 63, v0
    s_cmp_ge_u32 s50, 2880
    s_cbranch_scc1 L_prep_partB2
    s_mov_b32 s52, 0x55555556
    s_mul_hi_u32 s53, s50, s52
    s_mul_i32 s54, s53, 3
    s_sub_u32 s54, s50, s54
    s_and_b32 s55, s53, 15
    s_lshr_b32 s56, s53, 4
    s_mul_i32 s57, s56, 24
    v_and_b32 v2, 15, v1
    v_lshrrev_b32 v3, 4, v1
    v_add_u32 v4, s57, v2
    v_mov_b32 v5, 0
    s_cmp_eq_u32 s54, 1
    s_cbranch_scc0 L_prep_f_not1
    v_mov_b32 v5, 1
L_prep_f_not1:
    s_cmp_eq_u32 s54, 2
    s_cbranch_scc0 L_prep_f_not2
    v_and_b32 v6, 7, v2
    v_add_u32 v4, s57, v6
    v_add_u32 v4, 16, v4
    v_lshrrev_b32 v5, 3, v2
L_prep_f_not2:
    s_lshl_b32 s58, s55, 5
    v_lshl_add_u32 v6, v3, 3, s58
    s_movk_i32 s59, 2752
    v_mul_lo_u32 v6, v6, s59
    v_lshl_add_u32 v6, v4, 1, v6
    v_bfrev_b32 v7, 1
    v_cmp_gt_u32 vcc, 1376, v4
    s_nop 1
    v_cndmask_b32 v6, v7, v6, vcc
    v_mov_b32 v16, 0
    v_mov_b32 v17, 0
    v_mov_b32 v18, 0
    v_mov_b32 v19, 0
    v_cmp_eq_u32 vcc, 0, v5
    s_and_saveexec_b64 s[60:61], vcc
    s_cbranch_execz L_skip_1
    v_add_u32 v8, 0, v6
    buffer_load_ushort v24, v8, s[36:39], 0 offen
    v_add_u32 v8, 2752, v6
    buffer_load_ushort v25, v8, s[36:39], 0 offen
    v_add_u32 v8, 5504, v6
    buffer_load_ushort v26, v8, s[36:39], 0 offen
    v_add_u32 v8, 8256, v6
    buffer_load_ushort v27, v8, s[36:39], 0 offen
    v_add_u32 v8, 11008, v6
    buffer_load_ushort v28, v8, s[36:39], 0 offen
    v_add_u32 v8, 13760, v6
    buffer_load_ushort v29, v8, s[36:39], 0 offen
    v_add_u32 v8, 16512, v6
    buffer_load_ushort v30, v8, s[36:39], 0 offen
    v_add_u32 v8, 19264, v6
    buffer_load_ushort v31, v8, s[36:39], 0 offen
    s_waitcnt vmcnt(0)
    v_lshl_or_b32 v16, v25, 16, v24
    v_lshl_or_b32 v17, v27, 16, v26
    v_lshl_or_b32 v18, v29, 16, v28
    v_lshl_or_b32 v19, v31, 16, v30
L_skip_1:
    s_mov_b64 exec, s[60:61]
    v_cmp_eq_u32 vcc, 1, v5
    s_and_saveexec_b64 s[60:61], vcc
    s_cbranch_execz L_skip_2
    v_add_u32 v8, 0, v6
    buffer_load_ushort v24, v8, s[40:43], 0 offen
    v_add_u32 v8, 2752, v6
    buffer_load_ushort v25, v8, s[40:43], 0 offen
    v_add_u32 v8, 5504, v6
    buffer_load_ushort v26, v8, s[40:43], 0 offen
    v_add_u32 v8, 8256, v6
    buffer_load_ushort v27, v8, s[40:43], 0 offen
    v_add_u32 v8, 11008, v6
    buffer_load_ushort v28, v8, s[40:43], 0 offen
    v_add_u32 v8, 13760, v6
    buffer_load_ushort v29, v8, s[40:43], 0 offen
    v_add_u32 v8, 16512, v6
    buffer_load_ushort v30, v8, s[40:43], 0 offen
    v_add_u32 v8, 19264, v6
    buffer_load_ushort v31, v8, s[40:43], 0 offen
    s_waitcnt vmcnt(0)
    v_lshl_or_b32 v16, v25, 16, v24
    v_lshl_or_b32 v17, v27, 16, v26
    v_lshl_or_b32 v18, v29, 16, v28
    v_lshl_or_b32 v19, v31, 16, v30
L_skip_2:
    s_mov_b64 exec, s[60:61]
    s_lshl_b32 s58, s50, 10
    v_lshl_add_u32 v6, v1, 4, s58
    v_add_u32 v6, 16777216, v6
    buffer_store_dwordx4 v[16:19], v6, s[32:35], 0 offen
    s_waitcnt vmcnt(0)
    s_endpgm
L_prep_partB2:
    s_sub_u32 s50, s50, 2880
    s_cmp_ge_u32 s50, 1376
    s_cbranch_scc1 L_prep_done
    s_mov_b32 s52, 0x2FA0BEA
    s_mul_hi_u32 s53, s50, s52
    s_mul_i32 s54, s53, 86
    s_sub_u32 s54, s50, s54
    v_and_b32 v2, 31, v1
    v_lshrrev_b32 v3, 5, v1
    s_lshl_b32 s55, s54, 4
    v_lshl_add_u32 v6, v3, 3, s55
    v_lshlrev_b32 v6, 10, v6
    s_lshl_b32 s56, s53, 5
    v_add_u32 v2, s56, v2
    v_lshl_add_u32 v6, v2, 1, v6
    v_mov_b32 v16, 0
    v_mov_b32 v17, 0
    v_mov_b32 v18, 0
    v_mov_b32 v19, 0
    buffer_load_ushort v24, v6, s[44:47], 0 offen offset:0
    buffer_load_ushort v25, v6, s[44:47], 0 offen offset:1024
    buffer_load_ushort v26, v6, s[44:47], 0 offen offset:2048
    buffer_load_ushort v27, v6, s[44:47], 0 offen offset:3072
    v_add_u32 v7, 4096, v6
    buffer_load_ushort v28, v7, s[44:47], 0 offen offset:0
    buffer_load_ushort v29, v7, s[44:47], 0 offen offset:1024
    buffer_load_ushort v30, v7, s[44:47], 0 offen offset:2048
    buffer_load_ushort v31, v7, s[44:47], 0 offen offset:3072
    s_lshl_b32 s58, s50, 10
    v_lshl_add_u32 v6, v1, 4, s58
    v_add_u32 v6, 20971520, v6
    s_waitcnt vmcnt(0)
    v_lshl_or_b32 v16, v25, 16, v24
    v_lshl_or_b32 v17, v27, 16, v26
    v_lshl_or_b32 v18, v29, 16, v28
    v_lshl_or_b32 v19, v31, 16, v30
    buffer_store_dwordx4 v[16:19], v6, s[32:35], 0 offen
    s_waitcnt vmcnt(0)
L_prep_done:
    s_endpgm
.globl conv_kernel
.p2align 8
.type conv_kernel,@function
conv_kernel:
    s_cmp_ge_u32 s2, 256
    s_cbranch_scc1 L_conv_done
    s_load_dwordx2 s[4:5], s[0:1], 32
    s_load_dwordx2 s[6:7], s[0:1], 40
    s_load_dwordx2 s[8:9], s[0:1], 96
    s_waitcnt lgkmcnt(0)
    s_lshl_b32 s3, s2, 13
    s_add_u32 s4, s4, s3
    s_addc_u32 s5, s5, 0
    s_mov_b32 s12, s4
    s_mov_b32 s13, s5
    s_mov_b32 s14, 8192
    s_mov_b32 s15, 0x00020000
    s_mov_b32 s16, s6
    s_mov_b32 s17, s7
    s_mov_b32 s18, 1024
    s_mov_b32 s19, 0x00020000
    s_mov_b32 s20, s8
    s_mov_b32 s21, s9
    s_mov_b32 s22, 25165824
    s_mov_b32 s23, 0x00020000
    v_lshlrev_b32 v1, 4, v0
    v_add_u32 v2, s3, v1
    buffer_load_dwordx4 v[4:7], v2, s[20:23], 0 offen
    v_add_u32 v2, 4096, v2
    buffer_load_dwordx4 v[8:11], v2, s[20:23], 0 offen
    v_mov_b32 v12, 0
    v_mov_b32 v13, 0
    v_mov_b32 v14, 0
    v_mov_b32 v15, 0
    v_lshrrev_b32 v3, 7, v0
    v_and_b32 v16, 127, v0
    v_mul_u32_u24 v3, 7680, v3
    v_lshl_add_u32 v3, v16, 4, v3
    v_add_u32 v3, 67072, v3
    ds_write_b128 v3, v[12:15]
    ds_write_b128 v3, v[12:15] offset:512
    s_waitcnt vmcnt(0)
    v_lshrrev_b32 v16, 2, v0
    v_and_b32 v1, 3, v0
    v_mul_u32_u24 v16, 80, v16
    v_lshl_add_u32 v1, v1, 4, v16
    v_add_u32 v1, 69632, v1
    ds_write_b128 v1, v[4:7]
    ds_write_b128 v1, v[8:11] offset:7680
    s_mov_b32 s30, 0x03020504
    s_mov_b32 s23, s23
    s_mov_b32 s31, 0x01000302
    v_add_u32 v1, 0, v0
    v_cmp_le_u32 vcc, 260, v1
    s_nop 1
    v_cndmask_b32 v2, 0, 1, vcc
    v_mul_u32_u24 v3, 260, v2
    v_sub_u32 v3, v1, v3
    v_lshlrev_b32 v16, 3, v3
    v_sub_u32 v17, 2040, v16
    v_sub_u32 v18, 2048, v16
    v_mov_b32 v20, -1
    v_lshlrev_b32 v19, 1, v17
    v_lshl_add_u32 v19, v2, 12, v19
    v_cmp_gt_u32 vcc, 2048, v17
    s_nop 1
    v_cndmask_b32 v19, v20, v19, vcc
    buffer_load_dwordx4 v[4:7], v19, s[12:15], 0 offen
    v_lshlrev_b32 v19, 1, v18
    v_lshl_add_u32 v19, v2, 12, v19
    v_cmp_gt_u32 vcc, 2048, v18
    s_nop 1
    v_cndmask_b32 v19, v20, v19, vcc
    buffer_load_dwordx4 v[8:11], v19, s[12:15], 0 offen
    v_mul_u32_u24 v21, 33536, v2
    v_lshl_add_u32 v21, v3, 4, v21
    s_waitcnt vmcnt(0)
    v_perm_b32 v24, v8, v7, s30
    v_perm_b32 v25, v7, v6, s30
    v_perm_b32 v26, v6, v5, s30
    v_perm_b32 v27, v5, v4, s30
    ds_write_b128 v21, v[24:27] offset:0
    s_nop 1
    v_perm_b32 v24, v8, v8, s31
    v_perm_b32 v25, v7, v7, s31
    v_perm_b32 v26, v6, v6, s31
    v_perm_b32 v27, v5, v5, s31
    ds_write_b128 v21, v[24:27] offset:4192
    s_nop 1
    v_perm_b32 v24, v9, v8, s30
    v_perm_b32 v25, v8, v7, s30
    v_perm_b32 v26, v7, v6, s30
    v_perm_b32 v27, v6, v5, s30
    ds_write_b128 v21, v[24:27] offset:8384
    s_nop 1
    v_perm_b32 v24, v9, v9, s31
    v_perm_b32 v25, v8, v8, s31
    v_perm_b32 v26, v7, v7, s31
    v_perm_b32 v27, v6, v6, s31
    ds_write_b128 v21, v[24:27] offset:12576
    s_nop 1
    v_perm_b32 v24, v10, v9, s30
    v_perm_b32 v25, v9, v8, s30
    v_perm_b32 v26, v8, v7, s30
    v_perm_b32 v27, v7, v6, s30
    ds_write_b128 v21, v[24:27] offset:16768
    s_nop 1
    v_perm_b32 v24, v10, v10, s31
    v_perm_b32 v25, v9, v9, s31
    v_perm_b32 v26, v8, v8, s31
    v_perm_b32 v27, v7, v7, s31
    ds_write_b128 v21, v[24:27] offset:20960
    s_nop 1
    v_perm_b32 v24, v11, v10, s30
    v_perm_b32 v25, v10, v9, s30
    v_perm_b32 v26, v9, v8, s30
    v_perm_b32 v27, v8, v7, s30
    ds_write_b128 v21, v[24:27] offset:25152
    s_nop 1
    v_perm_b32 v24, v11, v11, s31
    v_perm_b32 v25, v10, v10, s31
    v_perm_b32 v26, v9, v9, s31
    v_perm_b32 v27, v8, v8, s31
    ds_write_b128 v21, v[24:27] offset:29344
    s_nop 1
    v_add_u32 v1, 256, v0
    v_cmp_le_u32 vcc, 260, v1
    s_nop 1
    v_cndmask_b32 v2, 0, 1, vcc
    v_mul_u32_u24 v3, 260, v2
    v_sub_u32 v3, v1, v3
    v_lshlrev_b32 v16, 3, v3
    v_sub_u32 v17, 2040, v16
    v_sub_u32 v18, 2048, v16
    v_mov_b32 v20, -1
    v_lshlrev_b32 v19, 1, v17
    v_lshl_add_u32 v19, v2, 12, v19
    v_cmp_gt_u32 vcc, 2048, v17
    s_nop 1
    v_cndmask_b32 v19, v20, v19, vcc
    buffer_load_dwordx4 v[4:7], v19, s[12:15], 0 offen
    v_lshlrev_b32 v19, 1, v18
    v_lshl_add_u32 v19, v2, 12, v19
    v_cmp_gt_u32 vcc, 2048, v18
    s_nop 1
    v_cndmask_b32 v19, v20, v19, vcc
    buffer_load_dwordx4 v[8:11], v19, s[12:15], 0 offen
    v_mul_u32_u24 v21, 33536, v2
    v_lshl_add_u32 v21, v3, 4, v21
    s_waitcnt vmcnt(0)
    v_perm_b32 v24, v8, v7, s30
    v_perm_b32 v25, v7, v6, s30
    v_perm_b32 v26, v6, v5, s30
    v_perm_b32 v27, v5, v4, s30
    ds_write_b128 v21, v[24:27] offset:0
    s_nop 1
    v_perm_b32 v24, v8, v8, s31
    v_perm_b32 v25, v7, v7, s31
    v_perm_b32 v26, v6, v6, s31
    v_perm_b32 v27, v5, v5, s31
    ds_write_b128 v21, v[24:27] offset:4192
    s_nop 1
    v_perm_b32 v24, v9, v8, s30
    v_perm_b32 v25, v8, v7, s30
    v_perm_b32 v26, v7, v6, s30
    v_perm_b32 v27, v6, v5, s30
    ds_write_b128 v21, v[24:27] offset:8384
    s_nop 1
    v_perm_b32 v24, v9, v9, s31
    v_perm_b32 v25, v8, v8, s31
    v_perm_b32 v26, v7, v7, s31
    v_perm_b32 v27, v6, v6, s31
    ds_write_b128 v21, v[24:27] offset:12576
    s_nop 1
    v_perm_b32 v24, v10, v9, s30
    v_perm_b32 v25, v9, v8, s30
    v_perm_b32 v26, v8, v7, s30
    v_perm_b32 v27, v7, v6, s30
    ds_write_b128 v21, v[24:27] offset:16768
    s_nop 1
    v_perm_b32 v24, v10, v10, s31
    v_perm_b32 v25, v9, v9, s31
    v_perm_b32 v26, v8, v8, s31
    v_perm_b32 v27, v7, v7, s31
    ds_write_b128 v21, v[24:27] offset:20960
    s_nop 1
    v_perm_b32 v24, v11, v10, s30
    v_perm_b32 v25, v10, v9, s30
    v_perm_b32 v26, v9, v8, s30
    v_perm_b32 v27, v8, v7, s30
    ds_write_b128 v21, v[24:27] offset:25152
    s_nop 1
    v_perm_b32 v24, v11, v11, s31
    v_perm_b32 v25, v10, v10, s31
    v_perm_b32 v26, v9, v9, s31
    v_perm_b32 v27, v8, v8, s31
    ds_write_b128 v21, v[24:27] offset:29344
    s_nop 1
    v_add_u32 v1, 512, v0
    v_cmp_gt_u32 vcc, 520, v1
    s_and_saveexec_b64 s[24:25], vcc
    s_cbranch_execz L_conv_qdone
    v_cmp_le_u32 vcc, 260, v1
    s_nop 1
    v_cndmask_b32 v2, 0, 1, vcc
    v_mul_u32_u24 v3, 260, v2
    v_sub_u32 v3, v1, v3
    v_lshlrev_b32 v16, 3, v3
    v_sub_u32 v17, 2040, v16
    v_sub_u32 v18, 2048, v16
    v_mov_b32 v20, -1
    v_lshlrev_b32 v19, 1, v17
    v_lshl_add_u32 v19, v2, 12, v19
    v_cmp_gt_u32 vcc, 2048, v17
    s_nop 1
    v_cndmask_b32 v19, v20, v19, vcc
    buffer_load_dwordx4 v[4:7], v19, s[12:15], 0 offen
    v_lshlrev_b32 v19, 1, v18
    v_lshl_add_u32 v19, v2, 12, v19
    v_cmp_gt_u32 vcc, 2048, v18
    s_nop 1
    v_cndmask_b32 v19, v20, v19, vcc
    buffer_load_dwordx4 v[8:11], v19, s[12:15], 0 offen
    v_mul_u32_u24 v21, 33536, v2
    v_lshl_add_u32 v21, v3, 4, v21
    s_waitcnt vmcnt(0)
    v_perm_b32 v24, v8, v7, s30
    v_perm_b32 v25, v7, v6, s30
    v_perm_b32 v26, v6, v5, s30
    v_perm_b32 v27, v5, v4, s30
    ds_write_b128 v21, v[24:27] offset:0
    s_nop 1
    v_perm_b32 v24, v8, v8, s31
    v_perm_b32 v25, v7, v7, s31
    v_perm_b32 v26, v6, v6, s31
    v_perm_b32 v27, v5, v5, s31
    ds_write_b128 v21, v[24:27] offset:4192
    s_nop 1
    v_perm_b32 v24, v9, v8, s30
    v_perm_b32 v25, v8, v7, s30
    v_perm_b32 v26, v7, v6, s30
    v_perm_b32 v27, v6, v5, s30
    ds_write_b128 v21, v[24:27] offset:8384
    s_nop 1
    v_perm_b32 v24, v9, v9, s31
    v_perm_b32 v25, v8, v8, s31
    v_perm_b32 v26, v7, v7, s31
    v_perm_b32 v27, v6, v6, s31
    ds_write_b128 v21, v[24:27] offset:12576
    s_nop 1
    v_perm_b32 v24, v10, v9, s30
    v_perm_b32 v25, v9, v8, s30
    v_perm_b32 v26, v8, v7, s30
    v_perm_b32 v27, v7, v6, s30
    ds_write_b128 v21, v[24:27] offset:16768
    s_nop 1
    v_perm_b32 v24, v10, v10, s31
    v_perm_b32 v25, v9, v9, s31
    v_perm_b32 v26, v8, v8, s31
    v_perm_b32 v27, v7, v7, s31
    ds_write_b128 v21, v[24:27] offset:20960
    s_nop 1
    v_perm_b32 v24, v11, v10, s30
    v_perm_b32 v25, v10, v9, s30
    v_perm_b32 v26, v9, v8, s30
    v_perm_b32 v27, v8, v7, s30
    ds_write_b128 v21, v[24:27] offset:25152
    s_nop 1
    v_perm_b32 v24, v11, v11, s31
    v_perm_b32 v25, v10, v10, s31
    v_perm_b32 v26, v9, v9, s31
    v_perm_b32 v27, v8, v8, s31
    ds_write_b128 v21, v[24:27] offset:29344
    s_nop 1
L_conv_qdone:
    s_mov_b64 exec, -1
    s_waitcnt lgkmcnt(0)
    s_barrier
    v_lshrrev_b32 v1, 6, v0
    s_nop 0
    v_readfirstlane_b32 s26, v1
    s_nop 3
    s_lshr_b32 s27, s26, 1
    s_and_b32 s28, s26, 1
    v_and_b32 v1, 63, v0
    v_and_b32 v2, 31, v1
    v_lshrrev_b32 v3, 5, v1
    v_and_b32 v4, 7, v2
    v_mul_u32_u24 v4, 4192, v4
    v_lshrrev_b32 v5, 3, v2
    v_sub_u32 v5, v3, v5
    v_lshlrev_b32 v5, 4, v5
    v_add_u32 v4, v4, v5
    s_mul_i32 s29, s27, 33536
    s_add_u32 s29, s29, 4096
    s_lshl_b32 s24, s28, 6
    s_sub_u32 s29, s29, s24
    v_add_u32 v4, s29, v4
    v_mul_u32_u24 v5, 80, v2
    v_lshl_add_u32 v5, v3, 4, v5
    s_mul_i32 s29, s27, 7680
    s_add_u32 s29, s29, 69632
    s_mul_i32 s24, s28, 80
    s_sub_u32 s29, s29, s24
    v_add_u32 v5, s29, v5
    v_mov_b32 v64, 0
    v_mov_b32 v65, 0
    v_mov_b32 v66, 0
    v_mov_b32 v67, 0
    v_mov_b32 v68, 0
    v_mov_b32 v69, 0
    v_mov_b32 v70, 0
    v_mov_b32 v71, 0
    v_mov_b32 v72, 0
    v_mov_b32 v73, 0
    v_mov_b32 v74, 0
    v_mov_b32 v75, 0
    v_mov_b32 v76, 0
    v_mov_b32 v77, 0
    v_mov_b32 v78, 0
    v_mov_b32 v79, 0
    v_mov_b32 v80, 0
    v_mov_b32 v81, 0
    v_mov_b32 v82, 0
    v_mov_b32 v83, 0
    v_mov_b32 v84, 0
    v_mov_b32 v85, 0
    v_mov_b32 v86, 0
    v_mov_b32 v87, 0
    v_mov_b32 v88, 0
    v_mov_b32 v89, 0
    v_mov_b32 v90, 0
    v_mov_b32 v91, 0
    v_mov_b32 v92, 0
    v_mov_b32 v93, 0
    v_mov_b32 v94, 0
    v_mov_b32 v95, 0
    ds_read_b128 v[8:11], v4 offset:0
    ds_read_b128 v[12:15], v4 offset:32
    ds_read_b128 v[16:19], v5 offset:0
    ds_read_b128 v[20:23], v5 offset:32
    ds_read_b128 v[24:27], v5 offset:2560
    ds_read_b128 v[28:31], v5 offset:2592
    v_subrev_u32 v4, 128, v4
    v_subrev_u32 v5, 160, v5
    ds_read_b128 v[96:99], v4 offset:0
    ds_read_b128 v[100:103], v4 offset:32
    ds_read_b128 v[104:107], v5 offset:0
    ds_read_b128 v[108:111], v5 offset:32
    ds_read_b128 v[112:115], v5 offset:2560
    ds_read_b128 v[116:119], v5 offset:2592
    v_subrev_u32 v4, 128, v4
    v_subrev_u32 v5, 160, v5
    s_waitcnt lgkmcnt(6)
    v_mfma_f32_32x32x16_bf16 v[64:79], v[8:11], v[16:19], v[64:79]
    v_mfma_f32_32x32x16_bf16 v[64:79], v[12:15], v[20:23], v[64:79]
    v_mfma_f32_32x32x16_bf16 v[80:95], v[8:11], v[24:27], v[80:95]
    v_mfma_f32_32x32x16_bf16 v[80:95], v[12:15], v[28:31], v[80:95]
    ds_read_b128 v[8:11], v4 offset:0
    ds_read_b128 v[12:15], v4 offset:32
    ds_read_b128 v[16:19], v5 offset:0
    ds_read_b128 v[20:23], v5 offset:32
    ds_read_b128 v[24:27], v5 offset:2560
    ds_read_b128 v[28:31], v5 offset:2592
    v_subrev_u32 v4, 128, v4
    v_subrev_u32 v5, 160, v5
    s_waitcnt lgkmcnt(6)
    v_mfma_f32_32x32x16_bf16 v[64:79], v[96:99], v[104:107], v[64:79]
    v_mfma_f32_32x32x16_bf16 v[64:79], v[100:103], v[108:111], v[64:79]
    v_mfma_f32_32x32x16_bf16 v[80:95], v[96:99], v[112:115], v[80:95]
    v_mfma_f32_32x32x16_bf16 v[80:95], v[100:103], v[116:119], v[80:95]
    ds_read_b128 v[96:99], v4 offset:0
    ds_read_b128 v[100:103], v4 offset:32
    ds_read_b128 v[104:107], v5 offset:0
    ds_read_b128 v[108:111], v5 offset:32
    ds_read_b128 v[112:115], v5 offset:2560
    ds_read_b128 v[116:119], v5 offset:2592
    v_subrev_u32 v4, 128, v4
    v_subrev_u32 v5, 160, v5
    s_waitcnt lgkmcnt(6)
    v_mfma_f32_32x32x16_bf16 v[64:79], v[8:11], v[16:19], v[64:79]
    v_mfma_f32_32x32x16_bf16 v[64:79], v[12:15], v[20:23], v[64:79]
    v_mfma_f32_32x32x16_bf16 v[80:95], v[8:11], v[24:27], v[80:95]
    v_mfma_f32_32x32x16_bf16 v[80:95], v[12:15], v[28:31], v[80:95]
    ds_read_b128 v[8:11], v4 offset:0
    ds_read_b128 v[12:15], v4 offset:32
    ds_read_b128 v[16:19], v5 offset:0
    ds_read_b128 v[20:23], v5 offset:32
    ds_read_b128 v[24:27], v5 offset:2560
    ds_read_b128 v[28:31], v5 offset:2592
    v_subrev_u32 v4, 128, v4
    v_subrev_u32 v5, 160, v5
    s_waitcnt lgkmcnt(6)
    v_mfma_f32_32x32x16_bf16 v[64:79], v[96:99], v[104:107], v[64:79]
    v_mfma_f32_32x32x16_bf16 v[64:79], v[100:103], v[108:111], v[64:79]
    v_mfma_f32_32x32x16_bf16 v[80:95], v[96:99], v[112:115], v[80:95]
    v_mfma_f32_32x32x16_bf16 v[80:95], v[100:103], v[116:119], v[80:95]
    ds_read_b128 v[96:99], v4 offset:0
    ds_read_b128 v[100:103], v4 offset:32
    ds_read_b128 v[104:107], v5 offset:0
    ds_read_b128 v[108:111], v5 offset:32
    ds_read_b128 v[112:115], v5 offset:2560
    ds_read_b128 v[116:119], v5 offset:2592
    v_subrev_u32 v4, 128, v4
    v_subrev_u32 v5, 160, v5
    s_waitcnt lgkmcnt(6)
    v_mfma_f32_32x32x16_bf16 v[64:79], v[8:11], v[16:19], v[64:79]
    v_mfma_f32_32x32x16_bf16 v[64:79], v[12:15], v[20:23], v[64:79]
    v_mfma_f32_32x32x16_bf16 v[80:95], v[8:11], v[24:27], v[80:95]
    v_mfma_f32_32x32x16_bf16 v[80:95], v[12:15], v[28:31], v[80:95]
    ds_read_b128 v[8:11], v4 offset:0
    ds_read_b128 v[12:15], v4 offset:32
    ds_read_b128 v[16:19], v5 offset:0
    ds_read_b128 v[20:23], v5 offset:32
    ds_read_b128 v[24:27], v5 offset:2560
    ds_read_b128 v[28:31], v5 offset:2592
    v_subrev_u32 v4, 128, v4
    v_subrev_u32 v5, 160, v5
    s_waitcnt lgkmcnt(6)
    v_mfma_f32_32x32x16_bf16 v[64:79], v[96:99], v[104:107], v[64:79]
    v_mfma_f32_32x32x16_bf16 v[64:79], v[100:103], v[108:111], v[64:79]
    v_mfma_f32_32x32x16_bf16 v[80:95], v[96:99], v[112:115], v[80:95]
    v_mfma_f32_32x32x16_bf16 v[80:95], v[100:103], v[116:119], v[80:95]
    ds_read_b128 v[96:99], v4 offset:0
    ds_read_b128 v[100:103], v4 offset:32
    ds_read_b128 v[104:107], v5 offset:0
    ds_read_b128 v[108:111], v5 offset:32
    ds_read_b128 v[112:115], v5 offset:2560
    ds_read_b128 v[116:119], v5 offset:2592
    v_subrev_u32 v4, 128, v4
    v_subrev_u32 v5, 160, v5
    s_waitcnt lgkmcnt(6)
    v_mfma_f32_32x32x16_bf16 v[64:79], v[8:11], v[16:19], v[64:79]
    v_mfma_f32_32x32x16_bf16 v[64:79], v[12:15], v[20:23], v[64:79]
    v_mfma_f32_32x32x16_bf16 v[80:95], v[8:11], v[24:27], v[80:95]
    v_mfma_f32_32x32x16_bf16 v[80:95], v[12:15], v[28:31], v[80:95]
    ds_read_b128 v[8:11], v4 offset:0
    ds_read_b128 v[12:15], v4 offset:32
    ds_read_b128 v[16:19], v5 offset:0
    ds_read_b128 v[20:23], v5 offset:32
    ds_read_b128 v[24:27], v5 offset:2560
    ds_read_b128 v[28:31], v5 offset:2592
    v_subrev_u32 v4, 128, v4
    v_subrev_u32 v5, 160, v5
    s_waitcnt lgkmcnt(6)
    v_mfma_f32_32x32x16_bf16 v[64:79], v[96:99], v[104:107], v[64:79]
    v_mfma_f32_32x32x16_bf16 v[64:79], v[100:103], v[108:111], v[64:79]
    v_mfma_f32_32x32x16_bf16 v[80:95], v[96:99], v[112:115], v[80:95]
    v_mfma_f32_32x32x16_bf16 v[80:95], v[100:103], v[116:119], v[80:95]
    ds_read_b128 v[96:99], v4 offset:0
    ds_read_b128 v[100:103], v4 offset:32
    ds_read_b128 v[104:107], v5 offset:0
    ds_read_b128 v[108:111], v5 offset:32
    ds_read_b128 v[112:115], v5 offset:2560
    ds_read_b128 v[116:119], v5 offset:2592
    v_subrev_u32 v4, 128, v4
    v_subrev_u32 v5, 160, v5
    s_waitcnt lgkmcnt(6)
    v_mfma_f32_32x32x16_bf16 v[64:79], v[8:11], v[16:19], v[64:79]
    v_mfma_f32_32x32x16_bf16 v[64:79], v[12:15], v[20:23], v[64:79]
    v_mfma_f32_32x32x16_bf16 v[80:95], v[8:11], v[24:27], v[80:95]
    v_mfma_f32_32x32x16_bf16 v[80:95], v[12:15], v[28:31], v[80:95]
    ds_read_b128 v[8:11], v4 offset:0
    ds_read_b128 v[12:15], v4 offset:32
    ds_read_b128 v[16:19], v5 offset:0
    ds_read_b128 v[20:23], v5 offset:32
    ds_read_b128 v[24:27], v5 offset:2560
    ds_read_b128 v[28:31], v5 offset:2592
    v_subrev_u32 v4, 128, v4
    v_subrev_u32 v5, 160, v5
    s_waitcnt lgkmcnt(6)
    v_mfma_f32_32x32x16_bf16 v[64:79], v[96:99], v[104:107], v[64:79]
    v_mfma_f32_32x32x16_bf16 v[64:79], v[100:103], v[108:111], v[64:79]
    v_mfma_f32_32x32x16_bf16 v[80:95], v[96:99], v[112:115], v[80:95]
    v_mfma_f32_32x32x16_bf16 v[80:95], v[100:103], v[116:119], v[80:95]
    ds_read_b128 v[96:99], v4 offset:0
    ds_read_b128 v[100:103], v4 offset:32
    ds_read_b128 v[104:107], v5 offset:0
    ds_read_b128 v[108:111], v5 offset:32
    ds_read_b128 v[112:115], v5 offset:2560
    ds_read_b128 v[116:119], v5 offset:2592
    v_subrev_u32 v4, 128, v4
    v_subrev_u32 v5, 160, v5
    s_waitcnt lgkmcnt(6)
    v_mfma_f32_32x32x16_bf16 v[64:79], v[8:11], v[16:19], v[64:79]
    v_mfma_f32_32x32x16_bf16 v[64:79], v[12:15], v[20:23], v[64:79]
    v_mfma_f32_32x32x16_bf16 v[80:95], v[8:11], v[24:27], v[80:95]
    v_mfma_f32_32x32x16_bf16 v[80:95], v[12:15], v[28:31], v[80:95]
    ds_read_b128 v[8:11], v4 offset:0
    ds_read_b128 v[12:15], v4 offset:32
    ds_read_b128 v[16:19], v5 offset:0
    ds_read_b128 v[20:23], v5 offset:32
    ds_read_b128 v[24:27], v5 offset:2560
    ds_read_b128 v[28:31], v5 offset:2592
    v_subrev_u32 v4, 128, v4
    v_subrev_u32 v5, 160, v5
    s_waitcnt lgkmcnt(6)
    v_mfma_f32_32x32x16_bf16 v[64:79], v[96:99], v[104:107], v[64:79]
    v_mfma_f32_32x32x16_bf16 v[64:79], v[100:103], v[108:111], v[64:79]
    v_mfma_f32_32x32x16_bf16 v[80:95], v[96:99], v[112:115], v[80:95]
    v_mfma_f32_32x32x16_bf16 v[80:95], v[100:103], v[116:119], v[80:95]
    ds_read_b128 v[96:99], v4 offset:0
    ds_read_b128 v[100:103], v4 offset:32
    ds_read_b128 v[104:107], v5 offset:0
    ds_read_b128 v[108:111], v5 offset:32
    ds_read_b128 v[112:115], v5 offset:2560
    ds_read_b128 v[116:119], v5 offset:2592
    v_subrev_u32 v4, 128, v4
    v_subrev_u32 v5, 160, v5
    s_waitcnt lgkmcnt(6)
    v_mfma_f32_32x32x16_bf16 v[64:79], v[8:11], v[16:19], v[64:79]
    v_mfma_f32_32x32x16_bf16 v[64:79], v[12:15], v[20:23], v[64:79]
    v_mfma_f32_32x32x16_bf16 v[80:95], v[8:11], v[24:27], v[80:95]
    v_mfma_f32_32x32x16_bf16 v[80:95], v[12:15], v[28:31], v[80:95]
    ds_read_b128 v[8:11], v4 offset:0
    ds_read_b128 v[12:15], v4 offset:32
    ds_read_b128 v[16:19], v5 offset:0
    ds_read_b128 v[20:23], v5 offset:32
    ds_read_b128 v[24:27], v5 offset:2560
    ds_read_b128 v[28:31], v5 offset:2592
    v_subrev_u32 v4, 128, v4
    v_subrev_u32 v5, 160, v5
    s_waitcnt lgkmcnt(6)
    v_mfma_f32_32x32x16_bf16 v[64:79], v[96:99], v[104:107], v[64:79]
    v_mfma_f32_32x32x16_bf16 v[64:79], v[100:103], v[108:111], v[64:79]
    v_mfma_f32_32x32x16_bf16 v[80:95], v[96:99], v[112:115], v[80:95]
    v_mfma_f32_32x32x16_bf16 v[80:95], v[100:103], v[116:119], v[80:95]
    ds_read_b128 v[96:99], v4 offset:0
    ds_read_b128 v[100:103], v4 offset:32
    ds_read_b128 v[104:107], v5 offset:0
    ds_read_b128 v[108:111], v5 offset:32
    ds_read_b128 v[112:115], v5 offset:2560
    ds_read_b128 v[116:119], v5 offset:2592
    v_subrev_u32 v4, 128, v4
    v_subrev_u32 v5, 160, v5
    s_waitcnt lgkmcnt(6)
    v_mfma_f32_32x32x16_bf16 v[64:79], v[8:11], v[16:19], v[64:79]
    v_mfma_f32_32x32x16_bf16 v[64:79], v[12:15], v[20:23], v[64:79]
    v_mfma_f32_32x32x16_bf16 v[80:95], v[8:11], v[24:27], v[80:95]
    v_mfma_f32_32x32x16_bf16 v[80:95], v[12:15], v[28:31], v[80:95]
    ds_read_b128 v[8:11], v4 offset:0
    ds_read_b128 v[12:15], v4 offset:32
    ds_read_b128 v[24:27], v5 offset:2560
    ds_read_b128 v[28:31], v5 offset:2592
    v_subrev_u32 v4, 128, v4
    v_subrev_u32 v5, 160, v5
    s_waitcnt lgkmcnt(4)
    v_mfma_f32_32x32x16_bf16 v[64:79], v[96:99], v[104:107], v[64:79]
    v_mfma_f32_32x32x16_bf16 v[64:79], v[100:103], v[108:111], v[64:79]
    v_mfma_f32_32x32x16_bf16 v[80:95], v[96:99], v[112:115], v[80:95]
    v_mfma_f32_32x32x16_bf16 v[80:95], v[100:103], v[116:119], v[80:95]
    ds_read_b128 v[96:99], v4 offset:0
    ds_read_b128 v[100:103], v4 offset:32
    ds_read_b128 v[112:115], v5 offset:2560
    ds_read_b128 v[116:119], v5 offset:2592
    v_subrev_u32 v4, 128, v4
    v_subrev_u32 v5, 160, v5
    s_waitcnt lgkmcnt(4)
    v_mfma_f32_32x32x16_bf16 v[80:95], v[8:11], v[24:27], v[80:95]
    v_mfma_f32_32x32x16_bf16 v[80:95], v[12:15], v[28:31], v[80:95]
    ds_read_b128 v[8:11], v4 offset:0
    ds_read_b128 v[12:15], v4 offset:32
    ds_read_b128 v[24:27], v5 offset:2560
    ds_read_b128 v[28:31], v5 offset:2592
    v_subrev_u32 v4, 128, v4
    v_subrev_u32 v5, 160, v5
    s_waitcnt lgkmcnt(4)
    v_mfma_f32_32x32x16_bf16 v[80:95], v[96:99], v[112:115], v[80:95]
    v_mfma_f32_32x32x16_bf16 v[80:95], v[100:103], v[116:119], v[80:95]
    ds_read_b128 v[96:99], v4 offset:0
    ds_read_b128 v[100:103], v4 offset:32
    ds_read_b128 v[112:115], v5 offset:2560
    ds_read_b128 v[116:119], v5 offset:2592
    v_subrev_u32 v4, 128, v4
    v_subrev_u32 v5, 160, v5
    s_waitcnt lgkmcnt(4)
    v_mfma_f32_32x32x16_bf16 v[80:95], v[8:11], v[24:27], v[80:95]
    v_mfma_f32_32x32x16_bf16 v[80:95], v[12:15], v[28:31], v[80:95]
    ds_read_b128 v[8:11], v4 offset:0
    ds_read_b128 v[12:15], v4 offset:32
    ds_read_b128 v[24:27], v5 offset:2560
    ds_read_b128 v[28:31], v5 offset:2592
    v_subrev_u32 v4, 128, v4
    v_subrev_u32 v5, 160, v5
    s_waitcnt lgkmcnt(4)
    v_mfma_f32_32x32x16_bf16 v[80:95], v[96:99], v[112:115], v[80:95]
    v_mfma_f32_32x32x16_bf16 v[80:95], v[100:103], v[116:119], v[80:95]
    ds_read_b128 v[96:99], v4 offset:0
    ds_read_b128 v[100:103], v4 offset:32
    ds_read_b128 v[112:115], v5 offset:2560
    ds_read_b128 v[116:119], v5 offset:2592
    v_subrev_u32 v4, 128, v4
    v_subrev_u32 v5, 160, v5
    s_waitcnt lgkmcnt(4)
    v_mfma_f32_32x32x16_bf16 v[80:95], v[8:11], v[24:27], v[80:95]
    v_mfma_f32_32x32x16_bf16 v[80:95], v[12:15], v[28:31], v[80:95]
    ds_read_b128 v[8:11], v4 offset:0
    ds_read_b128 v[12:15], v4 offset:32
    ds_read_b128 v[24:27], v5 offset:2560
    ds_read_b128 v[28:31], v5 offset:2592
    v_subrev_u32 v4, 128, v4
    v_subrev_u32 v5, 160, v5
    s_waitcnt lgkmcnt(4)
    v_mfma_f32_32x32x16_bf16 v[80:95], v[96:99], v[112:115], v[80:95]
    v_mfma_f32_32x32x16_bf16 v[80:95], v[100:103], v[116:119], v[80:95]
    ds_read_b128 v[96:99], v4 offset:0
    ds_read_b128 v[100:103], v4 offset:32
    ds_read_b128 v[112:115], v5 offset:2560
    ds_read_b128 v[116:119], v5 offset:2592
    v_subrev_u32 v4, 128, v4
    v_subrev_u32 v5, 160, v5
    s_waitcnt lgkmcnt(4)
    v_mfma_f32_32x32x16_bf16 v[80:95], v[8:11], v[24:27], v[80:95]
    v_mfma_f32_32x32x16_bf16 v[80:95], v[12:15], v[28:31], v[80:95]
    ds_read_b128 v[8:11], v4 offset:0
    ds_read_b128 v[12:15], v4 offset:32
    ds_read_b128 v[24:27], v5 offset:2560
    ds_read_b128 v[28:31], v5 offset:2592
    v_subrev_u32 v4, 128, v4
    v_subrev_u32 v5, 160, v5
    s_waitcnt lgkmcnt(4)
    v_mfma_f32_32x32x16_bf16 v[80:95], v[96:99], v[112:115], v[80:95]
    v_mfma_f32_32x32x16_bf16 v[80:95], v[100:103], v[116:119], v[80:95]
    ds_read_b128 v[96:99], v4 offset:0
    ds_read_b128 v[100:103], v4 offset:32
    ds_read_b128 v[112:115], v5 offset:2560
    ds_read_b128 v[116:119], v5 offset:2592
    v_subrev_u32 v4, 128, v4
    v_subrev_u32 v5, 160, v5
    s_waitcnt lgkmcnt(4)
    v_mfma_f32_32x32x16_bf16 v[80:95], v[8:11], v[24:27], v[80:95]
    v_mfma_f32_32x32x16_bf16 v[80:95], v[12:15], v[28:31], v[80:95]
    ds_read_b128 v[8:11], v4 offset:0
    ds_read_b128 v[12:15], v4 offset:32
    ds_read_b128 v[24:27], v5 offset:2560
    ds_read_b128 v[28:31], v5 offset:2592
    v_subrev_u32 v4, 128, v4
    v_subrev_u32 v5, 160, v5
    s_waitcnt lgkmcnt(4)
    v_mfma_f32_32x32x16_bf16 v[80:95], v[96:99], v[112:115], v[80:95]
    v_mfma_f32_32x32x16_bf16 v[80:95], v[100:103], v[116:119], v[80:95]
    ds_read_b128 v[96:99], v4 offset:0
    ds_read_b128 v[100:103], v4 offset:32
    ds_read_b128 v[112:115], v5 offset:2560
    ds_read_b128 v[116:119], v5 offset:2592
    v_subrev_u32 v4, 128, v4
    v_subrev_u32 v5, 160, v5
    s_waitcnt lgkmcnt(4)
    v_mfma_f32_32x32x16_bf16 v[80:95], v[8:11], v[24:27], v[80:95]
    v_mfma_f32_32x32x16_bf16 v[80:95], v[12:15], v[28:31], v[80:95]
    ds_read_b128 v[8:11], v4 offset:0
    ds_read_b128 v[12:15], v4 offset:32
    ds_read_b128 v[24:27], v5 offset:2560
    ds_read_b128 v[28:31], v5 offset:2592
    v_subrev_u32 v4, 128, v4
    v_subrev_u32 v5, 160, v5
    s_waitcnt lgkmcnt(4)
    v_mfma_f32_32x32x16_bf16 v[80:95], v[96:99], v[112:115], v[80:95]
    v_mfma_f32_32x32x16_bf16 v[80:95], v[100:103], v[116:119], v[80:95]
    ds_read_b128 v[96:99], v4 offset:0
    ds_read_b128 v[100:103], v4 offset:32
    ds_read_b128 v[112:115], v5 offset:2560
    ds_read_b128 v[116:119], v5 offset:2592
    v_subrev_u32 v4, 128, v4
    v_subrev_u32 v5, 160, v5
    s_waitcnt lgkmcnt(4)
    v_mfma_f32_32x32x16_bf16 v[80:95], v[8:11], v[24:27], v[80:95]
    v_mfma_f32_32x32x16_bf16 v[80:95], v[12:15], v[28:31], v[80:95]
    ds_read_b128 v[8:11], v4 offset:0
    ds_read_b128 v[12:15], v4 offset:32
    ds_read_b128 v[24:27], v5 offset:2560
    ds_read_b128 v[28:31], v5 offset:2592
    v_subrev_u32 v4, 128, v4
    v_subrev_u32 v5, 160, v5
    s_waitcnt lgkmcnt(4)
    v_mfma_f32_32x32x16_bf16 v[80:95], v[96:99], v[112:115], v[80:95]
    v_mfma_f32_32x32x16_bf16 v[80:95], v[100:103], v[116:119], v[80:95]
    ds_read_b128 v[96:99], v4 offset:0
    ds_read_b128 v[100:103], v4 offset:32
    ds_read_b128 v[112:115], v5 offset:2560
    ds_read_b128 v[116:119], v5 offset:2592
    v_subrev_u32 v4, 128, v4
    v_subrev_u32 v5, 160, v5
    s_waitcnt lgkmcnt(4)
    v_mfma_f32_32x32x16_bf16 v[80:95], v[8:11], v[24:27], v[80:95]
    v_mfma_f32_32x32x16_bf16 v[80:95], v[12:15], v[28:31], v[80:95]
    s_waitcnt lgkmcnt(0)
    v_mfma_f32_32x32x16_bf16 v[80:95], v[96:99], v[112:115], v[80:95]
    v_mfma_f32_32x32x16_bf16 v[80:95], v[100:103], v[116:119], v[80:95]
    s_nop 15
    s_lshl_b32 s24, s27, 1
    s_xor_b32 s29, s28, 1
    s_add_u32 s29, s24, s29
    s_lshl_b32 s29, s29, 12
    s_add_u32 s29, s29, 82432
    v_lshl_add_u32 v6, v1, 2, s29
    s_add_u32 s29, s24, s28
    s_lshl_b32 s29, s29, 12
    s_add_u32 s29, s29, 82432
    v_lshl_add_u32 v7, v1, 2, s29
    s_cmp_eq_u32 s28, 0
    s_cbranch_scc1 L_conv_h0w
    ds_write_b32 v6, v64 offset:0
    v_mov_b32 v64, v80
    ds_write_b32 v6, v65 offset:256
    v_mov_b32 v65, v81
    ds_write_b32 v6, v66 offset:512
    v_mov_b32 v66, v82
    ds_write_b32 v6, v67 offset:768
    v_mov_b32 v67, v83
    ds_write_b32 v6, v68 offset:1024
    v_mov_b32 v68, v84
    ds_write_b32 v6, v69 offset:1280
    v_mov_b32 v69, v85
    ds_write_b32 v6, v70 offset:1536
    v_mov_b32 v70, v86
    ds_write_b32 v6, v71 offset:1792
    v_mov_b32 v71, v87
    ds_write_b32 v6, v72 offset:2048
    v_mov_b32 v72, v88
    ds_write_b32 v6, v73 offset:2304
    v_mov_b32 v73, v89
    ds_write_b32 v6, v74 offset:2560
    v_mov_b32 v74, v90
    ds_write_b32 v6, v75 offset:2816
    v_mov_b32 v75, v91
    ds_write_b32 v6, v76 offset:3072
    v_mov_b32 v76, v92
    ds_write_b32 v6, v77 offset:3328
    v_mov_b32 v77, v93
    ds_write_b32 v6, v78 offset:3584
    v_mov_b32 v78, v94
    ds_write_b32 v6, v79 offset:3840
    v_mov_b32 v79, v95
    s_branch L_conv_wdone
L_conv_h0w:
    ds_write_b32 v6, v80 offset:0
    ds_write_b32 v6, v81 offset:256
    ds_write_b32 v6, v82 offset:512
    ds_write_b32 v6, v83 offset:768
    ds_write_b32 v6, v84 offset:1024
    ds_write_b32 v6, v85 offset:1280
    ds_write_b32 v6, v86 offset:1536
    ds_write_b32 v6, v87 offset:1792
    ds_write_b32 v6, v88 offset:2048
    ds_write_b32 v6, v89 offset:2304
    ds_write_b32 v6, v90 offset:2560
    ds_write_b32 v6, v91 offset:2816
    ds_write_b32 v6, v92 offset:3072
    ds_write_b32 v6, v93 offset:3328
    ds_write_b32 v6, v94 offset:3584
    ds_write_b32 v6, v95 offset:3840
L_conv_wdone:
    s_waitcnt lgkmcnt(0)
    s_barrier
    ds_read_b32 v8, v7 offset:0
    ds_read_b32 v9, v7 offset:256
    ds_read_b32 v10, v7 offset:512
    ds_read_b32 v11, v7 offset:768
    ds_read_b32 v12, v7 offset:1024
    ds_read_b32 v13, v7 offset:1280
    ds_read_b32 v14, v7 offset:1536
    ds_read_b32 v15, v7 offset:1792
    ds_read_b32 v16, v7 offset:2048
    ds_read_b32 v17, v7 offset:2304
    ds_read_b32 v18, v7 offset:2560
    ds_read_b32 v19, v7 offset:2816
    ds_read_b32 v20, v7 offset:3072
    ds_read_b32 v21, v7 offset:3328
    ds_read_b32 v22, v7 offset:3584
    ds_read_b32 v23, v7 offset:3840
    s_lshl_b32 s24, s28, 5
    v_add_u32 v30, s24, v2
    v_mul_u32_u24 v31, 80, v30
    v_lshl_add_u32 v31, v3, 3, v31
    s_mul_i32 s29, s27, 7680
    s_add_u32 s29, s29, 69632
    v_add_u32 v31, s29, v31
    ds_read_b64 v[40:41], v31 offset:0
    ds_read_b64 v[42:43], v31 offset:16
    ds_read_b64 v[44:45], v31 offset:32
    ds_read_b64 v[46:47], v31 offset:48
    s_lshl_b32 s24, s2, 1
    s_add_u32 s24, s24, s27
    s_lshl_b32 s29, s24, 1
    v_mov_b32 v32, s29
    buffer_load_ushort v33, v32, s[16:19], 0 offen
    v_lshlrev_b32 v34, 5, v30
    v_lshl_add_u32 v34, v3, 2, v34
    v_lshlrev_b32 v34, 1, v34
    s_lshl_b32 s29, s24, 12
    v_add_u32 v34, s29, v34
    v_add_u32 v34, 2097152, v34
    s_waitcnt vmcnt(0) lgkmcnt(0)
    v_lshlrev_b32 v33, 16, v33
    v_add_f32 v35, v64, v8
    v_cvt_pk_bf16_f32 v36, v35, v35
    v_lshlrev_b32 v35, 16, v36
    v_lshlrev_b32 v37, 16, v40
    v_mul_f32 v37, v37, v33
    v_cvt_pk_bf16_f32 v36, v37, v37
    v_lshlrev_b32 v37, 16, v36
    v_add_f32 v35, v35, v37
    v_cvt_pk_bf16_f32 v48, v35, v35
    v_add_f32 v35, v65, v9
    v_cvt_pk_bf16_f32 v36, v35, v35
    v_lshlrev_b32 v35, 16, v36
    v_and_b32 v37, 0xffff0000, v40
    v_mul_f32 v37, v37, v33
    v_cvt_pk_bf16_f32 v36, v37, v37
    v_lshlrev_b32 v37, 16, v36
    v_add_f32 v35, v35, v37
    v_cvt_pk_bf16_f32 v49, v35, v35
    v_add_f32 v35, v66, v10
    v_cvt_pk_bf16_f32 v36, v35, v35
    v_lshlrev_b32 v35, 16, v36
    v_lshlrev_b32 v37, 16, v41
    v_mul_f32 v37, v37, v33
    v_cvt_pk_bf16_f32 v36, v37, v37
    v_lshlrev_b32 v37, 16, v36
    v_add_f32 v35, v35, v37
    v_cvt_pk_bf16_f32 v50, v35, v35
    v_add_f32 v35, v67, v11
    v_cvt_pk_bf16_f32 v36, v35, v35
    v_lshlrev_b32 v35, 16, v36
    v_and_b32 v37, 0xffff0000, v41
    v_mul_f32 v37, v37, v33
    v_cvt_pk_bf16_f32 v36, v37, v37
    v_lshlrev_b32 v37, 16, v36
    v_add_f32 v35, v35, v37
    v_cvt_pk_bf16_f32 v51, v35, v35
    v_add_f32 v35, v68, v12
    v_cvt_pk_bf16_f32 v36, v35, v35
    v_lshlrev_b32 v35, 16, v36
    v_lshlrev_b32 v37, 16, v42
    v_mul_f32 v37, v37, v33
    v_cvt_pk_bf16_f32 v36, v37, v37
    v_lshlrev_b32 v37, 16, v36
    v_add_f32 v35, v35, v37
    v_cvt_pk_bf16_f32 v52, v35, v35
    v_add_f32 v35, v69, v13
    v_cvt_pk_bf16_f32 v36, v35, v35
    v_lshlrev_b32 v35, 16, v36
    v_and_b32 v37, 0xffff0000, v42
    v_mul_f32 v37, v37, v33
    v_cvt_pk_bf16_f32 v36, v37, v37
    v_lshlrev_b32 v37, 16, v36
    v_add_f32 v35, v35, v37
    v_cvt_pk_bf16_f32 v53, v35, v35
    v_add_f32 v35, v70, v14
    v_cvt_pk_bf16_f32 v36, v35, v35
    v_lshlrev_b32 v35, 16, v36
    v_lshlrev_b32 v37, 16, v43
    v_mul_f32 v37, v37, v33
    v_cvt_pk_bf16_f32 v36, v37, v37
    v_lshlrev_b32 v37, 16, v36
    v_add_f32 v35, v35, v37
    v_cvt_pk_bf16_f32 v54, v35, v35
    v_add_f32 v35, v71, v15
    v_cvt_pk_bf16_f32 v36, v35, v35
    v_lshlrev_b32 v35, 16, v36
    v_and_b32 v37, 0xffff0000, v43
    v_mul_f32 v37, v37, v33
    v_cvt_pk_bf16_f32 v36, v37, v37
    v_lshlrev_b32 v37, 16, v36
    v_add_f32 v35, v35, v37
    v_cvt_pk_bf16_f32 v55, v35, v35
    v_add_f32 v35, v72, v16
    v_cvt_pk_bf16_f32 v36, v35, v35
    v_lshlrev_b32 v35, 16, v36
    v_lshlrev_b32 v37, 16, v44
    v_mul_f32 v37, v37, v33
    v_cvt_pk_bf16_f32 v36, v37, v37
    v_lshlrev_b32 v37, 16, v36
    v_add_f32 v35, v35, v37
    v_cvt_pk_bf16_f32 v56, v35, v35
    v_add_f32 v35, v73, v17
    v_cvt_pk_bf16_f32 v36, v35, v35
    v_lshlrev_b32 v35, 16, v36
    v_and_b32 v37, 0xffff0000, v44
    v_mul_f32 v37, v37, v33
    v_cvt_pk_bf16_f32 v36, v37, v37
    v_lshlrev_b32 v37, 16, v36
    v_add_f32 v35, v35, v37
    v_cvt_pk_bf16_f32 v57, v35, v35
    v_add_f32 v35, v74, v18
    v_cvt_pk_bf16_f32 v36, v35, v35
    v_lshlrev_b32 v35, 16, v36
    v_lshlrev_b32 v37, 16, v45
    v_mul_f32 v37, v37, v33
    v_cvt_pk_bf16_f32 v36, v37, v37
    v_lshlrev_b32 v37, 16, v36
    v_add_f32 v35, v35, v37
    v_cvt_pk_bf16_f32 v58, v35, v35
    v_add_f32 v35, v75, v19
    v_cvt_pk_bf16_f32 v36, v35, v35
    v_lshlrev_b32 v35, 16, v36
    v_and_b32 v37, 0xffff0000, v45
    v_mul_f32 v37, v37, v33
    v_cvt_pk_bf16_f32 v36, v37, v37
    v_lshlrev_b32 v37, 16, v36
    v_add_f32 v35, v35, v37
    v_cvt_pk_bf16_f32 v59, v35, v35
    v_add_f32 v35, v76, v20
    v_cvt_pk_bf16_f32 v36, v35, v35
    v_lshlrev_b32 v35, 16, v36
    v_lshlrev_b32 v37, 16, v46
    v_mul_f32 v37, v37, v33
    v_cvt_pk_bf16_f32 v36, v37, v37
    v_lshlrev_b32 v37, 16, v36
    v_add_f32 v35, v35, v37
    v_cvt_pk_bf16_f32 v60, v35, v35
    v_add_f32 v35, v77, v21
    v_cvt_pk_bf16_f32 v36, v35, v35
    v_lshlrev_b32 v35, 16, v36
    v_and_b32 v37, 0xffff0000, v46
    v_mul_f32 v37, v37, v33
    v_cvt_pk_bf16_f32 v36, v37, v37
    v_lshlrev_b32 v37, 16, v36
    v_add_f32 v35, v35, v37
    v_cvt_pk_bf16_f32 v61, v35, v35
    v_add_f32 v35, v78, v22
    v_cvt_pk_bf16_f32 v36, v35, v35
    v_lshlrev_b32 v35, 16, v36
    v_lshlrev_b32 v37, 16, v47
    v_mul_f32 v37, v37, v33
    v_cvt_pk_bf16_f32 v36, v37, v37
    v_lshlrev_b32 v37, 16, v36
    v_add_f32 v35, v35, v37
    v_cvt_pk_bf16_f32 v62, v35, v35
    v_add_f32 v35, v79, v23
    v_cvt_pk_bf16_f32 v36, v35, v35
    v_lshlrev_b32 v35, 16, v36
    v_and_b32 v37, 0xffff0000, v47
    v_mul_f32 v37, v37, v33
    v_cvt_pk_bf16_f32 v36, v37, v37
    v_lshlrev_b32 v37, 16, v36
    v_add_f32 v35, v35, v37
    v_cvt_pk_bf16_f32 v63, v35, v35
    s_mov_b32 s25, 0x05040100
    v_perm_b32 v40, v49, v48, s25
    v_perm_b32 v41, v51, v50, s25
    buffer_store_dwordx2 v[40:41], v34, s[20:23], 0 offen offset:0
    v_perm_b32 v42, v53, v52, s25
    v_perm_b32 v43, v55, v54, s25
    buffer_store_dwordx2 v[42:43], v34, s[20:23], 0 offen offset:16
    v_perm_b32 v44, v57, v56, s25
    v_perm_b32 v45, v59, v58, s25
    buffer_store_dwordx2 v[44:45], v34, s[20:23], 0 offen offset:32
    v_perm_b32 v46, v61, v60, s25
    v_perm_b32 v47, v63, v62, s25
    buffer_store_dwordx2 v[46:47], v34, s[20:23], 0 offen offset:48
    s_waitcnt vmcnt(0)
L_conv_done:
    s_endpgm
.globl ln1_kernel
.p2align 8
.type ln1_kernel,@function
ln1_kernel:
    s_cmp_ge_u32 s2, 128
    s_cbranch_scc1 L_ln1_kernel_done
    s_load_dwordx2 s[4:5], s[0:1], 0
    s_load_dwordx2 s[8:9], s[0:1], 96
    s_waitcnt lgkmcnt(0)
    s_mov_b32 s20, s8
    s_mov_b32 s21, s9
    s_mov_b32 s22, 25165824
    s_mov_b32 s23, 0x00020000
    s_mov_b32 s12, s4
    s_mov_b32 s13, s5
    s_mov_b32 s14, 2097152
    s_mov_b32 s15, 0x00020000
    v_lshrrev_b32 v1, 6, v0
    s_nop 0
    v_readfirstlane_b32 s27, v1
    v_and_b32 v1, 63, v0
    v_lshrrev_b32 v5, 4, v1
    v_and_b32 v6, 15, v1
    s_lshl_b32 s29, s2, 4
    s_lshl_b32 s30, s27, 2
    s_add_u32 s29, s29, s30
    v_add_u32 v7, s29, v5
    v_lshlrev_b32 v7, 10, v7
    v_lshl_add_u32 v7, v6, 4, v7
    v_add_u32 v8, 0, v7
    v_add_u32 v9, 2097152, v7
    v_add_u32 v10, 4194304, v7
    v_lshrrev_b32 v11, 2, v6
    v_lshlrev_b32 v11, 6, v11
    v_and_b32 v12, 3, v6
    v_lshl_add_u32 v11, v12, 4, v11
    v_add_u32 v11, v5, v11
    v_add_u32 v11, s30, v11
    v_lshlrev_b32 v11, 4, v11
    s_lshl_b32 s29, s2, 14
    s_add_u32 s29, s29, 23068672
    v_add_u32 v11, s29, v11
    v_add_u32 v13, 4096, v11
    buffer_load_dwordx4 v[16:19], v8, s[12:15], 0 offen offset:0
    buffer_load_dwordx4 v[20:23], v8, s[12:15], 0 offen offset:256
    buffer_load_dwordx4 v[24:27], v8, s[12:15], 0 offen offset:512
    buffer_load_dwordx4 v[28:31], v8, s[12:15], 0 offen offset:768
    v_lshlrev_b32 v9, 12, v0
    s_lshl_b32 s29, s2, 5
    s_add_u32 s29, s29, 2097152
    v_add_u32 v9, s29, v9
    v_add_u32 v12, 0x100000, v9
    buffer_load_dwordx4 v[32:35], v9, s[20:23], 0 offen
    buffer_load_dwordx4 v[36:39], v9, s[20:23], 0 offen offset:16
    buffer_load_dwordx4 v[40:43], v12, s[20:23], 0 offen
    buffer_load_dwordx4 v[44:47], v12, s[20:23], 0 offen offset:16
    v_lshlrev_b32 v12, 1, v0
    s_waitcnt vmcnt(0)
    ds_write_b16 v12, v32 offset:0
    ds_write_b16_d16_hi v12, v32 offset:1040
    ds_write_b16 v12, v33 offset:2080
    ds_write_b16_d16_hi v12, v33 offset:3120
    ds_write_b16 v12, v34 offset:4160
    ds_write_b16_d16_hi v12, v34 offset:5200
    ds_write_b16 v12, v35 offset:6240
    ds_write_b16_d16_hi v12, v35 offset:7280
    ds_write_b16 v12, v36 offset:8320
    ds_write_b16_d16_hi v12, v36 offset:9360
    ds_write_b16 v12, v37 offset:10400
    ds_write_b16_d16_hi v12, v37 offset:11440
    ds_write_b16 v12, v38 offset:12480
    ds_write_b16_d16_hi v12, v38 offset:13520
    ds_write_b16 v12, v39 offset:14560
    ds_write_b16_d16_hi v12, v39 offset:15600
    ds_write_b16 v12, v40 offset:512
    ds_write_b16_d16_hi v12, v40 offset:1552
    ds_write_b16 v12, v41 offset:2592
    ds_write_b16_d16_hi v12, v41 offset:3632
    ds_write_b16 v12, v42 offset:4672
    ds_write_b16_d16_hi v12, v42 offset:5712
    ds_write_b16 v12, v43 offset:6752
    ds_write_b16_d16_hi v12, v43 offset:7792
    ds_write_b16 v12, v44 offset:8832
    ds_write_b16_d16_hi v12, v44 offset:9872
    ds_write_b16 v12, v45 offset:10912
    ds_write_b16_d16_hi v12, v45 offset:11952
    ds_write_b16 v12, v46 offset:12992
    ds_write_b16_d16_hi v12, v46 offset:14032
    ds_write_b16 v12, v47 offset:15072
    ds_write_b16_d16_hi v12, v47 offset:16112
    v_add_u32 v12, s30, v5
    v_mul_u32_u24 v12, 1040, v12
    v_lshl_add_u32 v12, v6, 4, v12
    s_waitcnt lgkmcnt(0)
    s_barrier
    ds_read_b128 v[32:35], v12 offset:0
    ds_read_b128 v[36:39], v12 offset:256
    ds_read_b128 v[40:43], v12 offset:512
    ds_read_b128 v[44:47], v12 offset:768
    s_waitcnt lgkmcnt(0)
    v_lshlrev_b32 v64, 16, v16
    v_and_b32 v65, 0xffff0000, v16
    v_lshlrev_b32 v66, 16, v17
    v_and_b32 v67, 0xffff0000, v17
    v_lshlrev_b32 v68, 16, v18
    v_and_b32 v69, 0xffff0000, v18
    v_lshlrev_b32 v70, 16, v19
    v_and_b32 v71, 0xffff0000, v19
    v_lshlrev_b32 v96, 16, v32
    v_and_b32 v97, 0xffff0000, v32
    v_lshlrev_b32 v98, 16, v33
    v_and_b32 v99, 0xffff0000, v33
    v_lshlrev_b32 v100, 16, v34
    v_and_b32 v101, 0xffff0000, v34
    v_lshlrev_b32 v102, 16, v35
    v_and_b32 v103, 0xffff0000, v35
    v_lshlrev_b32 v72, 16, v20
    v_and_b32 v73, 0xffff0000, v20
    v_lshlrev_b32 v74, 16, v21
    v_and_b32 v75, 0xffff0000, v21
    v_lshlrev_b32 v76, 16, v22
    v_and_b32 v77, 0xffff0000, v22
    v_lshlrev_b32 v78, 16, v23
    v_and_b32 v79, 0xffff0000, v23
    v_lshlrev_b32 v104, 16, v36
    v_and_b32 v105, 0xffff0000, v36
    v_lshlrev_b32 v106, 16, v37
    v_and_b32 v107, 0xffff0000, v37
    v_lshlrev_b32 v108, 16, v38
    v_and_b32 v109, 0xffff0000, v38
    v_lshlrev_b32 v110, 16, v39
    v_and_b32 v111, 0xffff0000, v39
    v_lshlrev_b32 v80, 16, v24
    v_and_b32 v81, 0xffff0000, v24
    v_lshlrev_b32 v82, 16, v25
    v_and_b32 v83, 0xffff0000, v25
    v_lshlrev_b32 v84, 16, v26
    v_and_b32 v85, 0xffff0000, v26
    v_lshlrev_b32 v86, 16, v27
    v_and_b32 v87, 0xffff0000, v27
    v_lshlrev_b32 v112, 16, v40
    v_and_b32 v113, 0xffff0000, v40
    v_lshlrev_b32 v114, 16, v41
    v_and_b32 v115, 0xffff0000, v41
    v_lshlrev_b32 v116, 16, v42
    v_and_b32 v117, 0xffff0000, v42
    v_lshlrev_b32 v118, 16, v43
    v_and_b32 v119, 0xffff0000, v43
    v_lshlrev_b32 v88, 16, v28
    v_and_b32 v89, 0xffff0000, v28
    v_lshlrev_b32 v90, 16, v29
    v_and_b32 v91, 0xffff0000, v29
    v_lshlrev_b32 v92, 16, v30
    v_and_b32 v93, 0xffff0000, v30
    v_lshlrev_b32 v94, 16, v31
    v_and_b32 v95, 0xffff0000, v31
    v_lshlrev_b32 v120, 16, v44
    v_and_b32 v121, 0xffff0000, v44
    v_lshlrev_b32 v122, 16, v45
    v_and_b32 v123, 0xffff0000, v45
    v_lshlrev_b32 v124, 16, v46
    v_and_b32 v125, 0xffff0000, v46
    v_lshlrev_b32 v126, 16, v47
    v_and_b32 v127, 0xffff0000, v47
    v_mov_b32 v60, 0
    v_mov_b32 v61, 0
    v_add_f32 v60, v60, v64
    v_fmac_f32 v61, v64, v64
    v_add_f32 v60, v60, v65
    v_fmac_f32 v61, v65, v65
    v_add_f32 v60, v60, v66
    v_fmac_f32 v61, v66, v66
    v_add_f32 v60, v60, v67
    v_fmac_f32 v61, v67, v67
    v_add_f32 v60, v60, v68
    v_fmac_f32 v61, v68, v68
    v_add_f32 v60, v60, v69
    v_fmac_f32 v61, v69, v69
    v_add_f32 v60, v60, v70
    v_fmac_f32 v61, v70, v70
    v_add_f32 v60, v60, v71
    v_fmac_f32 v61, v71, v71
    v_add_f32 v60, v60, v72
    v_fmac_f32 v61, v72, v72
    v_add_f32 v60, v60, v73
    v_fmac_f32 v61, v73, v73
    v_add_f32 v60, v60, v74
    v_fmac_f32 v61, v74, v74
    v_add_f32 v60, v60, v75
    v_fmac_f32 v61, v75, v75
    v_add_f32 v60, v60, v76
    v_fmac_f32 v61, v76, v76
    v_add_f32 v60, v60, v77
    v_fmac_f32 v61, v77, v77
    v_add_f32 v60, v60, v78
    v_fmac_f32 v61, v78, v78
    v_add_f32 v60, v60, v79
    v_fmac_f32 v61, v79, v79
    v_add_f32 v60, v60, v80
    v_fmac_f32 v61, v80, v80
    v_add_f32 v60, v60, v81
    v_fmac_f32 v61, v81, v81
    v_add_f32 v60, v60, v82
    v_fmac_f32 v61, v82, v82
    v_add_f32 v60, v60, v83
    v_fmac_f32 v61, v83, v83
    v_add_f32 v60, v60, v84
    v_fmac_f32 v61, v84, v84
    v_add_f32 v60, v60, v85
    v_fmac_f32 v61, v85, v85
    v_add_f32 v60, v60, v86
    v_fmac_f32 v61, v86, v86
    v_add_f32 v60, v60, v87
    v_fmac_f32 v61, v87, v87
    v_add_f32 v60, v60, v88
    v_fmac_f32 v61, v88, v88
    v_add_f32 v60, v60, v89
    v_fmac_f32 v61, v89, v89
    v_add_f32 v60, v60, v90
    v_fmac_f32 v61, v90, v90
    v_add_f32 v60, v60, v91
    v_fmac_f32 v61, v91, v91
    v_add_f32 v60, v60, v92
    v_fmac_f32 v61, v92, v92
    v_add_f32 v60, v60, v93
    v_fmac_f32 v61, v93, v93
    v_add_f32 v60, v60, v94
    v_fmac_f32 v61, v94, v94
    v_add_f32 v60, v60, v95
    v_fmac_f32 v61, v95, v95
    s_nop 1
    v_add_f32_dpp v60, v60, v60 row_ror:8 row_mask:0xf bank_mask:0xf
    s_nop 1
    v_add_f32_dpp v60, v60, v60 row_ror:4 row_mask:0xf bank_mask:0xf
    s_nop 1
    v_add_f32_dpp v60, v60, v60 row_ror:2 row_mask:0xf bank_mask:0xf
    s_nop 1
    v_add_f32_dpp v60, v60, v60 row_ror:1 row_mask:0xf bank_mask:0xf
    s_nop 1
    v_add_f32_dpp v61, v61, v61 row_ror:8 row_mask:0xf bank_mask:0xf
    s_nop 1
    v_add_f32_dpp v61, v61, v61 row_ror:4 row_mask:0xf bank_mask:0xf
    s_nop 1
    v_add_f32_dpp v61, v61, v61 row_ror:2 row_mask:0xf bank_mask:0xf
    s_nop 1
    v_add_f32_dpp v61, v61, v61 row_ror:1 row_mask:0xf bank_mask:0xf
    v_mul_f32 v60, 0x3b000000, v60
    v_mul_f32 v61, 0x3b000000, v61
    v_fma_f32 v61, -v60, v60, v61
    v_max_f32 v61, 0, v61
    v_cvt_pk_bf16_f32 v62, v60, v61
    v_lshlrev_b32 v60, 16, v62
    v_and_b32 v61, 0xffff0000, v62
    v_add_f32 v61, 0x3727c5ac, v61
    v_cvt_pk_bf16_f32 v62, v61, v61
    v_lshlrev_b32 v61, 16, v62
    v_and_b32 v61, 0xffff0000, v62
    v_sqrt_f32 v61, v61
    s_nop 0
    v_cvt_pk_bf16_f32 v62, v61, v61
    v_lshlrev_b32 v61, 16, v62
    v_and_b32 v61, 0xffff0000, v62
    v_rcp_f32 v61, v61
    s_nop 0
    v_sub_f32 v128, v64, v60
    v_sub_f32 v129, v65, v60
    v_cvt_pk_bf16_f32 v62, v128, v129
    v_lshlrev_b32 v128, 16, v62
    v_and_b32 v129, 0xffff0000, v62
    v_mul_f32 v128, v128, v61
    v_mul_f32 v129, v129, v61
    v_cvt_pk_bf16_f32 v62, v128, v129
    v_lshlrev_b32 v128, 16, v62
    v_and_b32 v129, 0xffff0000, v62
    v_sub_f32 v130, v66, v60
    v_sub_f32 v131, v67, v60
    v_cvt_pk_bf16_f32 v62, v130, v131
    v_lshlrev_b32 v130, 16, v62
    v_and_b32 v131, 0xffff0000, v62
    v_mul_f32 v130, v130, v61
    v_mul_f32 v131, v131, v61
    v_cvt_pk_bf16_f32 v62, v130, v131
    v_lshlrev_b32 v130, 16, v62
    v_and_b32 v131, 0xffff0000, v62
    v_sub_f32 v132, v68, v60
    v_sub_f32 v133, v69, v60
    v_cvt_pk_bf16_f32 v62, v132, v133
    v_lshlrev_b32 v132, 16, v62
    v_and_b32 v133, 0xffff0000, v62
    v_mul_f32 v132, v132, v61
    v_mul_f32 v133, v133, v61
    v_cvt_pk_bf16_f32 v62, v132, v133
    v_lshlrev_b32 v132, 16, v62
    v_and_b32 v133, 0xffff0000, v62
    v_sub_f32 v134, v70, v60
    v_sub_f32 v135, v71, v60
    v_cvt_pk_bf16_f32 v62, v134, v135
    v_lshlrev_b32 v134, 16, v62
    v_and_b32 v135, 0xffff0000, v62
    v_mul_f32 v134, v134, v61
    v_mul_f32 v135, v135, v61
    v_cvt_pk_bf16_f32 v62, v134, v135
    v_lshlrev_b32 v134, 16, v62
    v_and_b32 v135, 0xffff0000, v62
    v_sub_f32 v136, v72, v60
    v_sub_f32 v137, v73, v60
    v_cvt_pk_bf16_f32 v62, v136, v137
    v_lshlrev_b32 v136, 16, v62
    v_and_b32 v137, 0xffff0000, v62
    v_mul_f32 v136, v136, v61
    v_mul_f32 v137, v137, v61
    v_cvt_pk_bf16_f32 v62, v136, v137
    v_lshlrev_b32 v136, 16, v62
    v_and_b32 v137, 0xffff0000, v62
    v_sub_f32 v138, v74, v60
    v_sub_f32 v139, v75, v60
    v_cvt_pk_bf16_f32 v62, v138, v139
    v_lshlrev_b32 v138, 16, v62
    v_and_b32 v139, 0xffff0000, v62
    v_mul_f32 v138, v138, v61
    v_mul_f32 v139, v139, v61
    v_cvt_pk_bf16_f32 v62, v138, v139
    v_lshlrev_b32 v138, 16, v62
    v_and_b32 v139, 0xffff0000, v62
    v_sub_f32 v140, v76, v60
    v_sub_f32 v141, v77, v60
    v_cvt_pk_bf16_f32 v62, v140, v141
    v_lshlrev_b32 v140, 16, v62
    v_and_b32 v141, 0xffff0000, v62
    v_mul_f32 v140, v140, v61
    v_mul_f32 v141, v141, v61
    v_cvt_pk_bf16_f32 v62, v140, v141
    v_lshlrev_b32 v140, 16, v62
    v_and_b32 v141, 0xffff0000, v62
    v_sub_f32 v142, v78, v60
    v_sub_f32 v143, v79, v60
    v_cvt_pk_bf16_f32 v62, v142, v143
    v_lshlrev_b32 v142, 16, v62
    v_and_b32 v143, 0xffff0000, v62
    v_mul_f32 v142, v142, v61
    v_mul_f32 v143, v143, v61
    v_cvt_pk_bf16_f32 v62, v142, v143
    v_lshlrev_b32 v142, 16, v62
    v_and_b32 v143, 0xffff0000, v62
    v_sub_f32 v144, v80, v60
    v_sub_f32 v145, v81, v60
    v_cvt_pk_bf16_f32 v62, v144, v145
    v_lshlrev_b32 v144, 16, v62
    v_and_b32 v145, 0xffff0000, v62
    v_mul_f32 v144, v144, v61
    v_mul_f32 v145, v145, v61
    v_cvt_pk_bf16_f32 v62, v144, v145
    v_lshlrev_b32 v144, 16, v62
    v_and_b32 v145, 0xffff0000, v62
    v_sub_f32 v146, v82, v60
    v_sub_f32 v147, v83, v60
    v_cvt_pk_bf16_f32 v62, v146, v147
    v_lshlrev_b32 v146, 16, v62
    v_and_b32 v147, 0xffff0000, v62
    v_mul_f32 v146, v146, v61
    v_mul_f32 v147, v147, v61
    v_cvt_pk_bf16_f32 v62, v146, v147
    v_lshlrev_b32 v146, 16, v62
    v_and_b32 v147, 0xffff0000, v62
    v_sub_f32 v148, v84, v60
    v_sub_f32 v149, v85, v60
    v_cvt_pk_bf16_f32 v62, v148, v149
    v_lshlrev_b32 v148, 16, v62
    v_and_b32 v149, 0xffff0000, v62
    v_mul_f32 v148, v148, v61
    v_mul_f32 v149, v149, v61
    v_cvt_pk_bf16_f32 v62, v148, v149
    v_lshlrev_b32 v148, 16, v62
    v_and_b32 v149, 0xffff0000, v62
    v_sub_f32 v150, v86, v60
    v_sub_f32 v151, v87, v60
    v_cvt_pk_bf16_f32 v62, v150, v151
    v_lshlrev_b32 v150, 16, v62
    v_and_b32 v151, 0xffff0000, v62
    v_mul_f32 v150, v150, v61
    v_mul_f32 v151, v151, v61
    v_cvt_pk_bf16_f32 v62, v150, v151
    v_lshlrev_b32 v150, 16, v62
    v_and_b32 v151, 0xffff0000, v62
    v_sub_f32 v152, v88, v60
    v_sub_f32 v153, v89, v60
    v_cvt_pk_bf16_f32 v62, v152, v153
    v_lshlrev_b32 v152, 16, v62
    v_and_b32 v153, 0xffff0000, v62
    v_mul_f32 v152, v152, v61
    v_mul_f32 v153, v153, v61
    v_cvt_pk_bf16_f32 v62, v152, v153
    v_lshlrev_b32 v152, 16, v62
    v_and_b32 v153, 0xffff0000, v62
    v_sub_f32 v154, v90, v60
    v_sub_f32 v155, v91, v60
    v_cvt_pk_bf16_f32 v62, v154, v155
    v_lshlrev_b32 v154, 16, v62
    v_and_b32 v155, 0xffff0000, v62
    v_mul_f32 v154, v154, v61
    v_mul_f32 v155, v155, v61
    v_cvt_pk_bf16_f32 v62, v154, v155
    v_lshlrev_b32 v154, 16, v62
    v_and_b32 v155, 0xffff0000, v62
    v_sub_f32 v156, v92, v60
    v_sub_f32 v157, v93, v60
    v_cvt_pk_bf16_f32 v62, v156, v157
    v_lshlrev_b32 v156, 16, v62
    v_and_b32 v157, 0xffff0000, v62
    v_mul_f32 v156, v156, v61
    v_mul_f32 v157, v157, v61
    v_cvt_pk_bf16_f32 v62, v156, v157
    v_lshlrev_b32 v156, 16, v62
    v_and_b32 v157, 0xffff0000, v62
    v_sub_f32 v158, v94, v60
    v_sub_f32 v159, v95, v60
    v_cvt_pk_bf16_f32 v62, v158, v159
    v_lshlrev_b32 v158, 16, v62
    v_and_b32 v159, 0xffff0000, v62
    v_mul_f32 v158, v158, v61
    v_mul_f32 v159, v159, v61
    v_cvt_pk_bf16_f32 v62, v158, v159
    v_lshlrev_b32 v158, 16, v62
    v_and_b32 v159, 0xffff0000, v62
    v_mul_f32 v128, v128, v96
    v_mul_f32 v129, v129, v97
    v_cvt_pk_bf16_f32 v62, v128, v129
    v_lshlrev_b32 v128, 16, v62
    v_and_b32 v129, 0xffff0000, v62
    v_add_f32 v64, v64, v128
    v_add_f32 v65, v65, v129
    v_cvt_pk_bf16_f32 v16, v64, v65
    v_lshlrev_b32 v64, 16, v16
    v_and_b32 v65, 0xffff0000, v16
    v_mul_f32 v130, v130, v98
    v_mul_f32 v131, v131, v99
    v_cvt_pk_bf16_f32 v62, v130, v131
    v_lshlrev_b32 v130, 16, v62
    v_and_b32 v131, 0xffff0000, v62
    v_add_f32 v66, v66, v130
    v_add_f32 v67, v67, v131
    v_cvt_pk_bf16_f32 v17, v66, v67
    v_lshlrev_b32 v66, 16, v17
    v_and_b32 v67, 0xffff0000, v17
    v_mul_f32 v132, v132, v100
    v_mul_f32 v133, v133, v101
    v_cvt_pk_bf16_f32 v62, v132, v133
    v_lshlrev_b32 v132, 16, v62
    v_and_b32 v133, 0xffff0000, v62
    v_add_f32 v68, v68, v132
    v_add_f32 v69, v69, v133
    v_cvt_pk_bf16_f32 v18, v68, v69
    v_lshlrev_b32 v68, 16, v18
    v_and_b32 v69, 0xffff0000, v18
    v_mul_f32 v134, v134, v102
    v_mul_f32 v135, v135, v103
    v_cvt_pk_bf16_f32 v62, v134, v135
    v_lshlrev_b32 v134, 16, v62
    v_and_b32 v135, 0xffff0000, v62
    v_add_f32 v70, v70, v134
    v_add_f32 v71, v71, v135
    v_cvt_pk_bf16_f32 v19, v70, v71
    v_lshlrev_b32 v70, 16, v19
    v_and_b32 v71, 0xffff0000, v19
    v_mul_f32 v136, v136, v104
    v_mul_f32 v137, v137, v105
    v_cvt_pk_bf16_f32 v62, v136, v137
    v_lshlrev_b32 v136, 16, v62
    v_and_b32 v137, 0xffff0000, v62
    v_add_f32 v72, v72, v136
    v_add_f32 v73, v73, v137
    v_cvt_pk_bf16_f32 v20, v72, v73
    v_lshlrev_b32 v72, 16, v20
    v_and_b32 v73, 0xffff0000, v20
    v_mul_f32 v138, v138, v106
    v_mul_f32 v139, v139, v107
    v_cvt_pk_bf16_f32 v62, v138, v139
    v_lshlrev_b32 v138, 16, v62
    v_and_b32 v139, 0xffff0000, v62
    v_add_f32 v74, v74, v138
    v_add_f32 v75, v75, v139
    v_cvt_pk_bf16_f32 v21, v74, v75
    v_lshlrev_b32 v74, 16, v21
    v_and_b32 v75, 0xffff0000, v21
    v_mul_f32 v140, v140, v108
    v_mul_f32 v141, v141, v109
    v_cvt_pk_bf16_f32 v62, v140, v141
    v_lshlrev_b32 v140, 16, v62
    v_and_b32 v141, 0xffff0000, v62
    v_add_f32 v76, v76, v140
    v_add_f32 v77, v77, v141
    v_cvt_pk_bf16_f32 v22, v76, v77
    v_lshlrev_b32 v76, 16, v22
    v_and_b32 v77, 0xffff0000, v22
    v_mul_f32 v142, v142, v110
    v_mul_f32 v143, v143, v111
    v_cvt_pk_bf16_f32 v62, v142, v143
    v_lshlrev_b32 v142, 16, v62
    v_and_b32 v143, 0xffff0000, v62
    v_add_f32 v78, v78, v142
    v_add_f32 v79, v79, v143
    v_cvt_pk_bf16_f32 v23, v78, v79
    v_lshlrev_b32 v78, 16, v23
    v_and_b32 v79, 0xffff0000, v23
    v_mul_f32 v144, v144, v112
    v_mul_f32 v145, v145, v113
    v_cvt_pk_bf16_f32 v62, v144, v145
    v_lshlrev_b32 v144, 16, v62
    v_and_b32 v145, 0xffff0000, v62
    v_add_f32 v80, v80, v144
    v_add_f32 v81, v81, v145
    v_cvt_pk_bf16_f32 v24, v80, v81
    v_lshlrev_b32 v80, 16, v24
    v_and_b32 v81, 0xffff0000, v24
    v_mul_f32 v146, v146, v114
    v_mul_f32 v147, v147, v115
    v_cvt_pk_bf16_f32 v62, v146, v147
    v_lshlrev_b32 v146, 16, v62
    v_and_b32 v147, 0xffff0000, v62
    v_add_f32 v82, v82, v146
    v_add_f32 v83, v83, v147
    v_cvt_pk_bf16_f32 v25, v82, v83
    v_lshlrev_b32 v82, 16, v25
    v_and_b32 v83, 0xffff0000, v25
    v_mul_f32 v148, v148, v116
    v_mul_f32 v149, v149, v117
    v_cvt_pk_bf16_f32 v62, v148, v149
    v_lshlrev_b32 v148, 16, v62
    v_and_b32 v149, 0xffff0000, v62
    v_add_f32 v84, v84, v148
    v_add_f32 v85, v85, v149
    v_cvt_pk_bf16_f32 v26, v84, v85
    v_lshlrev_b32 v84, 16, v26
    v_and_b32 v85, 0xffff0000, v26
    v_mul_f32 v150, v150, v118
    v_mul_f32 v151, v151, v119
    v_cvt_pk_bf16_f32 v62, v150, v151
    v_lshlrev_b32 v150, 16, v62
    v_and_b32 v151, 0xffff0000, v62
    v_add_f32 v86, v86, v150
    v_add_f32 v87, v87, v151
    v_cvt_pk_bf16_f32 v27, v86, v87
    v_lshlrev_b32 v86, 16, v27
    v_and_b32 v87, 0xffff0000, v27
    v_mul_f32 v152, v152, v120
    v_mul_f32 v153, v153, v121
    v_cvt_pk_bf16_f32 v62, v152, v153
    v_lshlrev_b32 v152, 16, v62
    v_and_b32 v153, 0xffff0000, v62
    v_add_f32 v88, v88, v152
    v_add_f32 v89, v89, v153
    v_cvt_pk_bf16_f32 v28, v88, v89
    v_lshlrev_b32 v88, 16, v28
    v_and_b32 v89, 0xffff0000, v28
    v_mul_f32 v154, v154, v122
    v_mul_f32 v155, v155, v123
    v_cvt_pk_bf16_f32 v62, v154, v155
    v_lshlrev_b32 v154, 16, v62
    v_and_b32 v155, 0xffff0000, v62
    v_add_f32 v90, v90, v154
    v_add_f32 v91, v91, v155
    v_cvt_pk_bf16_f32 v29, v90, v91
    v_lshlrev_b32 v90, 16, v29
    v_and_b32 v91, 0xffff0000, v29
    v_mul_f32 v156, v156, v124
    v_mul_f32 v157, v157, v125
    v_cvt_pk_bf16_f32 v62, v156, v157
    v_lshlrev_b32 v156, 16, v62
    v_and_b32 v157, 0xffff0000, v62
    v_add_f32 v92, v92, v156
    v_add_f32 v93, v93, v157
    v_cvt_pk_bf16_f32 v30, v92, v93
    v_lshlrev_b32 v92, 16, v30
    v_and_b32 v93, 0xffff0000, v30
    v_mul_f32 v158, v158, v126
    v_mul_f32 v159, v159, v127
    v_cvt_pk_bf16_f32 v62, v158, v159
    v_lshlrev_b32 v158, 16, v62
    v_and_b32 v159, 0xffff0000, v62
    v_add_f32 v94, v94, v158
    v_add_f32 v95, v95, v159
    v_cvt_pk_bf16_f32 v31, v94, v95
    v_lshlrev_b32 v94, 16, v31
    v_and_b32 v95, 0xffff0000, v31
    buffer_store_dwordx4 v[16:19], v10, s[20:23], 0 offen offset:0
    buffer_store_dwordx4 v[20:23], v10, s[20:23], 0 offen offset:256
    buffer_store_dwordx4 v[24:27], v10, s[20:23], 0 offen offset:512
    buffer_store_dwordx4 v[28:31], v10, s[20:23], 0 offen offset:768
    v_mov_b32 v60, 0
    v_mov_b32 v61, 0
    v_add_f32 v60, v60, v64
    v_fmac_f32 v61, v64, v64
    v_add_f32 v60, v60, v65
    v_fmac_f32 v61, v65, v65
    v_add_f32 v60, v60, v66
    v_fmac_f32 v61, v66, v66
    v_add_f32 v60, v60, v67
    v_fmac_f32 v61, v67, v67
    v_add_f32 v60, v60, v68
    v_fmac_f32 v61, v68, v68
    v_add_f32 v60, v60, v69
    v_fmac_f32 v61, v69, v69
    v_add_f32 v60, v60, v70
    v_fmac_f32 v61, v70, v70
    v_add_f32 v60, v60, v71
    v_fmac_f32 v61, v71, v71
    v_add_f32 v60, v60, v72
    v_fmac_f32 v61, v72, v72
    v_add_f32 v60, v60, v73
    v_fmac_f32 v61, v73, v73
    v_add_f32 v60, v60, v74
    v_fmac_f32 v61, v74, v74
    v_add_f32 v60, v60, v75
    v_fmac_f32 v61, v75, v75
    v_add_f32 v60, v60, v76
    v_fmac_f32 v61, v76, v76
    v_add_f32 v60, v60, v77
    v_fmac_f32 v61, v77, v77
    v_add_f32 v60, v60, v78
    v_fmac_f32 v61, v78, v78
    v_add_f32 v60, v60, v79
    v_fmac_f32 v61, v79, v79
    v_add_f32 v60, v60, v80
    v_fmac_f32 v61, v80, v80
    v_add_f32 v60, v60, v81
    v_fmac_f32 v61, v81, v81
    v_add_f32 v60, v60, v82
    v_fmac_f32 v61, v82, v82
    v_add_f32 v60, v60, v83
    v_fmac_f32 v61, v83, v83
    v_add_f32 v60, v60, v84
    v_fmac_f32 v61, v84, v84
    v_add_f32 v60, v60, v85
    v_fmac_f32 v61, v85, v85
    v_add_f32 v60, v60, v86
    v_fmac_f32 v61, v86, v86
    v_add_f32 v60, v60, v87
    v_fmac_f32 v61, v87, v87
    v_add_f32 v60, v60, v88
    v_fmac_f32 v61, v88, v88
    v_add_f32 v60, v60, v89
    v_fmac_f32 v61, v89, v89
    v_add_f32 v60, v60, v90
    v_fmac_f32 v61, v90, v90
    v_add_f32 v60, v60, v91
    v_fmac_f32 v61, v91, v91
    v_add_f32 v60, v60, v92
    v_fmac_f32 v61, v92, v92
    v_add_f32 v60, v60, v93
    v_fmac_f32 v61, v93, v93
    v_add_f32 v60, v60, v94
    v_fmac_f32 v61, v94, v94
    v_add_f32 v60, v60, v95
    v_fmac_f32 v61, v95, v95
    s_nop 1
    v_add_f32_dpp v60, v60, v60 row_ror:8 row_mask:0xf bank_mask:0xf
    s_nop 1
    v_add_f32_dpp v60, v60, v60 row_ror:4 row_mask:0xf bank_mask:0xf
    s_nop 1
    v_add_f32_dpp v60, v60, v60 row_ror:2 row_mask:0xf bank_mask:0xf
    s_nop 1
    v_add_f32_dpp v60, v60, v60 row_ror:1 row_mask:0xf bank_mask:0xf
    s_nop 1
    v_add_f32_dpp v61, v61, v61 row_ror:8 row_mask:0xf bank_mask:0xf
    s_nop 1
    v_add_f32_dpp v61, v61, v61 row_ror:4 row_mask:0xf bank_mask:0xf
    s_nop 1
    v_add_f32_dpp v61, v61, v61 row_ror:2 row_mask:0xf bank_mask:0xf
    s_nop 1
    v_add_f32_dpp v61, v61, v61 row_ror:1 row_mask:0xf bank_mask:0xf
    v_mul_f32 v60, 0x3b000000, v60
    v_mul_f32 v61, 0x3b000000, v61
    v_fma_f32 v61, -v60, v60, v61
    v_max_f32 v61, 0, v61
    v_cvt_pk_bf16_f32 v62, v60, v61
    v_lshlrev_b32 v60, 16, v62
    v_and_b32 v61, 0xffff0000, v62
    v_add_f32 v61, 0x3727c5ac, v61
    v_cvt_pk_bf16_f32 v62, v61, v61
    v_lshlrev_b32 v61, 16, v62
    v_and_b32 v61, 0xffff0000, v62
    v_sqrt_f32 v61, v61
    s_nop 0
    v_cvt_pk_bf16_f32 v62, v61, v61
    v_lshlrev_b32 v61, 16, v62
    v_and_b32 v61, 0xffff0000, v62
    v_rcp_f32 v61, v61
    s_nop 0
    v_sub_f32 v128, v64, v60
    v_sub_f32 v129, v65, v60
    v_cvt_pk_bf16_f32 v62, v128, v129
    v_lshlrev_b32 v128, 16, v62
    v_and_b32 v129, 0xffff0000, v62
    v_mul_f32 v128, v128, v61
    v_mul_f32 v129, v129, v61
    v_cvt_pk_bf16_f32 v62, v128, v129
    v_lshlrev_b32 v128, 16, v62
    v_and_b32 v129, 0xffff0000, v62
    v_sub_f32 v130, v66, v60
    v_sub_f32 v131, v67, v60
    v_cvt_pk_bf16_f32 v62, v130, v131
    v_lshlrev_b32 v130, 16, v62
    v_and_b32 v131, 0xffff0000, v62
    v_mul_f32 v130, v130, v61
    v_mul_f32 v131, v131, v61
    v_cvt_pk_bf16_f32 v62, v130, v131
    v_lshlrev_b32 v130, 16, v62
    v_and_b32 v131, 0xffff0000, v62
    v_sub_f32 v132, v68, v60
    v_sub_f32 v133, v69, v60
    v_cvt_pk_bf16_f32 v62, v132, v133
    v_lshlrev_b32 v132, 16, v62
    v_and_b32 v133, 0xffff0000, v62
    v_mul_f32 v132, v132, v61
    v_mul_f32 v133, v133, v61
    v_cvt_pk_bf16_f32 v62, v132, v133
    v_lshlrev_b32 v132, 16, v62
    v_and_b32 v133, 0xffff0000, v62
    v_sub_f32 v134, v70, v60
    v_sub_f32 v135, v71, v60
    v_cvt_pk_bf16_f32 v62, v134, v135
    v_lshlrev_b32 v134, 16, v62
    v_and_b32 v135, 0xffff0000, v62
    v_mul_f32 v134, v134, v61
    v_mul_f32 v135, v135, v61
    v_cvt_pk_bf16_f32 v62, v134, v135
    v_lshlrev_b32 v134, 16, v62
    v_and_b32 v135, 0xffff0000, v62
    v_sub_f32 v136, v72, v60
    v_sub_f32 v137, v73, v60
    v_cvt_pk_bf16_f32 v62, v136, v137
    v_lshlrev_b32 v136, 16, v62
    v_and_b32 v137, 0xffff0000, v62
    v_mul_f32 v136, v136, v61
    v_mul_f32 v137, v137, v61
    v_cvt_pk_bf16_f32 v62, v136, v137
    v_lshlrev_b32 v136, 16, v62
    v_and_b32 v137, 0xffff0000, v62
    v_sub_f32 v138, v74, v60
    v_sub_f32 v139, v75, v60
    v_cvt_pk_bf16_f32 v62, v138, v139
    v_lshlrev_b32 v138, 16, v62
    v_and_b32 v139, 0xffff0000, v62
    v_mul_f32 v138, v138, v61
    v_mul_f32 v139, v139, v61
    v_cvt_pk_bf16_f32 v62, v138, v139
    v_lshlrev_b32 v138, 16, v62
    v_and_b32 v139, 0xffff0000, v62
    v_sub_f32 v140, v76, v60
    v_sub_f32 v141, v77, v60
    v_cvt_pk_bf16_f32 v62, v140, v141
    v_lshlrev_b32 v140, 16, v62
    v_and_b32 v141, 0xffff0000, v62
    v_mul_f32 v140, v140, v61
    v_mul_f32 v141, v141, v61
    v_cvt_pk_bf16_f32 v62, v140, v141
    v_lshlrev_b32 v140, 16, v62
    v_and_b32 v141, 0xffff0000, v62
    v_sub_f32 v142, v78, v60
    v_sub_f32 v143, v79, v60
    v_cvt_pk_bf16_f32 v62, v142, v143
    v_lshlrev_b32 v142, 16, v62
    v_and_b32 v143, 0xffff0000, v62
    v_mul_f32 v142, v142, v61
    v_mul_f32 v143, v143, v61
    v_cvt_pk_bf16_f32 v62, v142, v143
    v_lshlrev_b32 v142, 16, v62
    v_and_b32 v143, 0xffff0000, v62
    v_sub_f32 v144, v80, v60
    v_sub_f32 v145, v81, v60
    v_cvt_pk_bf16_f32 v62, v144, v145
    v_lshlrev_b32 v144, 16, v62
    v_and_b32 v145, 0xffff0000, v62
    v_mul_f32 v144, v144, v61
    v_mul_f32 v145, v145, v61
    v_cvt_pk_bf16_f32 v62, v144, v145
    v_lshlrev_b32 v144, 16, v62
    v_and_b32 v145, 0xffff0000, v62
    v_sub_f32 v146, v82, v60
    v_sub_f32 v147, v83, v60
    v_cvt_pk_bf16_f32 v62, v146, v147
    v_lshlrev_b32 v146, 16, v62
    v_and_b32 v147, 0xffff0000, v62
    v_mul_f32 v146, v146, v61
    v_mul_f32 v147, v147, v61
    v_cvt_pk_bf16_f32 v62, v146, v147
    v_lshlrev_b32 v146, 16, v62
    v_and_b32 v147, 0xffff0000, v62
    v_sub_f32 v148, v84, v60
    v_sub_f32 v149, v85, v60
    v_cvt_pk_bf16_f32 v62, v148, v149
    v_lshlrev_b32 v148, 16, v62
    v_and_b32 v149, 0xffff0000, v62
    v_mul_f32 v148, v148, v61
    v_mul_f32 v149, v149, v61
    v_cvt_pk_bf16_f32 v62, v148, v149
    v_lshlrev_b32 v148, 16, v62
    v_and_b32 v149, 0xffff0000, v62
    v_sub_f32 v150, v86, v60
    v_sub_f32 v151, v87, v60
    v_cvt_pk_bf16_f32 v62, v150, v151
    v_lshlrev_b32 v150, 16, v62
    v_and_b32 v151, 0xffff0000, v62
    v_mul_f32 v150, v150, v61
    v_mul_f32 v151, v151, v61
    v_cvt_pk_bf16_f32 v62, v150, v151
    v_lshlrev_b32 v150, 16, v62
    v_and_b32 v151, 0xffff0000, v62
    v_sub_f32 v152, v88, v60
    v_sub_f32 v153, v89, v60
    v_cvt_pk_bf16_f32 v62, v152, v153
    v_lshlrev_b32 v152, 16, v62
    v_and_b32 v153, 0xffff0000, v62
    v_mul_f32 v152, v152, v61
    v_mul_f32 v153, v153, v61
    v_cvt_pk_bf16_f32 v62, v152, v153
    v_lshlrev_b32 v152, 16, v62
    v_and_b32 v153, 0xffff0000, v62
    v_sub_f32 v154, v90, v60
    v_sub_f32 v155, v91, v60
    v_cvt_pk_bf16_f32 v62, v154, v155
    v_lshlrev_b32 v154, 16, v62
    v_and_b32 v155, 0xffff0000, v62
    v_mul_f32 v154, v154, v61
    v_mul_f32 v155, v155, v61
    v_cvt_pk_bf16_f32 v62, v154, v155
    v_lshlrev_b32 v154, 16, v62
    v_and_b32 v155, 0xffff0000, v62
    v_sub_f32 v156, v92, v60
    v_sub_f32 v157, v93, v60
    v_cvt_pk_bf16_f32 v62, v156, v157
    v_lshlrev_b32 v156, 16, v62
    v_and_b32 v157, 0xffff0000, v62
    v_mul_f32 v156, v156, v61
    v_mul_f32 v157, v157, v61
    v_cvt_pk_bf16_f32 v62, v156, v157
    v_lshlrev_b32 v156, 16, v62
    v_and_b32 v157, 0xffff0000, v62
    v_sub_f32 v158, v94, v60
    v_sub_f32 v159, v95, v60
    v_cvt_pk_bf16_f32 v62, v158, v159
    v_lshlrev_b32 v158, 16, v62
    v_and_b32 v159, 0xffff0000, v62
    v_mul_f32 v158, v158, v61
    v_mul_f32 v159, v159, v61
    v_cvt_pk_bf16_f32 v62, v158, v159
    v_lshlrev_b32 v158, 16, v62
    v_and_b32 v159, 0xffff0000, v62
    v_cvt_pk_bf16_f32 v32, v128, v129
    v_cvt_pk_bf16_f32 v33, v130, v131
    v_cvt_pk_bf16_f32 v34, v132, v133
    v_cvt_pk_bf16_f32 v35, v134, v135
    v_cvt_pk_bf16_f32 v36, v136, v137
    v_cvt_pk_bf16_f32 v37, v138, v139
    v_cvt_pk_bf16_f32 v38, v140, v141
    v_cvt_pk_bf16_f32 v39, v142, v143
    v_cvt_pk_bf16_f32 v40, v144, v145
    v_cvt_pk_bf16_f32 v41, v146, v147
    v_cvt_pk_bf16_f32 v42, v148, v149
    v_cvt_pk_bf16_f32 v43, v150, v151
    v_cvt_pk_bf16_f32 v44, v152, v153
    v_cvt_pk_bf16_f32 v45, v154, v155
    v_cvt_pk_bf16_f32 v46, v156, v157
    v_cvt_pk_bf16_f32 v47, v158, v159
    buffer_store_dwordx4 v[32:35], v11, s[20:23], 0 offen offset:0
    buffer_store_dwordx4 v[36:39], v13, s[20:23], 0 offen offset:0
    v_add_u32 v13, 4096, v13
    buffer_store_dwordx4 v[40:43], v13, s[20:23], 0 offen offset:0
    v_add_u32 v13, 4096, v13
    buffer_store_dwordx4 v[44:47], v13, s[20:23], 0 offen offset:0
    s_waitcnt vmcnt(0)
L_ln1_kernel_done:
    s_endpgm
.globl ln2_kernel
.p2align 8
.type ln2_kernel,@function
ln2_kernel:
    s_cmp_ge_u32 s2, 128
    s_cbranch_scc1 L_ln2_kernel_done
    s_load_dwordx2 s[4:5], s[0:1], 0
    s_load_dwordx2 s[8:9], s[0:1], 96
    s_waitcnt lgkmcnt(0)
    s_mov_b32 s20, s8
    s_mov_b32 s21, s9
    s_mov_b32 s22, 25165824
    s_mov_b32 s23, 0x00020000
    s_mov_b32 s12, s8
    s_mov_b32 s13, s9
    s_mov_b32 s14, 25165824
    s_mov_b32 s15, 0x00020000
    v_lshrrev_b32 v1, 6, v0
    s_nop 0
    v_readfirstlane_b32 s27, v1
    v_and_b32 v1, 63, v0
    v_lshrrev_b32 v5, 4, v1
    v_and_b32 v6, 15, v1
    s_lshl_b32 s29, s2, 4
    s_lshl_b32 s30, s27, 2
    s_add_u32 s29, s29, s30
    v_add_u32 v7, s29, v5
    v_lshlrev_b32 v7, 10, v7
    v_lshl_add_u32 v7, v6, 4, v7
    v_add_u32 v8, 6291456, v7
    v_add_u32 v9, 2097152, v7
    v_add_u32 v10, 8388608, v7
    v_lshrrev_b32 v11, 2, v6
    v_lshlrev_b32 v11, 6, v11
    v_and_b32 v12, 3, v6
    v_lshl_add_u32 v11, v12, 4, v11
    v_add_u32 v11, v5, v11
    v_add_u32 v11, s30, v11
    v_lshlrev_b32 v11, 4, v11
    s_lshl_b32 s29, s2, 14
    s_add_u32 s29, s29, 23068672
    v_add_u32 v11, s29, v11
    v_add_u32 v13, 4096, v11
    buffer_load_dwordx4 v[16:19], v8, s[12:15], 0 offen offset:0
    buffer_load_dwordx4 v[20:23], v8, s[12:15], 0 offen offset:256
    buffer_load_dwordx4 v[24:27], v8, s[12:15], 0 offen offset:512
    buffer_load_dwordx4 v[28:31], v8, s[12:15], 0 offen offset:768
    v_lshlrev_b32 v9, 12, v0
    s_lshl_b32 s29, s2, 5
    s_add_u32 s29, s29, 2097152
    v_add_u32 v9, s29, v9
    v_add_u32 v12, 0x100000, v9
    buffer_load_dwordx4 v[32:35], v9, s[20:23], 0 offen
    buffer_load_dwordx4 v[36:39], v9, s[20:23], 0 offen offset:16
    buffer_load_dwordx4 v[40:43], v12, s[20:23], 0 offen
    buffer_load_dwordx4 v[44:47], v12, s[20:23], 0 offen offset:16
    v_lshlrev_b32 v12, 1, v0
    s_waitcnt vmcnt(0)
    ds_write_b16 v12, v32 offset:0
    ds_write_b16_d16_hi v12, v32 offset:1040
    ds_write_b16 v12, v33 offset:2080
    ds_write_b16_d16_hi v12, v33 offset:3120
    ds_write_b16 v12, v34 offset:4160
    ds_write_b16_d16_hi v12, v34 offset:5200
    ds_write_b16 v12, v35 offset:6240
    ds_write_b16_d16_hi v12, v35 offset:7280
    ds_write_b16 v12, v36 offset:8320
    ds_write_b16_d16_hi v12, v36 offset:9360
    ds_write_b16 v12, v37 offset:10400
    ds_write_b16_d16_hi v12, v37 offset:11440
    ds_write_b16 v12, v38 offset:12480
    ds_write_b16_d16_hi v12, v38 offset:13520
    ds_write_b16 v12, v39 offset:14560
    ds_write_b16_d16_hi v12, v39 offset:15600
    ds_write_b16 v12, v40 offset:512
    ds_write_b16_d16_hi v12, v40 offset:1552
    ds_write_b16 v12, v41 offset:2592
    ds_write_b16_d16_hi v12, v41 offset:3632
    ds_write_b16 v12, v42 offset:4672
    ds_write_b16_d16_hi v12, v42 offset:5712
    ds_write_b16 v12, v43 offset:6752
    ds_write_b16_d16_hi v12, v43 offset:7792
    ds_write_b16 v12, v44 offset:8832
    ds_write_b16_d16_hi v12, v44 offset:9872
    ds_write_b16 v12, v45 offset:10912
    ds_write_b16_d16_hi v12, v45 offset:11952
    ds_write_b16 v12, v46 offset:12992
    ds_write_b16_d16_hi v12, v46 offset:14032
    ds_write_b16 v12, v47 offset:15072
    ds_write_b16_d16_hi v12, v47 offset:16112
    v_add_u32 v12, s30, v5
    v_mul_u32_u24 v12, 1040, v12
    v_lshl_add_u32 v12, v6, 4, v12
    s_waitcnt lgkmcnt(0)
    s_barrier
    ds_read_b128 v[32:35], v12 offset:0
    ds_read_b128 v[36:39], v12 offset:256
    ds_read_b128 v[40:43], v12 offset:512
    ds_read_b128 v[44:47], v12 offset:768
    s_waitcnt lgkmcnt(0)
    v_lshlrev_b32 v64, 16, v16
    v_and_b32 v65, 0xffff0000, v16
    v_lshlrev_b32 v66, 16, v17
    v_and_b32 v67, 0xffff0000, v17
    v_lshlrev_b32 v68, 16, v18
    v_and_b32 v69, 0xffff0000, v18
    v_lshlrev_b32 v70, 16, v19
    v_and_b32 v71, 0xffff0000, v19
    v_lshlrev_b32 v96, 16, v32
    v_and_b32 v97, 0xffff0000, v32
    v_lshlrev_b32 v98, 16, v33
    v_and_b32 v99, 0xffff0000, v33
    v_lshlrev_b32 v100, 16, v34
    v_and_b32 v101, 0xffff0000, v34
    v_lshlrev_b32 v102, 16, v35
    v_and_b32 v103, 0xffff0000, v35
    v_lshlrev_b32 v72, 16, v20
    v_and_b32 v73, 0xffff0000, v20
    v_lshlrev_b32 v74, 16, v21
    v_and_b32 v75, 0xffff0000, v21
    v_lshlrev_b32 v76, 16, v22
    v_and_b32 v77, 0xffff0000, v22
    v_lshlrev_b32 v78, 16, v23
    v_and_b32 v79, 0xffff0000, v23
    v_lshlrev_b32 v104, 16, v36
    v_and_b32 v105, 0xffff0000, v36
    v_lshlrev_b32 v106, 16, v37
    v_and_b32 v107, 0xffff0000, v37
    v_lshlrev_b32 v108, 16, v38
    v_and_b32 v109, 0xffff0000, v38
    v_lshlrev_b32 v110, 16, v39
    v_and_b32 v111, 0xffff0000, v39
    v_lshlrev_b32 v80, 16, v24
    v_and_b32 v81, 0xffff0000, v24
    v_lshlrev_b32 v82, 16, v25
    v_and_b32 v83, 0xffff0000, v25
    v_lshlrev_b32 v84, 16, v26
    v_and_b32 v85, 0xffff0000, v26
    v_lshlrev_b32 v86, 16, v27
    v_and_b32 v87, 0xffff0000, v27
    v_lshlrev_b32 v112, 16, v40
    v_and_b32 v113, 0xffff0000, v40
    v_lshlrev_b32 v114, 16, v41
    v_and_b32 v115, 0xffff0000, v41
    v_lshlrev_b32 v116, 16, v42
    v_and_b32 v117, 0xffff0000, v42
    v_lshlrev_b32 v118, 16, v43
    v_and_b32 v119, 0xffff0000, v43
    v_lshlrev_b32 v88, 16, v28
    v_and_b32 v89, 0xffff0000, v28
    v_lshlrev_b32 v90, 16, v29
    v_and_b32 v91, 0xffff0000, v29
    v_lshlrev_b32 v92, 16, v30
    v_and_b32 v93, 0xffff0000, v30
    v_lshlrev_b32 v94, 16, v31
    v_and_b32 v95, 0xffff0000, v31
    v_lshlrev_b32 v120, 16, v44
    v_and_b32 v121, 0xffff0000, v44
    v_lshlrev_b32 v122, 16, v45
    v_and_b32 v123, 0xffff0000, v45
    v_lshlrev_b32 v124, 16, v46
    v_and_b32 v125, 0xffff0000, v46
    v_lshlrev_b32 v126, 16, v47
    v_and_b32 v127, 0xffff0000, v47
    v_mov_b32 v60, 0
    v_mov_b32 v61, 0
    v_add_f32 v60, v60, v64
    v_fmac_f32 v61, v64, v64
    v_add_f32 v60, v60, v65
    v_fmac_f32 v61, v65, v65
    v_add_f32 v60, v60, v66
    v_fmac_f32 v61, v66, v66
    v_add_f32 v60, v60, v67
    v_fmac_f32 v61, v67, v67
    v_add_f32 v60, v60, v68
    v_fmac_f32 v61, v68, v68
    v_add_f32 v60, v60, v69
    v_fmac_f32 v61, v69, v69
    v_add_f32 v60, v60, v70
    v_fmac_f32 v61, v70, v70
    v_add_f32 v60, v60, v71
    v_fmac_f32 v61, v71, v71
    v_add_f32 v60, v60, v72
    v_fmac_f32 v61, v72, v72
    v_add_f32 v60, v60, v73
    v_fmac_f32 v61, v73, v73
    v_add_f32 v60, v60, v74
    v_fmac_f32 v61, v74, v74
    v_add_f32 v60, v60, v75
    v_fmac_f32 v61, v75, v75
    v_add_f32 v60, v60, v76
    v_fmac_f32 v61, v76, v76
    v_add_f32 v60, v60, v77
    v_fmac_f32 v61, v77, v77
    v_add_f32 v60, v60, v78
    v_fmac_f32 v61, v78, v78
    v_add_f32 v60, v60, v79
    v_fmac_f32 v61, v79, v79
    v_add_f32 v60, v60, v80
    v_fmac_f32 v61, v80, v80
    v_add_f32 v60, v60, v81
    v_fmac_f32 v61, v81, v81
    v_add_f32 v60, v60, v82
    v_fmac_f32 v61, v82, v82
    v_add_f32 v60, v60, v83
    v_fmac_f32 v61, v83, v83
    v_add_f32 v60, v60, v84
    v_fmac_f32 v61, v84, v84
    v_add_f32 v60, v60, v85
    v_fmac_f32 v61, v85, v85
    v_add_f32 v60, v60, v86
    v_fmac_f32 v61, v86, v86
    v_add_f32 v60, v60, v87
    v_fmac_f32 v61, v87, v87
    v_add_f32 v60, v60, v88
    v_fmac_f32 v61, v88, v88
    v_add_f32 v60, v60, v89
    v_fmac_f32 v61, v89, v89
    v_add_f32 v60, v60, v90
    v_fmac_f32 v61, v90, v90
    v_add_f32 v60, v60, v91
    v_fmac_f32 v61, v91, v91
    v_add_f32 v60, v60, v92
    v_fmac_f32 v61, v92, v92
    v_add_f32 v60, v60, v93
    v_fmac_f32 v61, v93, v93
    v_add_f32 v60, v60, v94
    v_fmac_f32 v61, v94, v94
    v_add_f32 v60, v60, v95
    v_fmac_f32 v61, v95, v95
    s_nop 1
    v_add_f32_dpp v60, v60, v60 row_ror:8 row_mask:0xf bank_mask:0xf
    s_nop 1
    v_add_f32_dpp v60, v60, v60 row_ror:4 row_mask:0xf bank_mask:0xf
    s_nop 1
    v_add_f32_dpp v60, v60, v60 row_ror:2 row_mask:0xf bank_mask:0xf
    s_nop 1
    v_add_f32_dpp v60, v60, v60 row_ror:1 row_mask:0xf bank_mask:0xf
    s_nop 1
    v_add_f32_dpp v61, v61, v61 row_ror:8 row_mask:0xf bank_mask:0xf
    s_nop 1
    v_add_f32_dpp v61, v61, v61 row_ror:4 row_mask:0xf bank_mask:0xf
    s_nop 1
    v_add_f32_dpp v61, v61, v61 row_ror:2 row_mask:0xf bank_mask:0xf
    s_nop 1
    v_add_f32_dpp v61, v61, v61 row_ror:1 row_mask:0xf bank_mask:0xf
    v_mul_f32 v60, 0x3b000000, v60
    v_mul_f32 v61, 0x3b000000, v61
    v_fma_f32 v61, -v60, v60, v61
    v_max_f32 v61, 0, v61
    v_cvt_pk_bf16_f32 v62, v60, v61
    v_lshlrev_b32 v60, 16, v62
    v_and_b32 v61, 0xffff0000, v62
    v_add_f32 v61, 0x3727c5ac, v61
    v_cvt_pk_bf16_f32 v62, v61, v61
    v_lshlrev_b32 v61, 16, v62
    v_and_b32 v61, 0xffff0000, v62
    v_sqrt_f32 v61, v61
    s_nop 0
    v_cvt_pk_bf16_f32 v62, v61, v61
    v_lshlrev_b32 v61, 16, v62
    v_and_b32 v61, 0xffff0000, v62
    v_rcp_f32 v61, v61
    s_nop 0
    v_sub_f32 v128, v64, v60
    v_sub_f32 v129, v65, v60
    v_cvt_pk_bf16_f32 v62, v128, v129
    v_lshlrev_b32 v128, 16, v62
    v_and_b32 v129, 0xffff0000, v62
    v_mul_f32 v128, v128, v61
    v_mul_f32 v129, v129, v61
    v_cvt_pk_bf16_f32 v62, v128, v129
    v_lshlrev_b32 v128, 16, v62
    v_and_b32 v129, 0xffff0000, v62
    v_sub_f32 v130, v66, v60
    v_sub_f32 v131, v67, v60
    v_cvt_pk_bf16_f32 v62, v130, v131
    v_lshlrev_b32 v130, 16, v62
    v_and_b32 v131, 0xffff0000, v62
    v_mul_f32 v130, v130, v61
    v_mul_f32 v131, v131, v61
    v_cvt_pk_bf16_f32 v62, v130, v131
    v_lshlrev_b32 v130, 16, v62
    v_and_b32 v131, 0xffff0000, v62
    v_sub_f32 v132, v68, v60
    v_sub_f32 v133, v69, v60
    v_cvt_pk_bf16_f32 v62, v132, v133
    v_lshlrev_b32 v132, 16, v62
    v_and_b32 v133, 0xffff0000, v62
    v_mul_f32 v132, v132, v61
    v_mul_f32 v133, v133, v61
    v_cvt_pk_bf16_f32 v62, v132, v133
    v_lshlrev_b32 v132, 16, v62
    v_and_b32 v133, 0xffff0000, v62
    v_sub_f32 v134, v70, v60
    v_sub_f32 v135, v71, v60
    v_cvt_pk_bf16_f32 v62, v134, v135
    v_lshlrev_b32 v134, 16, v62
    v_and_b32 v135, 0xffff0000, v62
    v_mul_f32 v134, v134, v61
    v_mul_f32 v135, v135, v61
    v_cvt_pk_bf16_f32 v62, v134, v135
    v_lshlrev_b32 v134, 16, v62
    v_and_b32 v135, 0xffff0000, v62
    v_sub_f32 v136, v72, v60
    v_sub_f32 v137, v73, v60
    v_cvt_pk_bf16_f32 v62, v136, v137
    v_lshlrev_b32 v136, 16, v62
    v_and_b32 v137, 0xffff0000, v62
    v_mul_f32 v136, v136, v61
    v_mul_f32 v137, v137, v61
    v_cvt_pk_bf16_f32 v62, v136, v137
    v_lshlrev_b32 v136, 16, v62
    v_and_b32 v137, 0xffff0000, v62
    v_sub_f32 v138, v74, v60
    v_sub_f32 v139, v75, v60
    v_cvt_pk_bf16_f32 v62, v138, v139
    v_lshlrev_b32 v138, 16, v62
    v_and_b32 v139, 0xffff0000, v62
    v_mul_f32 v138, v138, v61
    v_mul_f32 v139, v139, v61
    v_cvt_pk_bf16_f32 v62, v138, v139
    v_lshlrev_b32 v138, 16, v62
    v_and_b32 v139, 0xffff0000, v62
    v_sub_f32 v140, v76, v60
    v_sub_f32 v141, v77, v60
    v_cvt_pk_bf16_f32 v62, v140, v141
    v_lshlrev_b32 v140, 16, v62
    v_and_b32 v141, 0xffff0000, v62
    v_mul_f32 v140, v140, v61
    v_mul_f32 v141, v141, v61
    v_cvt_pk_bf16_f32 v62, v140, v141
    v_lshlrev_b32 v140, 16, v62
    v_and_b32 v141, 0xffff0000, v62
    v_sub_f32 v142, v78, v60
    v_sub_f32 v143, v79, v60
    v_cvt_pk_bf16_f32 v62, v142, v143
    v_lshlrev_b32 v142, 16, v62
    v_and_b32 v143, 0xffff0000, v62
    v_mul_f32 v142, v142, v61
    v_mul_f32 v143, v143, v61
    v_cvt_pk_bf16_f32 v62, v142, v143
    v_lshlrev_b32 v142, 16, v62
    v_and_b32 v143, 0xffff0000, v62
    v_sub_f32 v144, v80, v60
    v_sub_f32 v145, v81, v60
    v_cvt_pk_bf16_f32 v62, v144, v145
    v_lshlrev_b32 v144, 16, v62
    v_and_b32 v145, 0xffff0000, v62
    v_mul_f32 v144, v144, v61
    v_mul_f32 v145, v145, v61
    v_cvt_pk_bf16_f32 v62, v144, v145
    v_lshlrev_b32 v144, 16, v62
    v_and_b32 v145, 0xffff0000, v62
    v_sub_f32 v146, v82, v60
    v_sub_f32 v147, v83, v60
    v_cvt_pk_bf16_f32 v62, v146, v147
    v_lshlrev_b32 v146, 16, v62
    v_and_b32 v147, 0xffff0000, v62
    v_mul_f32 v146, v146, v61
    v_mul_f32 v147, v147, v61
    v_cvt_pk_bf16_f32 v62, v146, v147
    v_lshlrev_b32 v146, 16, v62
    v_and_b32 v147, 0xffff0000, v62
    v_sub_f32 v148, v84, v60
    v_sub_f32 v149, v85, v60
    v_cvt_pk_bf16_f32 v62, v148, v149
    v_lshlrev_b32 v148, 16, v62
    v_and_b32 v149, 0xffff0000, v62
    v_mul_f32 v148, v148, v61
    v_mul_f32 v149, v149, v61
    v_cvt_pk_bf16_f32 v62, v148, v149
    v_lshlrev_b32 v148, 16, v62
    v_and_b32 v149, 0xffff0000, v62
    v_sub_f32 v150, v86, v60
    v_sub_f32 v151, v87, v60
    v_cvt_pk_bf16_f32 v62, v150, v151
    v_lshlrev_b32 v150, 16, v62
    v_and_b32 v151, 0xffff0000, v62
    v_mul_f32 v150, v150, v61
    v_mul_f32 v151, v151, v61
    v_cvt_pk_bf16_f32 v62, v150, v151
    v_lshlrev_b32 v150, 16, v62
    v_and_b32 v151, 0xffff0000, v62
    v_sub_f32 v152, v88, v60
    v_sub_f32 v153, v89, v60
    v_cvt_pk_bf16_f32 v62, v152, v153
    v_lshlrev_b32 v152, 16, v62
    v_and_b32 v153, 0xffff0000, v62
    v_mul_f32 v152, v152, v61
    v_mul_f32 v153, v153, v61
    v_cvt_pk_bf16_f32 v62, v152, v153
    v_lshlrev_b32 v152, 16, v62
    v_and_b32 v153, 0xffff0000, v62
    v_sub_f32 v154, v90, v60
    v_sub_f32 v155, v91, v60
    v_cvt_pk_bf16_f32 v62, v154, v155
    v_lshlrev_b32 v154, 16, v62
    v_and_b32 v155, 0xffff0000, v62
    v_mul_f32 v154, v154, v61
    v_mul_f32 v155, v155, v61
    v_cvt_pk_bf16_f32 v62, v154, v155
    v_lshlrev_b32 v154, 16, v62
    v_and_b32 v155, 0xffff0000, v62
    v_sub_f32 v156, v92, v60
    v_sub_f32 v157, v93, v60
    v_cvt_pk_bf16_f32 v62, v156, v157
    v_lshlrev_b32 v156, 16, v62
    v_and_b32 v157, 0xffff0000, v62
    v_mul_f32 v156, v156, v61
    v_mul_f32 v157, v157, v61
    v_cvt_pk_bf16_f32 v62, v156, v157
    v_lshlrev_b32 v156, 16, v62
    v_and_b32 v157, 0xffff0000, v62
    v_sub_f32 v158, v94, v60
    v_sub_f32 v159, v95, v60
    v_cvt_pk_bf16_f32 v62, v158, v159
    v_lshlrev_b32 v158, 16, v62
    v_and_b32 v159, 0xffff0000, v62
    v_mul_f32 v158, v158, v61
    v_mul_f32 v159, v159, v61
    v_cvt_pk_bf16_f32 v62, v158, v159
    v_lshlrev_b32 v158, 16, v62
    v_and_b32 v159, 0xffff0000, v62
    v_mul_f32 v128, v128, v96
    v_mul_f32 v129, v129, v97
    v_cvt_pk_bf16_f32 v62, v128, v129
    v_lshlrev_b32 v128, 16, v62
    v_and_b32 v129, 0xffff0000, v62
    v_add_f32 v64, v64, v128
    v_add_f32 v65, v65, v129
    v_cvt_pk_bf16_f32 v16, v64, v65
    v_lshlrev_b32 v64, 16, v16
    v_and_b32 v65, 0xffff0000, v16
    v_mul_f32 v130, v130, v98
    v_mul_f32 v131, v131, v99
    v_cvt_pk_bf16_f32 v62, v130, v131
    v_lshlrev_b32 v130, 16, v62
    v_and_b32 v131, 0xffff0000, v62
    v_add_f32 v66, v66, v130
    v_add_f32 v67, v67, v131
    v_cvt_pk_bf16_f32 v17, v66, v67
    v_lshlrev_b32 v66, 16, v17
    v_and_b32 v67, 0xffff0000, v17
    v_mul_f32 v132, v132, v100
    v_mul_f32 v133, v133, v101
    v_cvt_pk_bf16_f32 v62, v132, v133
    v_lshlrev_b32 v132, 16, v62
    v_and_b32 v133, 0xffff0000, v62
    v_add_f32 v68, v68, v132
    v_add_f32 v69, v69, v133
    v_cvt_pk_bf16_f32 v18, v68, v69
    v_lshlrev_b32 v68, 16, v18
    v_and_b32 v69, 0xffff0000, v18
    v_mul_f32 v134, v134, v102
    v_mul_f32 v135, v135, v103
    v_cvt_pk_bf16_f32 v62, v134, v135
    v_lshlrev_b32 v134, 16, v62
    v_and_b32 v135, 0xffff0000, v62
    v_add_f32 v70, v70, v134
    v_add_f32 v71, v71, v135
    v_cvt_pk_bf16_f32 v19, v70, v71
    v_lshlrev_b32 v70, 16, v19
    v_and_b32 v71, 0xffff0000, v19
    v_mul_f32 v136, v136, v104
    v_mul_f32 v137, v137, v105
    v_cvt_pk_bf16_f32 v62, v136, v137
    v_lshlrev_b32 v136, 16, v62
    v_and_b32 v137, 0xffff0000, v62
    v_add_f32 v72, v72, v136
    v_add_f32 v73, v73, v137
    v_cvt_pk_bf16_f32 v20, v72, v73
    v_lshlrev_b32 v72, 16, v20
    v_and_b32 v73, 0xffff0000, v20
    v_mul_f32 v138, v138, v106
    v_mul_f32 v139, v139, v107
    v_cvt_pk_bf16_f32 v62, v138, v139
    v_lshlrev_b32 v138, 16, v62
    v_and_b32 v139, 0xffff0000, v62
    v_add_f32 v74, v74, v138
    v_add_f32 v75, v75, v139
    v_cvt_pk_bf16_f32 v21, v74, v75
    v_lshlrev_b32 v74, 16, v21
    v_and_b32 v75, 0xffff0000, v21
    v_mul_f32 v140, v140, v108
    v_mul_f32 v141, v141, v109
    v_cvt_pk_bf16_f32 v62, v140, v141
    v_lshlrev_b32 v140, 16, v62
    v_and_b32 v141, 0xffff0000, v62
    v_add_f32 v76, v76, v140
    v_add_f32 v77, v77, v141
    v_cvt_pk_bf16_f32 v22, v76, v77
    v_lshlrev_b32 v76, 16, v22
    v_and_b32 v77, 0xffff0000, v22
    v_mul_f32 v142, v142, v110
    v_mul_f32 v143, v143, v111
    v_cvt_pk_bf16_f32 v62, v142, v143
    v_lshlrev_b32 v142, 16, v62
    v_and_b32 v143, 0xffff0000, v62
    v_add_f32 v78, v78, v142
    v_add_f32 v79, v79, v143
    v_cvt_pk_bf16_f32 v23, v78, v79
    v_lshlrev_b32 v78, 16, v23
    v_and_b32 v79, 0xffff0000, v23
    v_mul_f32 v144, v144, v112
    v_mul_f32 v145, v145, v113
    v_cvt_pk_bf16_f32 v62, v144, v145
    v_lshlrev_b32 v144, 16, v62
    v_and_b32 v145, 0xffff0000, v62
    v_add_f32 v80, v80, v144
    v_add_f32 v81, v81, v145
    v_cvt_pk_bf16_f32 v24, v80, v81
    v_lshlrev_b32 v80, 16, v24
    v_and_b32 v81, 0xffff0000, v24
    v_mul_f32 v146, v146, v114
    v_mul_f32 v147, v147, v115
    v_cvt_pk_bf16_f32 v62, v146, v147
    v_lshlrev_b32 v146, 16, v62
    v_and_b32 v147, 0xffff0000, v62
    v_add_f32 v82, v82, v146
    v_add_f32 v83, v83, v147
    v_cvt_pk_bf16_f32 v25, v82, v83
    v_lshlrev_b32 v82, 16, v25
    v_and_b32 v83, 0xffff0000, v25
    v_mul_f32 v148, v148, v116
    v_mul_f32 v149, v149, v117
    v_cvt_pk_bf16_f32 v62, v148, v149
    v_lshlrev_b32 v148, 16, v62
    v_and_b32 v149, 0xffff0000, v62
    v_add_f32 v84, v84, v148
    v_add_f32 v85, v85, v149
    v_cvt_pk_bf16_f32 v26, v84, v85
    v_lshlrev_b32 v84, 16, v26
    v_and_b32 v85, 0xffff0000, v26
    v_mul_f32 v150, v150, v118
    v_mul_f32 v151, v151, v119
    v_cvt_pk_bf16_f32 v62, v150, v151
    v_lshlrev_b32 v150, 16, v62
    v_and_b32 v151, 0xffff0000, v62
    v_add_f32 v86, v86, v150
    v_add_f32 v87, v87, v151
    v_cvt_pk_bf16_f32 v27, v86, v87
    v_lshlrev_b32 v86, 16, v27
    v_and_b32 v87, 0xffff0000, v27
    v_mul_f32 v152, v152, v120
    v_mul_f32 v153, v153, v121
    v_cvt_pk_bf16_f32 v62, v152, v153
    v_lshlrev_b32 v152, 16, v62
    v_and_b32 v153, 0xffff0000, v62
    v_add_f32 v88, v88, v152
    v_add_f32 v89, v89, v153
    v_cvt_pk_bf16_f32 v28, v88, v89
    v_lshlrev_b32 v88, 16, v28
    v_and_b32 v89, 0xffff0000, v28
    v_mul_f32 v154, v154, v122
    v_mul_f32 v155, v155, v123
    v_cvt_pk_bf16_f32 v62, v154, v155
    v_lshlrev_b32 v154, 16, v62
    v_and_b32 v155, 0xffff0000, v62
    v_add_f32 v90, v90, v154
    v_add_f32 v91, v91, v155
    v_cvt_pk_bf16_f32 v29, v90, v91
    v_lshlrev_b32 v90, 16, v29
    v_and_b32 v91, 0xffff0000, v29
    v_mul_f32 v156, v156, v124
    v_mul_f32 v157, v157, v125
    v_cvt_pk_bf16_f32 v62, v156, v157
    v_lshlrev_b32 v156, 16, v62
    v_and_b32 v157, 0xffff0000, v62
    v_add_f32 v92, v92, v156
    v_add_f32 v93, v93, v157
    v_cvt_pk_bf16_f32 v30, v92, v93
    v_lshlrev_b32 v92, 16, v30
    v_and_b32 v93, 0xffff0000, v30
    v_mul_f32 v158, v158, v126
    v_mul_f32 v159, v159, v127
    v_cvt_pk_bf16_f32 v62, v158, v159
    v_lshlrev_b32 v158, 16, v62
    v_and_b32 v159, 0xffff0000, v62
    v_add_f32 v94, v94, v158
    v_add_f32 v95, v95, v159
    v_cvt_pk_bf16_f32 v31, v94, v95
    v_lshlrev_b32 v94, 16, v31
    v_and_b32 v95, 0xffff0000, v31
    buffer_store_dwordx4 v[16:19], v10, s[20:23], 0 offen offset:0
    buffer_store_dwordx4 v[20:23], v10, s[20:23], 0 offen offset:256
    buffer_store_dwordx4 v[24:27], v10, s[20:23], 0 offen offset:512
    buffer_store_dwordx4 v[28:31], v10, s[20:23], 0 offen offset:768
    v_mov_b32 v60, 0
    v_mov_b32 v61, 0
    v_add_f32 v60, v60, v64
    v_fmac_f32 v61, v64, v64
    v_add_f32 v60, v60, v65
    v_fmac_f32 v61, v65, v65
    v_add_f32 v60, v60, v66
    v_fmac_f32 v61, v66, v66
    v_add_f32 v60, v60, v67
    v_fmac_f32 v61, v67, v67
    v_add_f32 v60, v60, v68
    v_fmac_f32 v61, v68, v68
    v_add_f32 v60, v60, v69
    v_fmac_f32 v61, v69, v69
    v_add_f32 v60, v60, v70
    v_fmac_f32 v61, v70, v70
    v_add_f32 v60, v60, v71
    v_fmac_f32 v61, v71, v71
    v_add_f32 v60, v60, v72
    v_fmac_f32 v61, v72, v72
    v_add_f32 v60, v60, v73
    v_fmac_f32 v61, v73, v73
    v_add_f32 v60, v60, v74
    v_fmac_f32 v61, v74, v74
    v_add_f32 v60, v60, v75
    v_fmac_f32 v61, v75, v75
    v_add_f32 v60, v60, v76
    v_fmac_f32 v61, v76, v76
    v_add_f32 v60, v60, v77
    v_fmac_f32 v61, v77, v77
    v_add_f32 v60, v60, v78
    v_fmac_f32 v61, v78, v78
    v_add_f32 v60, v60, v79
    v_fmac_f32 v61, v79, v79
    v_add_f32 v60, v60, v80
    v_fmac_f32 v61, v80, v80
    v_add_f32 v60, v60, v81
    v_fmac_f32 v61, v81, v81
    v_add_f32 v60, v60, v82
    v_fmac_f32 v61, v82, v82
    v_add_f32 v60, v60, v83
    v_fmac_f32 v61, v83, v83
    v_add_f32 v60, v60, v84
    v_fmac_f32 v61, v84, v84
    v_add_f32 v60, v60, v85
    v_fmac_f32 v61, v85, v85
    v_add_f32 v60, v60, v86
    v_fmac_f32 v61, v86, v86
    v_add_f32 v60, v60, v87
    v_fmac_f32 v61, v87, v87
    v_add_f32 v60, v60, v88
    v_fmac_f32 v61, v88, v88
    v_add_f32 v60, v60, v89
    v_fmac_f32 v61, v89, v89
    v_add_f32 v60, v60, v90
    v_fmac_f32 v61, v90, v90
    v_add_f32 v60, v60, v91
    v_fmac_f32 v61, v91, v91
    v_add_f32 v60, v60, v92
    v_fmac_f32 v61, v92, v92
    v_add_f32 v60, v60, v93
    v_fmac_f32 v61, v93, v93
    v_add_f32 v60, v60, v94
    v_fmac_f32 v61, v94, v94
    v_add_f32 v60, v60, v95
    v_fmac_f32 v61, v95, v95
    s_nop 1
    v_add_f32_dpp v60, v60, v60 row_ror:8 row_mask:0xf bank_mask:0xf
    s_nop 1
    v_add_f32_dpp v60, v60, v60 row_ror:4 row_mask:0xf bank_mask:0xf
    s_nop 1
    v_add_f32_dpp v60, v60, v60 row_ror:2 row_mask:0xf bank_mask:0xf
    s_nop 1
    v_add_f32_dpp v60, v60, v60 row_ror:1 row_mask:0xf bank_mask:0xf
    s_nop 1
    v_add_f32_dpp v61, v61, v61 row_ror:8 row_mask:0xf bank_mask:0xf
    s_nop 1
    v_add_f32_dpp v61, v61, v61 row_ror:4 row_mask:0xf bank_mask:0xf
    s_nop 1
    v_add_f32_dpp v61, v61, v61 row_ror:2 row_mask:0xf bank_mask:0xf
    s_nop 1
    v_add_f32_dpp v61, v61, v61 row_ror:1 row_mask:0xf bank_mask:0xf
    v_mul_f32 v60, 0x3b000000, v60
    v_mul_f32 v61, 0x3b000000, v61
    v_fma_f32 v61, -v60, v60, v61
    v_max_f32 v61, 0, v61
    v_cvt_pk_bf16_f32 v62, v60, v61
    v_lshlrev_b32 v60, 16, v62
    v_and_b32 v61, 0xffff0000, v62
    v_add_f32 v61, 0x3727c5ac, v61
    v_cvt_pk_bf16_f32 v62, v61, v61
    v_lshlrev_b32 v61, 16, v62
    v_and_b32 v61, 0xffff0000, v62
    v_sqrt_f32 v61, v61
    s_nop 0
    v_cvt_pk_bf16_f32 v62, v61, v61
    v_lshlrev_b32 v61, 16, v62
    v_and_b32 v61, 0xffff0000, v62
    v_rcp_f32 v61, v61
    s_nop 0
    v_sub_f32 v128, v64, v60
    v_sub_f32 v129, v65, v60
    v_cvt_pk_bf16_f32 v62, v128, v129
    v_lshlrev_b32 v128, 16, v62
    v_and_b32 v129, 0xffff0000, v62
    v_mul_f32 v128, v128, v61
    v_mul_f32 v129, v129, v61
    v_cvt_pk_bf16_f32 v62, v128, v129
    v_lshlrev_b32 v128, 16, v62
    v_and_b32 v129, 0xffff0000, v62
    v_sub_f32 v130, v66, v60
    v_sub_f32 v131, v67, v60
    v_cvt_pk_bf16_f32 v62, v130, v131
    v_lshlrev_b32 v130, 16, v62
    v_and_b32 v131, 0xffff0000, v62
    v_mul_f32 v130, v130, v61
    v_mul_f32 v131, v131, v61
    v_cvt_pk_bf16_f32 v62, v130, v131
    v_lshlrev_b32 v130, 16, v62
    v_and_b32 v131, 0xffff0000, v62
    v_sub_f32 v132, v68, v60
    v_sub_f32 v133, v69, v60
    v_cvt_pk_bf16_f32 v62, v132, v133
    v_lshlrev_b32 v132, 16, v62
    v_and_b32 v133, 0xffff0000, v62
    v_mul_f32 v132, v132, v61
    v_mul_f32 v133, v133, v61
    v_cvt_pk_bf16_f32 v62, v132, v133
    v_lshlrev_b32 v132, 16, v62
    v_and_b32 v133, 0xffff0000, v62
    v_sub_f32 v134, v70, v60
    v_sub_f32 v135, v71, v60
    v_cvt_pk_bf16_f32 v62, v134, v135
    v_lshlrev_b32 v134, 16, v62
    v_and_b32 v135, 0xffff0000, v62
    v_mul_f32 v134, v134, v61
    v_mul_f32 v135, v135, v61
    v_cvt_pk_bf16_f32 v62, v134, v135
    v_lshlrev_b32 v134, 16, v62
    v_and_b32 v135, 0xffff0000, v62
    v_sub_f32 v136, v72, v60
    v_sub_f32 v137, v73, v60
    v_cvt_pk_bf16_f32 v62, v136, v137
    v_lshlrev_b32 v136, 16, v62
    v_and_b32 v137, 0xffff0000, v62
    v_mul_f32 v136, v136, v61
    v_mul_f32 v137, v137, v61
    v_cvt_pk_bf16_f32 v62, v136, v137
    v_lshlrev_b32 v136, 16, v62
    v_and_b32 v137, 0xffff0000, v62
    v_sub_f32 v138, v74, v60
    v_sub_f32 v139, v75, v60
    v_cvt_pk_bf16_f32 v62, v138, v139
    v_lshlrev_b32 v138, 16, v62
    v_and_b32 v139, 0xffff0000, v62
    v_mul_f32 v138, v138, v61
    v_mul_f32 v139, v139, v61
    v_cvt_pk_bf16_f32 v62, v138, v139
    v_lshlrev_b32 v138, 16, v62
    v_and_b32 v139, 0xffff0000, v62
    v_sub_f32 v140, v76, v60
    v_sub_f32 v141, v77, v60
    v_cvt_pk_bf16_f32 v62, v140, v141
    v_lshlrev_b32 v140, 16, v62
    v_and_b32 v141, 0xffff0000, v62
    v_mul_f32 v140, v140, v61
    v_mul_f32 v141, v141, v61
    v_cvt_pk_bf16_f32 v62, v140, v141
    v_lshlrev_b32 v140, 16, v62
    v_and_b32 v141, 0xffff0000, v62
    v_sub_f32 v142, v78, v60
    v_sub_f32 v143, v79, v60
    v_cvt_pk_bf16_f32 v62, v142, v143
    v_lshlrev_b32 v142, 16, v62
    v_and_b32 v143, 0xffff0000, v62
    v_mul_f32 v142, v142, v61
    v_mul_f32 v143, v143, v61
    v_cvt_pk_bf16_f32 v62, v142, v143
    v_lshlrev_b32 v142, 16, v62
    v_and_b32 v143, 0xffff0000, v62
    v_sub_f32 v144, v80, v60
    v_sub_f32 v145, v81, v60
    v_cvt_pk_bf16_f32 v62, v144, v145
    v_lshlrev_b32 v144, 16, v62
    v_and_b32 v145, 0xffff0000, v62
    v_mul_f32 v144, v144, v61
    v_mul_f32 v145, v145, v61
    v_cvt_pk_bf16_f32 v62, v144, v145
    v_lshlrev_b32 v144, 16, v62
    v_and_b32 v145, 0xffff0000, v62
    v_sub_f32 v146, v82, v60
    v_sub_f32 v147, v83, v60
    v_cvt_pk_bf16_f32 v62, v146, v147
    v_lshlrev_b32 v146, 16, v62
    v_and_b32 v147, 0xffff0000, v62
    v_mul_f32 v146, v146, v61
    v_mul_f32 v147, v147, v61
    v_cvt_pk_bf16_f32 v62, v146, v147
    v_lshlrev_b32 v146, 16, v62
    v_and_b32 v147, 0xffff0000, v62
    v_sub_f32 v148, v84, v60
    v_sub_f32 v149, v85, v60
    v_cvt_pk_bf16_f32 v62, v148, v149
    v_lshlrev_b32 v148, 16, v62
    v_and_b32 v149, 0xffff0000, v62
    v_mul_f32 v148, v148, v61
    v_mul_f32 v149, v149, v61
    v_cvt_pk_bf16_f32 v62, v148, v149
    v_lshlrev_b32 v148, 16, v62
    v_and_b32 v149, 0xffff0000, v62
    v_sub_f32 v150, v86, v60
    v_sub_f32 v151, v87, v60
    v_cvt_pk_bf16_f32 v62, v150, v151
    v_lshlrev_b32 v150, 16, v62
    v_and_b32 v151, 0xffff0000, v62
    v_mul_f32 v150, v150, v61
    v_mul_f32 v151, v151, v61
    v_cvt_pk_bf16_f32 v62, v150, v151
    v_lshlrev_b32 v150, 16, v62
    v_and_b32 v151, 0xffff0000, v62
    v_sub_f32 v152, v88, v60
    v_sub_f32 v153, v89, v60
    v_cvt_pk_bf16_f32 v62, v152, v153
    v_lshlrev_b32 v152, 16, v62
    v_and_b32 v153, 0xffff0000, v62
    v_mul_f32 v152, v152, v61
    v_mul_f32 v153, v153, v61
    v_cvt_pk_bf16_f32 v62, v152, v153
    v_lshlrev_b32 v152, 16, v62
    v_and_b32 v153, 0xffff0000, v62
    v_sub_f32 v154, v90, v60
    v_sub_f32 v155, v91, v60
    v_cvt_pk_bf16_f32 v62, v154, v155
    v_lshlrev_b32 v154, 16, v62
    v_and_b32 v155, 0xffff0000, v62
    v_mul_f32 v154, v154, v61
    v_mul_f32 v155, v155, v61
    v_cvt_pk_bf16_f32 v62, v154, v155
    v_lshlrev_b32 v154, 16, v62
    v_and_b32 v155, 0xffff0000, v62
    v_sub_f32 v156, v92, v60
    v_sub_f32 v157, v93, v60
    v_cvt_pk_bf16_f32 v62, v156, v157
    v_lshlrev_b32 v156, 16, v62
    v_and_b32 v157, 0xffff0000, v62
    v_mul_f32 v156, v156, v61
    v_mul_f32 v157, v157, v61
    v_cvt_pk_bf16_f32 v62, v156, v157
    v_lshlrev_b32 v156, 16, v62
    v_and_b32 v157, 0xffff0000, v62
    v_sub_f32 v158, v94, v60
    v_sub_f32 v159, v95, v60
    v_cvt_pk_bf16_f32 v62, v158, v159
    v_lshlrev_b32 v158, 16, v62
    v_and_b32 v159, 0xffff0000, v62
    v_mul_f32 v158, v158, v61
    v_mul_f32 v159, v159, v61
    v_cvt_pk_bf16_f32 v62, v158, v159
    v_lshlrev_b32 v158, 16, v62
    v_and_b32 v159, 0xffff0000, v62
    v_cvt_pk_bf16_f32 v32, v128, v129
    v_cvt_pk_bf16_f32 v33, v130, v131
    v_cvt_pk_bf16_f32 v34, v132, v133
    v_cvt_pk_bf16_f32 v35, v134, v135
    v_cvt_pk_bf16_f32 v36, v136, v137
    v_cvt_pk_bf16_f32 v37, v138, v139
    v_cvt_pk_bf16_f32 v38, v140, v141
    v_cvt_pk_bf16_f32 v39, v142, v143
    v_cvt_pk_bf16_f32 v40, v144, v145
    v_cvt_pk_bf16_f32 v41, v146, v147
    v_cvt_pk_bf16_f32 v42, v148, v149
    v_cvt_pk_bf16_f32 v43, v150, v151
    v_cvt_pk_bf16_f32 v44, v152, v153
    v_cvt_pk_bf16_f32 v45, v154, v155
    v_cvt_pk_bf16_f32 v46, v156, v157
    v_cvt_pk_bf16_f32 v47, v158, v159
    buffer_store_dwordx4 v[32:35], v11, s[20:23], 0 offen offset:0
    buffer_store_dwordx4 v[36:39], v13, s[20:23], 0 offen offset:0
    v_add_u32 v13, 4096, v13
    buffer_store_dwordx4 v[40:43], v13, s[20:23], 0 offen offset:0
    v_add_u32 v13, 4096, v13
    buffer_store_dwordx4 v[44:47], v13, s[20:23], 0 offen offset:0
    s_waitcnt vmcnt(0)
L_ln2_kernel_done:
    s_endpgm
.globl ffn1a_kernel
.p2align 8
.type ffn1a_kernel,@function
ffn1a_kernel:
    s_cmp_ge_u32 s2, 240
    s_cbranch_scc1 L_ffn1a_kernel_done
    s_load_dwordx2 s[4:5], s[0:1], 0
    s_load_dwordx2 s[8:9], s[0:1], 96
    s_mov_b32 s24, 0x11111112
    s_mul_hi_u32 s25, s2, s24
    s_mul_i32 s26, s25, 15
    s_sub_u32 s26, s2, s26
    s_waitcnt lgkmcnt(0)
    s_mov_b32 s20, s8
    s_mov_b32 s21, s9
    s_mov_b32 s22, 25165824
    s_mov_b32 s23, 0x00020000
    s_mov_b32 s12, s4
    s_mov_b32 s13, s5
    s_mov_b32 s14, 2097152
    s_mov_b32 s15, 0x00020000
    v_lshrrev_b32 v1, 6, v0
    s_nop 0
    v_readfirstlane_b32 s27, v1
    v_and_b32 v1, 63, v0
    s_lshl_b32 s28, s26, 2
    s_add_u32 s28, s28, s27
    s_mul_i32 s28, s28, 49152
    s_add_u32 s28, s28, 16777216
    v_lshl_add_u32 v2, v1, 4, s28
    buffer_load_dwordx4 v[208:211], v2, s[20:23], 0 offen offset:0
    v_add_u32 v3, 4096, v2
    v_add_u32 v4, 8192, v2
    buffer_load_dwordx4 v[212:215], v2, s[20:23], 0 offen offset:1024
    buffer_load_dwordx4 v[216:219], v2, s[20:23], 0 offen offset:2048
    buffer_load_dwordx4 v[220:223], v2, s[20:23], 0 offen offset:3072
    buffer_load_dwordx4 v[224:227], v3, s[20:23], 0 offen offset:0
    buffer_load_dwordx4 v[228:231], v3, s[20:23], 0 offen offset:1024
    buffer_load_dwordx4 v[232:235], v3, s[20:23], 0 offen offset:2048
    buffer_load_dwordx4 v[236:239], v3, s[20:23], 0 offen offset:3072
    buffer_load_dwordx4 v[240:243], v4, s[20:23], 0 offen offset:0
    buffer_load_dwordx4 v[244:247], v4, s[20:23], 0 offen offset:1024
    buffer_load_dwordx4 v[248:251], v4, s[20:23], 0 offen offset:2048
    buffer_load_dwordx4 v[252:255], v4, s[20:23], 0 offen offset:3072
    v_add_u32 v2, 12288, v2
    s_lshl_b32 s29, s25, 17
    s_lshl_b32 s30, s27, 15
    s_add_u32 s29, s29, s30
    s_add_u32 s29, s29, 23068672
    v_lshl_add_u32 v7, v1, 4, s29
    s_add_u32 s31, s30, 0
    s_mov_b32 m0, s31
    s_nop 0
    buffer_load_dwordx4 v7, s[20:23], 0 offen offset:0 lds
    buffer_load_dwordx4 v7, s[20:23], 0 offen offset:1024 lds
    buffer_load_dwordx4 v7, s[20:23], 0 offen offset:2048 lds
    buffer_load_dwordx4 v7, s[20:23], 0 offen offset:3072 lds
    v_add_u32 v7, 4096, v7
    s_add_u32 s31, s30, 4096
    s_mov_b32 m0, s31
    s_nop 0
    buffer_load_dwordx4 v7, s[20:23], 0 offen offset:0 lds
    buffer_load_dwordx4 v7, s[20:23], 0 offen offset:1024 lds
    buffer_load_dwordx4 v7, s[20:23], 0 offen offset:2048 lds
    buffer_load_dwordx4 v7, s[20:23], 0 offen offset:3072 lds
    v_add_u32 v7, 4096, v7
    s_add_u32 s31, s30, 8192
    s_mov_b32 m0, s31
    s_nop 0
    buffer_load_dwordx4 v7, s[20:23], 0 offen offset:0 lds
    buffer_load_dwordx4 v7, s[20:23], 0 offen offset:1024 lds
    buffer_load_dwordx4 v7, s[20:23], 0 offen offset:2048 lds
    buffer_load_dwordx4 v7, s[20:23], 0 offen offset:3072 lds
    v_add_u32 v7, 4096, v7
    s_add_u32 s31, s30, 12288
    s_mov_b32 m0, s31
    s_nop 0
    buffer_load_dwordx4 v7, s[20:23], 0 offen offset:0 lds
    buffer_load_dwordx4 v7, s[20:23], 0 offen offset:1024 lds
    buffer_load_dwordx4 v7, s[20:23], 0 offen offset:2048 lds
    buffer_load_dwordx4 v7, s[20:23], 0 offen offset:3072 lds
    v_add_u32 v7, 4096, v7
    s_add_u32 s31, s30, 16384
    s_mov_b32 m0, s31
    s_nop 0
    buffer_load_dwordx4 v7, s[20:23], 0 offen offset:0 lds
    buffer_load_dwordx4 v7, s[20:23], 0 offen offset:1024 lds
    buffer_load_dwordx4 v7, s[20:23], 0 offen offset:2048 lds
    buffer_load_dwordx4 v7, s[20:23], 0 offen offset:3072 lds
    v_add_u32 v7, 4096, v7
    s_add_u32 s31, s30, 20480
    s_mov_b32 m0, s31
    s_nop 0
    buffer_load_dwordx4 v7, s[20:23], 0 offen offset:0 lds
    buffer_load_dwordx4 v7, s[20:23], 0 offen offset:1024 lds
    buffer_load_dwordx4 v7, s[20:23], 0 offen offset:2048 lds
    buffer_load_dwordx4 v7, s[20:23], 0 offen offset:3072 lds
    v_add_u32 v7, 4096, v7
    s_add_u32 s31, s30, 24576
    s_mov_b32 m0, s31
    s_nop 0
    buffer_load_dwordx4 v7, s[20:23], 0 offen offset:0 lds
    buffer_load_dwordx4 v7, s[20:23], 0 offen offset:1024 lds
    buffer_load_dwordx4 v7, s[20:23], 0 offen offset:2048 lds
    buffer_load_dwordx4 v7, s[20:23], 0 offen offset:3072 lds
    v_add_u32 v7, 4096, v7
    s_add_u32 s31, s30, 28672
    s_mov_b32 m0, s31
    s_nop 0
    buffer_load_dwordx4 v7, s[20:23], 0 offen offset:0 lds
    buffer_load_dwordx4 v7, s[20:23], 0 offen offset:1024 lds
    buffer_load_dwordx4 v7, s[20:23], 0 offen offset:2048 lds
    buffer_load_dwordx4 v7, s[20:23], 0 offen offset:3072 lds
    v_add_u32 v7, 4096, v7
    s_waitcnt vmcnt(0)
    s_waitcnt lgkmcnt(0)
    s_barrier
    v_mov_b32 v64, 0
    v_mov_b32 v65, 0
    v_mov_b32 v66, 0
    v_mov_b32 v67, 0
    v_mov_b32 v68, 0
    v_mov_b32 v69, 0
    v_mov_b32 v70, 0
    v_mov_b32 v71, 0
    v_mov_b32 v72, 0
    v_mov_b32 v73, 0
    v_mov_b32 v74, 0
    v_mov_b32 v75, 0
    v_mov_b32 v76, 0
    v_mov_b32 v77, 0
    v_mov_b32 v78, 0
    v_mov_b32 v79, 0
    v_mov_b32 v80, 0
    v_mov_b32 v81, 0
    v_mov_b32 v82, 0
    v_mov_b32 v83, 0
    v_mov_b32 v84, 0
    v_mov_b32 v85, 0
    v_mov_b32 v86, 0
    v_mov_b32 v87, 0
    v_mov_b32 v88, 0
    v_mov_b32 v89, 0
    v_mov_b32 v90, 0
    v_mov_b32 v91, 0
    v_mov_b32 v92, 0
    v_mov_b32 v93, 0
    v_mov_b32 v94, 0
    v_mov_b32 v95, 0
    v_mov_b32 v96, 0
    v_mov_b32 v97, 0
    v_mov_b32 v98, 0
    v_mov_b32 v99, 0
    v_mov_b32 v100, 0
    v_mov_b32 v101, 0
    v_mov_b32 v102, 0
    v_mov_b32 v103, 0
    v_mov_b32 v104, 0
    v_mov_b32 v105, 0
    v_mov_b32 v106, 0
    v_mov_b32 v107, 0
    v_mov_b32 v108, 0
    v_mov_b32 v109, 0
    v_mov_b32 v110, 0
    v_mov_b32 v111, 0
    v_mov_b32 v112, 0
    v_mov_b32 v113, 0
    v_mov_b32 v114, 0
    v_mov_b32 v115, 0
    v_mov_b32 v116, 0
    v_mov_b32 v117, 0
    v_mov_b32 v118, 0
    v_mov_b32 v119, 0
    v_mov_b32 v120, 0
    v_mov_b32 v121, 0
    v_mov_b32 v122, 0
    v_mov_b32 v123, 0
    v_mov_b32 v124, 0
    v_mov_b32 v125, 0
    v_mov_b32 v126, 0
    v_mov_b32 v127, 0
    v_mov_b32 v128, 0
    v_mov_b32 v129, 0
    v_mov_b32 v130, 0
    v_mov_b32 v131, 0
    v_mov_b32 v132, 0
    v_mov_b32 v133, 0
    v_mov_b32 v134, 0
    v_mov_b32 v135, 0
    v_mov_b32 v136, 0
    v_mov_b32 v137, 0
    v_mov_b32 v138, 0
    v_mov_b32 v139, 0
    v_mov_b32 v140, 0
    v_mov_b32 v141, 0
    v_mov_b32 v142, 0
    v_mov_b32 v143, 0
    v_mov_b32 v144, 0
    v_mov_b32 v145, 0
    v_mov_b32 v146, 0
    v_mov_b32 v147, 0
    v_mov_b32 v148, 0
    v_mov_b32 v149, 0
    v_mov_b32 v150, 0
    v_mov_b32 v151, 0
    v_mov_b32 v152, 0
    v_mov_b32 v153, 0
    v_mov_b32 v154, 0
    v_mov_b32 v155, 0
    v_mov_b32 v156, 0
    v_mov_b32 v157, 0
    v_mov_b32 v158, 0
    v_mov_b32 v159, 0
    v_lshlrev_b32 v5, 4, v1
    v_add_u32 v14, 0x10000, v5
    s_mov_b32 s31, 4
L_ffn1a_kernel_main:
    ds_read_b128 v[160:163], v5 offset:0
    ds_read_b128 v[164:167], v5 offset:16384
    ds_read_b128 v[168:171], v5 offset:32768
    ds_read_b128 v[172:175], v5 offset:49152
    ds_read_b128 v[176:179], v14 offset:0
    ds_read_b128 v[180:183], v14 offset:16384
    ds_read_b128 v[184:187], v14 offset:32768
    ds_read_b128 v[188:191], v14 offset:49152
    s_waitcnt vmcnt(9) lgkmcnt(0)
    v_mfma_f32_16x16x32_bf16 v[64:67], v[208:211], v[160:163], v[64:67]
    v_mfma_f32_16x16x32_bf16 v[68:71], v[208:211], v[164:167], v[68:71]
    v_mfma_f32_16x16x32_bf16 v[72:75], v[208:211], v[168:171], v[72:75]
    v_mfma_f32_16x16x32_bf16 v[76:79], v[208:211], v[172:175], v[76:79]
    v_mfma_f32_16x16x32_bf16 v[80:83], v[208:211], v[176:179], v[80:83]
    v_mfma_f32_16x16x32_bf16 v[84:87], v[208:211], v[180:183], v[84:87]
    v_mfma_f32_16x16x32_bf16 v[88:91], v[208:211], v[184:187], v[88:91]
    v_mfma_f32_16x16x32_bf16 v[92:95], v[208:211], v[188:191], v[92:95]
    v_mfma_f32_16x16x32_bf16 v[96:99], v[212:215], v[160:163], v[96:99]
    v_mfma_f32_16x16x32_bf16 v[100:103], v[212:215], v[164:167], v[100:103]
    v_mfma_f32_16x16x32_bf16 v[104:107], v[212:215], v[168:171], v[104:107]
    v_mfma_f32_16x16x32_bf16 v[108:111], v[212:215], v[172:175], v[108:111]
    v_mfma_f32_16x16x32_bf16 v[112:115], v[212:215], v[176:179], v[112:115]
    v_mfma_f32_16x16x32_bf16 v[116:119], v[212:215], v[180:183], v[116:119]
    v_mfma_f32_16x16x32_bf16 v[120:123], v[212:215], v[184:187], v[120:123]
    v_mfma_f32_16x16x32_bf16 v[124:127], v[212:215], v[188:191], v[124:127]
    v_mfma_f32_16x16x32_bf16 v[128:131], v[216:219], v[160:163], v[128:131]
    v_mfma_f32_16x16x32_bf16 v[132:135], v[216:219], v[164:167], v[132:135]
    v_mfma_f32_16x16x32_bf16 v[136:139], v[216:219], v[168:171], v[136:139]
    v_mfma_f32_16x16x32_bf16 v[140:143], v[216:219], v[172:175], v[140:143]
    v_mfma_f32_16x16x32_bf16 v[144:147], v[216:219], v[176:179], v[144:147]
    v_mfma_f32_16x16x32_bf16 v[148:151], v[216:219], v[180:183], v[148:151]
    v_mfma_f32_16x16x32_bf16 v[152:155], v[216:219], v[184:187], v[152:155]
    v_mfma_f32_16x16x32_bf16 v[156:159], v[216:219], v[188:191], v[156:159]
    buffer_load_dwordx4 v[208:211], v2, s[20:23], 0 offen offset:0
    buffer_load_dwordx4 v[212:215], v2, s[20:23], 0 offen offset:1024
    buffer_load_dwordx4 v[216:219], v2, s[20:23], 0 offen offset:2048
    v_add_u32 v2, 3072, v2
    ds_read_b128 v[160:163], v5 offset:1024
    ds_read_b128 v[164:167], v5 offset:17408
    ds_read_b128 v[168:171], v5 offset:33792
    ds_read_b128 v[172:175], v5 offset:50176
    ds_read_b128 v[176:179], v14 offset:1024
    ds_read_b128 v[180:183], v14 offset:17408
    ds_read_b128 v[184:187], v14 offset:33792
    ds_read_b128 v[188:191], v14 offset:50176
    s_waitcnt vmcnt(9) lgkmcnt(0)
    v_mfma_f32_16x16x32_bf16 v[64:67], v[220:223], v[160:163], v[64:67]
    v_mfma_f32_16x16x32_bf16 v[68:71], v[220:223], v[164:167], v[68:71]
    v_mfma_f32_16x16x32_bf16 v[72:75], v[220:223], v[168:171], v[72:75]
    v_mfma_f32_16x16x32_bf16 v[76:79], v[220:223], v[172:175], v[76:79]
    v_mfma_f32_16x16x32_bf16 v[80:83], v[220:223], v[176:179], v[80:83]
    v_mfma_f32_16x16x32_bf16 v[84:87], v[220:223], v[180:183], v[84:87]
    v_mfma_f32_16x16x32_bf16 v[88:91], v[220:223], v[184:187], v[88:91]
    v_mfma_f32_16x16x32_bf16 v[92:95], v[220:223], v[188:191], v[92:95]
    v_mfma_f32_16x16x32_bf16 v[96:99], v[224:227], v[160:163], v[96:99]
    v_mfma_f32_16x16x32_bf16 v[100:103], v[224:227], v[164:167], v[100:103]
    v_mfma_f32_16x16x32_bf16 v[104:107], v[224:227], v[168:171], v[104:107]
    v_mfma_f32_16x16x32_bf16 v[108:111], v[224:227], v[172:175], v[108:111]
    v_mfma_f32_16x16x32_bf16 v[112:115], v[224:227], v[176:179], v[112:115]
    v_mfma_f32_16x16x32_bf16 v[116:119], v[224:227], v[180:183], v[116:119]
    v_mfma_f32_16x16x32_bf16 v[120:123], v[224:227], v[184:187], v[120:123]
    v_mfma_f32_16x16x32_bf16 v[124:127], v[224:227], v[188:191], v[124:127]
    v_mfma_f32_16x16x32_bf16 v[128:131], v[228:231], v[160:163], v[128:131]
    v_mfma_f32_16x16x32_bf16 v[132:135], v[228:231], v[164:167], v[132:135]
    v_mfma_f32_16x16x32_bf16 v[136:139], v[228:231], v[168:171], v[136:139]
    v_mfma_f32_16x16x32_bf16 v[140:143], v[228:231], v[172:175], v[140:143]
    v_mfma_f32_16x16x32_bf16 v[144:147], v[228:231], v[176:179], v[144:147]
    v_mfma_f32_16x16x32_bf16 v[148:151], v[228:231], v[180:183], v[148:151]
    v_mfma_f32_16x16x32_bf16 v[152:155], v[228:231], v[184:187], v[152:155]
    v_mfma_f32_16x16x32_bf16 v[156:159], v[228:231], v[188:191], v[156:159]
    buffer_load_dwordx4 v[220:223], v2, s[20:23], 0 offen offset:0
    buffer_load_dwordx4 v[224:227], v2, s[20:23], 0 offen offset:1024
    buffer_load_dwordx4 v[228:231], v2, s[20:23], 0 offen offset:2048
    v_add_u32 v2, 3072, v2
    ds_read_b128 v[160:163], v5 offset:2048
    ds_read_b128 v[164:167], v5 offset:18432
    ds_read_b128 v[168:171], v5 offset:34816
    ds_read_b128 v[172:175], v5 offset:51200
    ds_read_b128 v[176:179], v14 offset:2048
    ds_read_b128 v[180:183], v14 offset:18432
    ds_read_b128 v[184:187], v14 offset:34816
    ds_read_b128 v[188:191], v14 offset:51200
    s_waitcnt vmcnt(9) lgkmcnt(0)
    v_mfma_f32_16x16x32_bf16 v[64:67], v[232:235], v[160:163], v[64:67]
    v_mfma_f32_16x16x32_bf16 v[68:71], v[232:235], v[164:167], v[68:71]
    v_mfma_f32_16x16x32_bf16 v[72:75], v[232:235], v[168:171], v[72:75]
    v_mfma_f32_16x16x32_bf16 v[76:79], v[232:235], v[172:175], v[76:79]
    v_mfma_f32_16x16x32_bf16 v[80:83], v[232:235], v[176:179], v[80:83]
    v_mfma_f32_16x16x32_bf16 v[84:87], v[232:235], v[180:183], v[84:87]
    v_mfma_f32_16x16x32_bf16 v[88:91], v[232:235], v[184:187], v[88:91]
    v_mfma_f32_16x16x32_bf16 v[92:95], v[232:235], v[188:191], v[92:95]
    v_mfma_f32_16x16x32_bf16 v[96:99], v[236:239], v[160:163], v[96:99]
    v_mfma_f32_16x16x32_bf16 v[100:103], v[236:239], v[164:167], v[100:103]
    v_mfma_f32_16x16x32_bf16 v[104:107], v[236:239], v[168:171], v[104:107]
    v_mfma_f32_16x16x32_bf16 v[108:111], v[236:239], v[172:175], v[108:111]
    v_mfma_f32_16x16x32_bf16 v[112:115], v[236:239], v[176:179], v[112:115]
    v_mfma_f32_16x16x32_bf16 v[116:119], v[236:239], v[180:183], v[116:119]
    v_mfma_f32_16x16x32_bf16 v[120:123], v[236:239], v[184:187], v[120:123]
    v_mfma_f32_16x16x32_bf16 v[124:127], v[236:239], v[188:191], v[124:127]
    v_mfma_f32_16x16x32_bf16 v[128:131], v[240:243], v[160:163], v[128:131]
    v_mfma_f32_16x16x32_bf16 v[132:135], v[240:243], v[164:167], v[132:135]
    v_mfma_f32_16x16x32_bf16 v[136:139], v[240:243], v[168:171], v[136:139]
    v_mfma_f32_16x16x32_bf16 v[140:143], v[240:243], v[172:175], v[140:143]
    v_mfma_f32_16x16x32_bf16 v[144:147], v[240:243], v[176:179], v[144:147]
    v_mfma_f32_16x16x32_bf16 v[148:151], v[240:243], v[180:183], v[148:151]
    v_mfma_f32_16x16x32_bf16 v[152:155], v[240:243], v[184:187], v[152:155]
    v_mfma_f32_16x16x32_bf16 v[156:159], v[240:243], v[188:191], v[156:159]
    buffer_load_dwordx4 v[232:235], v2, s[20:23], 0 offen offset:0
    buffer_load_dwordx4 v[236:239], v2, s[20:23], 0 offen offset:1024
    buffer_load_dwordx4 v[240:243], v2, s[20:23], 0 offen offset:2048
    v_add_u32 v2, 3072, v2
    ds_read_b128 v[160:163], v5 offset:3072
    ds_read_b128 v[164:167], v5 offset:19456
    ds_read_b128 v[168:171], v5 offset:35840
    ds_read_b128 v[172:175], v5 offset:52224
    ds_read_b128 v[176:179], v14 offset:3072
    ds_read_b128 v[180:183], v14 offset:19456
    ds_read_b128 v[184:187], v14 offset:35840
    ds_read_b128 v[188:191], v14 offset:52224
    s_waitcnt vmcnt(9) lgkmcnt(0)
    v_mfma_f32_16x16x32_bf16 v[64:67], v[244:247], v[160:163], v[64:67]
    v_mfma_f32_16x16x32_bf16 v[68:71], v[244:247], v[164:167], v[68:71]
    v_mfma_f32_16x16x32_bf16 v[72:75], v[244:247], v[168:171], v[72:75]
    v_mfma_f32_16x16x32_bf16 v[76:79], v[244:247], v[172:175], v[76:79]
    v_mfma_f32_16x16x32_bf16 v[80:83], v[244:247], v[176:179], v[80:83]
    v_mfma_f32_16x16x32_bf16 v[84:87], v[244:247], v[180:183], v[84:87]
    v_mfma_f32_16x16x32_bf16 v[88:91], v[244:247], v[184:187], v[88:91]
    v_mfma_f32_16x16x32_bf16 v[92:95], v[244:247], v[188:191], v[92:95]
    v_mfma_f32_16x16x32_bf16 v[96:99], v[248:251], v[160:163], v[96:99]
    v_mfma_f32_16x16x32_bf16 v[100:103], v[248:251], v[164:167], v[100:103]
    v_mfma_f32_16x16x32_bf16 v[104:107], v[248:251], v[168:171], v[104:107]
    v_mfma_f32_16x16x32_bf16 v[108:111], v[248:251], v[172:175], v[108:111]
    v_mfma_f32_16x16x32_bf16 v[112:115], v[248:251], v[176:179], v[112:115]
    v_mfma_f32_16x16x32_bf16 v[116:119], v[248:251], v[180:183], v[116:119]
    v_mfma_f32_16x16x32_bf16 v[120:123], v[248:251], v[184:187], v[120:123]
    v_mfma_f32_16x16x32_bf16 v[124:127], v[248:251], v[188:191], v[124:127]
    v_mfma_f32_16x16x32_bf16 v[128:131], v[252:255], v[160:163], v[128:131]
    v_mfma_f32_16x16x32_bf16 v[132:135], v[252:255], v[164:167], v[132:135]
    v_mfma_f32_16x16x32_bf16 v[136:139], v[252:255], v[168:171], v[136:139]
    v_mfma_f32_16x16x32_bf16 v[140:143], v[252:255], v[172:175], v[140:143]
    v_mfma_f32_16x16x32_bf16 v[144:147], v[252:255], v[176:179], v[144:147]
    v_mfma_f32_16x16x32_bf16 v[148:151], v[252:255], v[180:183], v[148:151]
    v_mfma_f32_16x16x32_bf16 v[152:155], v[252:255], v[184:187], v[152:155]
    v_mfma_f32_16x16x32_bf16 v[156:159], v[252:255], v[188:191], v[156:159]
    buffer_load_dwordx4 v[244:247], v2, s[20:23], 0 offen offset:0
    buffer_load_dwordx4 v[248:251], v2, s[20:23], 0 offen offset:1024
    buffer_load_dwordx4 v[252:255], v2, s[20:23], 0 offen offset:2048
    v_add_u32 v2, 3072, v2
    v_add_u32 v5, 4096, v5
    v_add_u32 v14, 4096, v14
    s_sub_u32 s31, s31, 1
    s_cmp_lg_u32 s31, 0
    s_cbranch_scc1 L_ffn1a_kernel_main
    s_nop 7
    s_waitcnt vmcnt(0)
    s_mul_i32 s28, s26, 96
    s_mul_i32 s29, s27, 24
    s_add_u32 s28, s28, s29
    v_and_b32 v6, 15, v1
    v_lshrrev_b32 v7, 4, v1
    v_lshl_add_u32 v8, v7, 2, s28
    v_add_u32 v9, 16, v8
    v_lshrrev_b32 v10, 4, v8
    v_lshlrev_b32 v10, 6, v10
    v_bfe_u32 v11, v8, 3, 1
    v_lshl_add_u32 v10, v11, 5, v10
    v_add_u32 v10, v10, v6
    v_lshlrev_b32 v10, 4, v10
    v_and_b32 v11, 4, v8
    v_lshl_add_u32 v12, v11, 1, v10
    s_lshl_b32 s29, s25, 2
    s_mul_i32 s29, s29, 88064
    s_add_u32 s29, s29, 10485760
    v_add_u32 v12, s29, v12
    v_bfrev_b32 v11, 1
    v_cmp_gt_u32 vcc, 1376, v8
    s_nop 1
    v_cndmask_b32 v12, v11, v12, vcc
    v_lshrrev_b32 v10, 4, v9
    v_lshlrev_b32 v10, 6, v10
    v_bfe_u32 v11, v9, 3, 1
    v_lshl_add_u32 v10, v11, 5, v10
    v_add_u32 v10, v10, v6
    v_lshlrev_b32 v10, 4, v10
    v_and_b32 v11, 4, v9
    v_lshl_add_u32 v13, v11, 1, v10
    s_lshl_b32 s29, s25, 2
    s_mul_i32 s29, s29, 88064
    s_add_u32 s29, s29, 10485760
    v_add_u32 v13, s29, v13
    v_bfrev_b32 v11, 1
    v_cmp_gt_u32 vcc, 1376, v9
    s_nop 1
    v_cndmask_b32 v13, v11, v13, vcc
    v_cmp_gt_u32 vcc, 2, v7
    v_bfrev_b32 v11, 1
    s_nop 0
    v_cndmask_b32 v13, v11, v13, vcc
    v_cvt_pk_bf16_f32 v16, v64, v65
    v_lshlrev_b32 v64, 16, v16
    v_and_b32 v65, 0xffff0000, v16
    v_cvt_pk_bf16_f32 v16, v96, v97
    v_lshlrev_b32 v96, 16, v16
    v_and_b32 v97, 0xffff0000, v16
    v_cvt_pk_bf16_f32 v16, v66, v67
    v_lshlrev_b32 v66, 16, v16
    v_and_b32 v67, 0xffff0000, v16
    v_cvt_pk_bf16_f32 v16, v98, v99
    v_lshlrev_b32 v98, 16, v16
    v_and_b32 v99, 0xffff0000, v16
    v_mul_f32 v17, 0xbfb8aa3b, v64
    v_exp_f32 v17, v17
    s_nop 0
    v_add_f32 v17, 1.0, v17
    v_rcp_f32 v17, v17
    s_nop 0
    v_mul_f32 v64, v64, v17
    v_mul_f32 v17, 0xbfb8aa3b, v65
    v_exp_f32 v17, v17
    s_nop 0
    v_add_f32 v17, 1.0, v17
    v_rcp_f32 v17, v17
    s_nop 0
    v_mul_f32 v65, v65, v17
    v_mul_f32 v17, 0xbfb8aa3b, v66
    v_exp_f32 v17, v17
    s_nop 0
    v_add_f32 v17, 1.0, v17
    v_rcp_f32 v17, v17
    s_nop 0
    v_mul_f32 v66, v66, v17
    v_mul_f32 v17, 0xbfb8aa3b, v67
    v_exp_f32 v17, v17
    s_nop 0
    v_add_f32 v17, 1.0, v17
    v_rcp_f32 v17, v17
    s_nop 0
    v_mul_f32 v67, v67, v17
    v_cvt_pk_bf16_f32 v16, v64, v65
    v_lshlrev_b32 v64, 16, v16
    v_and_b32 v65, 0xffff0000, v16
    v_cvt_pk_bf16_f32 v16, v66, v67
    v_lshlrev_b32 v66, 16, v16
    v_and_b32 v67, 0xffff0000, v16
    v_mul_f32 v64, v64, v96
    v_mul_f32 v65, v65, v97
    v_mul_f32 v66, v66, v98
    v_mul_f32 v67, v67, v99
    v_cvt_pk_bf16_f32 v20, v64, v65
    v_cvt_pk_bf16_f32 v21, v66, v67
    v_add_u32 v22, 0, v12
    buffer_store_dwordx2 v[20:21], v22, s[20:23], 0 offen
    v_mov_b32 v24, v128
    v_mov_b32 v25, v129
    v_mov_b32 v26, v130
    v_mov_b32 v27, v131
    s_nop 1
    v_permlane32_swap_b32 v128, v24
    v_permlane32_swap_b32 v129, v25
    v_permlane32_swap_b32 v130, v26
    v_permlane32_swap_b32 v131, v27
    s_nop 1
    v_cvt_pk_bf16_f32 v16, v128, v129
    v_lshlrev_b32 v128, 16, v16
    v_and_b32 v129, 0xffff0000, v16
    v_cvt_pk_bf16_f32 v16, v24, v25
    v_lshlrev_b32 v24, 16, v16
    v_and_b32 v25, 0xffff0000, v16
    v_cvt_pk_bf16_f32 v16, v130, v131
    v_lshlrev_b32 v130, 16, v16
    v_and_b32 v131, 0xffff0000, v16
    v_cvt_pk_bf16_f32 v16, v26, v27
    v_lshlrev_b32 v26, 16, v16
    v_and_b32 v27, 0xffff0000, v16
    v_mul_f32 v17, 0xbfb8aa3b, v128
    v_exp_f32 v17, v17
    s_nop 0
    v_add_f32 v17, 1.0, v17
    v_rcp_f32 v17, v17
    s_nop 0
    v_mul_f32 v128, v128, v17
    v_mul_f32 v17, 0xbfb8aa3b, v129
    v_exp_f32 v17, v17
    s_nop 0
    v_add_f32 v17, 1.0, v17
    v_rcp_f32 v17, v17
    s_nop 0
    v_mul_f32 v129, v129, v17
    v_mul_f32 v17, 0xbfb8aa3b, v130
    v_exp_f32 v17, v17
    s_nop 0
    v_add_f32 v17, 1.0, v17
    v_rcp_f32 v17, v17
    s_nop 0
    v_mul_f32 v130, v130, v17
    v_mul_f32 v17, 0xbfb8aa3b, v131
    v_exp_f32 v17, v17
    s_nop 0
    v_add_f32 v17, 1.0, v17
    v_rcp_f32 v17, v17
    s_nop 0
    v_mul_f32 v131, v131, v17
    v_cvt_pk_bf16_f32 v16, v128, v129
    v_lshlrev_b32 v128, 16, v16
    v_and_b32 v129, 0xffff0000, v16
    v_cvt_pk_bf16_f32 v16, v130, v131
    v_lshlrev_b32 v130, 16, v16
    v_and_b32 v131, 0xffff0000, v16
    v_mul_f32 v128, v128, v24
    v_mul_f32 v129, v129, v25
    v_mul_f32 v130, v130, v26
    v_mul_f32 v131, v131, v27
    v_cvt_pk_bf16_f32 v20, v128, v129
    v_cvt_pk_bf16_f32 v21, v130, v131
    v_add_u32 v22, 0, v13
    buffer_store_dwordx2 v[20:21], v22, s[20:23], 0 offen
    s_nop 1
    v_cvt_pk_bf16_f32 v16, v68, v69
    v_lshlrev_b32 v68, 16, v16
    v_and_b32 v69, 0xffff0000, v16
    v_cvt_pk_bf16_f32 v16, v100, v101
    v_lshlrev_b32 v100, 16, v16
    v_and_b32 v101, 0xffff0000, v16
    v_cvt_pk_bf16_f32 v16, v70, v71
    v_lshlrev_b32 v70, 16, v16
    v_and_b32 v71, 0xffff0000, v16
    v_cvt_pk_bf16_f32 v16, v102, v103
    v_lshlrev_b32 v102, 16, v16
    v_and_b32 v103, 0xffff0000, v16
    v_mul_f32 v17, 0xbfb8aa3b, v68
    v_exp_f32 v17, v17
    s_nop 0
    v_add_f32 v17, 1.0, v17
    v_rcp_f32 v17, v17
    s_nop 0
    v_mul_f32 v68, v68, v17
    v_mul_f32 v17, 0xbfb8aa3b, v69
    v_exp_f32 v17, v17
    s_nop 0
    v_add_f32 v17, 1.0, v17
    v_rcp_f32 v17, v17
    s_nop 0
    v_mul_f32 v69, v69, v17
    v_mul_f32 v17, 0xbfb8aa3b, v70
    v_exp_f32 v17, v17
    s_nop 0
    v_add_f32 v17, 1.0, v17
    v_rcp_f32 v17, v17
    s_nop 0
    v_mul_f32 v70, v70, v17
    v_mul_f32 v17, 0xbfb8aa3b, v71
    v_exp_f32 v17, v17
    s_nop 0
    v_add_f32 v17, 1.0, v17
    v_rcp_f32 v17, v17
    s_nop 0
    v_mul_f32 v71, v71, v17
    v_cvt_pk_bf16_f32 v16, v68, v69
    v_lshlrev_b32 v68, 16, v16
    v_and_b32 v69, 0xffff0000, v16
    v_cvt_pk_bf16_f32 v16, v70, v71
    v_lshlrev_b32 v70, 16, v16
    v_and_b32 v71, 0xffff0000, v16
    v_mul_f32 v68, v68, v100
    v_mul_f32 v69, v69, v101
    v_mul_f32 v70, v70, v102
    v_mul_f32 v71, v71, v103
    v_cvt_pk_bf16_f32 v20, v68, v69
    v_cvt_pk_bf16_f32 v21, v70, v71
    v_add_u32 v22, 256, v12
    buffer_store_dwordx2 v[20:21], v22, s[20:23], 0 offen
    v_mov_b32 v24, v132
    v_mov_b32 v25, v133
    v_mov_b32 v26, v134
    v_mov_b32 v27, v135
    s_nop 1
    v_permlane32_swap_b32 v132, v24
    v_permlane32_swap_b32 v133, v25
    v_permlane32_swap_b32 v134, v26
    v_permlane32_swap_b32 v135, v27
    s_nop 1
    v_cvt_pk_bf16_f32 v16, v132, v133
    v_lshlrev_b32 v132, 16, v16
    v_and_b32 v133, 0xffff0000, v16
    v_cvt_pk_bf16_f32 v16, v24, v25
    v_lshlrev_b32 v24, 16, v16
    v_and_b32 v25, 0xffff0000, v16
    v_cvt_pk_bf16_f32 v16, v134, v135
    v_lshlrev_b32 v134, 16, v16
    v_and_b32 v135, 0xffff0000, v16
    v_cvt_pk_bf16_f32 v16, v26, v27
    v_lshlrev_b32 v26, 16, v16
    v_and_b32 v27, 0xffff0000, v16
    v_mul_f32 v17, 0xbfb8aa3b, v132
    v_exp_f32 v17, v17
    s_nop 0
    v_add_f32 v17, 1.0, v17
    v_rcp_f32 v17, v17
    s_nop 0
    v_mul_f32 v132, v132, v17
    v_mul_f32 v17, 0xbfb8aa3b, v133
    v_exp_f32 v17, v17
    s_nop 0
    v_add_f32 v17, 1.0, v17
    v_rcp_f32 v17, v17
    s_nop 0
    v_mul_f32 v133, v133, v17
    v_mul_f32 v17, 0xbfb8aa3b, v134
    v_exp_f32 v17, v17
    s_nop 0
    v_add_f32 v17, 1.0, v17
    v_rcp_f32 v17, v17
    s_nop 0
    v_mul_f32 v134, v134, v17
    v_mul_f32 v17, 0xbfb8aa3b, v135
    v_exp_f32 v17, v17
    s_nop 0
    v_add_f32 v17, 1.0, v17
    v_rcp_f32 v17, v17
    s_nop 0
    v_mul_f32 v135, v135, v17
    v_cvt_pk_bf16_f32 v16, v132, v133
    v_lshlrev_b32 v132, 16, v16
    v_and_b32 v133, 0xffff0000, v16
    v_cvt_pk_bf16_f32 v16, v134, v135
    v_lshlrev_b32 v134, 16, v16
    v_and_b32 v135, 0xffff0000, v16
    v_mul_f32 v132, v132, v24
    v_mul_f32 v133, v133, v25
    v_mul_f32 v134, v134, v26
    v_mul_f32 v135, v135, v27
    v_cvt_pk_bf16_f32 v20, v132, v133
    v_cvt_pk_bf16_f32 v21, v134, v135
    v_add_u32 v22, 256, v13
    buffer_store_dwordx2 v[20:21], v22, s[20:23], 0 offen
    s_nop 1
    v_cvt_pk_bf16_f32 v16, v72, v73
    v_lshlrev_b32 v72, 16, v16
    v_and_b32 v73, 0xffff0000, v16
    v_cvt_pk_bf16_f32 v16, v104, v105
    v_lshlrev_b32 v104, 16, v16
    v_and_b32 v105, 0xffff0000, v16
    v_cvt_pk_bf16_f32 v16, v74, v75
    v_lshlrev_b32 v74, 16, v16
    v_and_b32 v75, 0xffff0000, v16
    v_cvt_pk_bf16_f32 v16, v106, v107
    v_lshlrev_b32 v106, 16, v16
    v_and_b32 v107, 0xffff0000, v16
    v_mul_f32 v17, 0xbfb8aa3b, v72
    v_exp_f32 v17, v17
    s_nop 0
    v_add_f32 v17, 1.0, v17
    v_rcp_f32 v17, v17
    s_nop 0
    v_mul_f32 v72, v72, v17
    v_mul_f32 v17, 0xbfb8aa3b, v73
    v_exp_f32 v17, v17
    s_nop 0
    v_add_f32 v17, 1.0, v17
    v_rcp_f32 v17, v17
    s_nop 0
    v_mul_f32 v73, v73, v17
    v_mul_f32 v17, 0xbfb8aa3b, v74
    v_exp_f32 v17, v17
    s_nop 0
    v_add_f32 v17, 1.0, v17
    v_rcp_f32 v17, v17
    s_nop 0
    v_mul_f32 v74, v74, v17
    v_mul_f32 v17, 0xbfb8aa3b, v75
    v_exp_f32 v17, v17
    s_nop 0
    v_add_f32 v17, 1.0, v17
    v_rcp_f32 v17, v17
    s_nop 0
    v_mul_f32 v75, v75, v17
    v_cvt_pk_bf16_f32 v16, v72, v73
    v_lshlrev_b32 v72, 16, v16
    v_and_b32 v73, 0xffff0000, v16
    v_cvt_pk_bf16_f32 v16, v74, v75
    v_lshlrev_b32 v74, 16, v16
    v_and_b32 v75, 0xffff0000, v16
    v_mul_f32 v72, v72, v104
    v_mul_f32 v73, v73, v105
    v_mul_f32 v74, v74, v106
    v_mul_f32 v75, v75, v107
    v_cvt_pk_bf16_f32 v20, v72, v73
    v_cvt_pk_bf16_f32 v21, v74, v75
    v_add_u32 v22, 88064, v12
    buffer_store_dwordx2 v[20:21], v22, s[20:23], 0 offen
    v_mov_b32 v24, v136
    v_mov_b32 v25, v137
    v_mov_b32 v26, v138
    v_mov_b32 v27, v139
    s_nop 1
    v_permlane32_swap_b32 v136, v24
    v_permlane32_swap_b32 v137, v25
    v_permlane32_swap_b32 v138, v26
    v_permlane32_swap_b32 v139, v27
    s_nop 1
    v_cvt_pk_bf16_f32 v16, v136, v137
    v_lshlrev_b32 v136, 16, v16
    v_and_b32 v137, 0xffff0000, v16
    v_cvt_pk_bf16_f32 v16, v24, v25
    v_lshlrev_b32 v24, 16, v16
    v_and_b32 v25, 0xffff0000, v16
    v_cvt_pk_bf16_f32 v16, v138, v139
    v_lshlrev_b32 v138, 16, v16
    v_and_b32 v139, 0xffff0000, v16
    v_cvt_pk_bf16_f32 v16, v26, v27
    v_lshlrev_b32 v26, 16, v16
    v_and_b32 v27, 0xffff0000, v16
    v_mul_f32 v17, 0xbfb8aa3b, v136
    v_exp_f32 v17, v17
    s_nop 0
    v_add_f32 v17, 1.0, v17
    v_rcp_f32 v17, v17
    s_nop 0
    v_mul_f32 v136, v136, v17
    v_mul_f32 v17, 0xbfb8aa3b, v137
    v_exp_f32 v17, v17
    s_nop 0
    v_add_f32 v17, 1.0, v17
    v_rcp_f32 v17, v17
    s_nop 0
    v_mul_f32 v137, v137, v17
    v_mul_f32 v17, 0xbfb8aa3b, v138
    v_exp_f32 v17, v17
    s_nop 0
    v_add_f32 v17, 1.0, v17
    v_rcp_f32 v17, v17
    s_nop 0
    v_mul_f32 v138, v138, v17
    v_mul_f32 v17, 0xbfb8aa3b, v139
    v_exp_f32 v17, v17
    s_nop 0
    v_add_f32 v17, 1.0, v17
    v_rcp_f32 v17, v17
    s_nop 0
    v_mul_f32 v139, v139, v17
    v_cvt_pk_bf16_f32 v16, v136, v137
    v_lshlrev_b32 v136, 16, v16
    v_and_b32 v137, 0xffff0000, v16
    v_cvt_pk_bf16_f32 v16, v138, v139
    v_lshlrev_b32 v138, 16, v16
    v_and_b32 v139, 0xffff0000, v16
    v_mul_f32 v136, v136, v24
    v_mul_f32 v137, v137, v25
    v_mul_f32 v138, v138, v26
    v_mul_f32 v139, v139, v27
    v_cvt_pk_bf16_f32 v20, v136, v137
    v_cvt_pk_bf16_f32 v21, v138, v139
    v_add_u32 v22, 88064, v13
    buffer_store_dwordx2 v[20:21], v22, s[20:23], 0 offen
    s_nop 1
    v_cvt_pk_bf16_f32 v16, v76, v77
    v_lshlrev_b32 v76, 16, v16
    v_and_b32 v77, 0xffff0000, v16
    v_cvt_pk_bf16_f32 v16, v108, v109
    v_lshlrev_b32 v108, 16, v16
    v_and_b32 v109, 0xffff0000, v16
    v_cvt_pk_bf16_f32 v16, v78, v79
    v_lshlrev_b32 v78, 16, v16
    v_and_b32 v79, 0xffff0000, v16
    v_cvt_pk_bf16_f32 v16, v110, v111
    v_lshlrev_b32 v110, 16, v16
    v_and_b32 v111, 0xffff0000, v16
    v_mul_f32 v17, 0xbfb8aa3b, v76
    v_exp_f32 v17, v17
    s_nop 0
    v_add_f32 v17, 1.0, v17
    v_rcp_f32 v17, v17
    s_nop 0
    v_mul_f32 v76, v76, v17
    v_mul_f32 v17, 0xbfb8aa3b, v77
    v_exp_f32 v17, v17
    s_nop 0
    v_add_f32 v17, 1.0, v17
    v_rcp_f32 v17, v17
    s_nop 0
    v_mul_f32 v77, v77, v17
    v_mul_f32 v17, 0xbfb8aa3b, v78
    v_exp_f32 v17, v17
    s_nop 0
    v_add_f32 v17, 1.0, v17
    v_rcp_f32 v17, v17
    s_nop 0
    v_mul_f32 v78, v78, v17
    v_mul_f32 v17, 0xbfb8aa3b, v79
    v_exp_f32 v17, v17
    s_nop 0
    v_add_f32 v17, 1.0, v17
    v_rcp_f32 v17, v17
    s_nop 0
    v_mul_f32 v79, v79, v17
    v_cvt_pk_bf16_f32 v16, v76, v77
    v_lshlrev_b32 v76, 16, v16
    v_and_b32 v77, 0xffff0000, v16
    v_cvt_pk_bf16_f32 v16, v78, v79
    v_lshlrev_b32 v78, 16, v16
    v_and_b32 v79, 0xffff0000, v16
    v_mul_f32 v76, v76, v108
    v_mul_f32 v77, v77, v109
    v_mul_f32 v78, v78, v110
    v_mul_f32 v79, v79, v111
    v_cvt_pk_bf16_f32 v20, v76, v77
    v_cvt_pk_bf16_f32 v21, v78, v79
    v_add_u32 v22, 88320, v12
    buffer_store_dwordx2 v[20:21], v22, s[20:23], 0 offen
    v_mov_b32 v24, v140
    v_mov_b32 v25, v141
    v_mov_b32 v26, v142
    v_mov_b32 v27, v143
    s_nop 1
    v_permlane32_swap_b32 v140, v24
    v_permlane32_swap_b32 v141, v25
    v_permlane32_swap_b32 v142, v26
    v_permlane32_swap_b32 v143, v27
    s_nop 1
    v_cvt_pk_bf16_f32 v16, v140, v141
    v_lshlrev_b32 v140, 16, v16
    v_and_b32 v141, 0xffff0000, v16
    v_cvt_pk_bf16_f32 v16, v24, v25
    v_lshlrev_b32 v24, 16, v16
    v_and_b32 v25, 0xffff0000, v16
    v_cvt_pk_bf16_f32 v16, v142, v143
    v_lshlrev_b32 v142, 16, v16
    v_and_b32 v143, 0xffff0000, v16
    v_cvt_pk_bf16_f32 v16, v26, v27
    v_lshlrev_b32 v26, 16, v16
    v_and_b32 v27, 0xffff0000, v16
    v_mul_f32 v17, 0xbfb8aa3b, v140
    v_exp_f32 v17, v17
    s_nop 0
    v_add_f32 v17, 1.0, v17
    v_rcp_f32 v17, v17
    s_nop 0
    v_mul_f32 v140, v140, v17
    v_mul_f32 v17, 0xbfb8aa3b, v141
    v_exp_f32 v17, v17
    s_nop 0
    v_add_f32 v17, 1.0, v17
    v_rcp_f32 v17, v17
    s_nop 0
    v_mul_f32 v141, v141, v17
    v_mul_f32 v17, 0xbfb8aa3b, v142
    v_exp_f32 v17, v17
    s_nop 0
    v_add_f32 v17, 1.0, v17
    v_rcp_f32 v17, v17
    s_nop 0
    v_mul_f32 v142, v142, v17
    v_mul_f32 v17, 0xbfb8aa3b, v143
    v_exp_f32 v17, v17
    s_nop 0
    v_add_f32 v17, 1.0, v17
    v_rcp_f32 v17, v17
    s_nop 0
    v_mul_f32 v143, v143, v17
    v_cvt_pk_bf16_f32 v16, v140, v141
    v_lshlrev_b32 v140, 16, v16
    v_and_b32 v141, 0xffff0000, v16
    v_cvt_pk_bf16_f32 v16, v142, v143
    v_lshlrev_b32 v142, 16, v16
    v_and_b32 v143, 0xffff0000, v16
    v_mul_f32 v140, v140, v24
    v_mul_f32 v141, v141, v25
    v_mul_f32 v142, v142, v26
    v_mul_f32 v143, v143, v27
    v_cvt_pk_bf16_f32 v20, v140, v141
    v_cvt_pk_bf16_f32 v21, v142, v143
    v_add_u32 v22, 88320, v13
    buffer_store_dwordx2 v[20:21], v22, s[20:23], 0 offen
    s_nop 1
    v_cvt_pk_bf16_f32 v16, v80, v81
    v_lshlrev_b32 v80, 16, v16
    v_and_b32 v81, 0xffff0000, v16
    v_cvt_pk_bf16_f32 v16, v112, v113
    v_lshlrev_b32 v112, 16, v16
    v_and_b32 v113, 0xffff0000, v16
    v_cvt_pk_bf16_f32 v16, v82, v83
    v_lshlrev_b32 v82, 16, v16
    v_and_b32 v83, 0xffff0000, v16
    v_cvt_pk_bf16_f32 v16, v114, v115
    v_lshlrev_b32 v114, 16, v16
    v_and_b32 v115, 0xffff0000, v16
    v_mul_f32 v17, 0xbfb8aa3b, v80
    v_exp_f32 v17, v17
    s_nop 0
    v_add_f32 v17, 1.0, v17
    v_rcp_f32 v17, v17
    s_nop 0
    v_mul_f32 v80, v80, v17
    v_mul_f32 v17, 0xbfb8aa3b, v81
    v_exp_f32 v17, v17
    s_nop 0
    v_add_f32 v17, 1.0, v17
    v_rcp_f32 v17, v17
    s_nop 0
    v_mul_f32 v81, v81, v17
    v_mul_f32 v17, 0xbfb8aa3b, v82
    v_exp_f32 v17, v17
    s_nop 0
    v_add_f32 v17, 1.0, v17
    v_rcp_f32 v17, v17
    s_nop 0
    v_mul_f32 v82, v82, v17
    v_mul_f32 v17, 0xbfb8aa3b, v83
    v_exp_f32 v17, v17
    s_nop 0
    v_add_f32 v17, 1.0, v17
    v_rcp_f32 v17, v17
    s_nop 0
    v_mul_f32 v83, v83, v17
    v_cvt_pk_bf16_f32 v16, v80, v81
    v_lshlrev_b32 v80, 16, v16
    v_and_b32 v81, 0xffff0000, v16
    v_cvt_pk_bf16_f32 v16, v82, v83
    v_lshlrev_b32 v82, 16, v16
    v_and_b32 v83, 0xffff0000, v16
    v_mul_f32 v80, v80, v112
    v_mul_f32 v81, v81, v113
    v_mul_f32 v82, v82, v114
    v_mul_f32 v83, v83, v115
    v_cvt_pk_bf16_f32 v20, v80, v81
    v_cvt_pk_bf16_f32 v21, v82, v83
    v_add_u32 v22, 176128, v12
    buffer_store_dwordx2 v[20:21], v22, s[20:23], 0 offen
    v_mov_b32 v24, v144
    v_mov_b32 v25, v145
    v_mov_b32 v26, v146
    v_mov_b32 v27, v147
    s_nop 1
    v_permlane32_swap_b32 v144, v24
    v_permlane32_swap_b32 v145, v25
    v_permlane32_swap_b32 v146, v26
    v_permlane32_swap_b32 v147, v27
    s_nop 1
    v_cvt_pk_bf16_f32 v16, v144, v145
    v_lshlrev_b32 v144, 16, v16
    v_and_b32 v145, 0xffff0000, v16
    v_cvt_pk_bf16_f32 v16, v24, v25
    v_lshlrev_b32 v24, 16, v16
    v_and_b32 v25, 0xffff0000, v16
    v_cvt_pk_bf16_f32 v16, v146, v147
    v_lshlrev_b32 v146, 16, v16
    v_and_b32 v147, 0xffff0000, v16
    v_cvt_pk_bf16_f32 v16, v26, v27
    v_lshlrev_b32 v26, 16, v16
    v_and_b32 v27, 0xffff0000, v16
    v_mul_f32 v17, 0xbfb8aa3b, v144
    v_exp_f32 v17, v17
    s_nop 0
    v_add_f32 v17, 1.0, v17
    v_rcp_f32 v17, v17
    s_nop 0
    v_mul_f32 v144, v144, v17
    v_mul_f32 v17, 0xbfb8aa3b, v145
    v_exp_f32 v17, v17
    s_nop 0
    v_add_f32 v17, 1.0, v17
    v_rcp_f32 v17, v17
    s_nop 0
    v_mul_f32 v145, v145, v17
    v_mul_f32 v17, 0xbfb8aa3b, v146
    v_exp_f32 v17, v17
    s_nop 0
    v_add_f32 v17, 1.0, v17
    v_rcp_f32 v17, v17
    s_nop 0
    v_mul_f32 v146, v146, v17
    v_mul_f32 v17, 0xbfb8aa3b, v147
    v_exp_f32 v17, v17
    s_nop 0
    v_add_f32 v17, 1.0, v17
    v_rcp_f32 v17, v17
    s_nop 0
    v_mul_f32 v147, v147, v17
    v_cvt_pk_bf16_f32 v16, v144, v145
    v_lshlrev_b32 v144, 16, v16
    v_and_b32 v145, 0xffff0000, v16
    v_cvt_pk_bf16_f32 v16, v146, v147
    v_lshlrev_b32 v146, 16, v16
    v_and_b32 v147, 0xffff0000, v16
    v_mul_f32 v144, v144, v24
    v_mul_f32 v145, v145, v25
    v_mul_f32 v146, v146, v26
    v_mul_f32 v147, v147, v27
    v_cvt_pk_bf16_f32 v20, v144, v145
    v_cvt_pk_bf16_f32 v21, v146, v147
    v_add_u32 v22, 176128, v13
    buffer_store_dwordx2 v[20:21], v22, s[20:23], 0 offen
    s_nop 1
    v_cvt_pk_bf16_f32 v16, v84, v85
    v_lshlrev_b32 v84, 16, v16
    v_and_b32 v85, 0xffff0000, v16
    v_cvt_pk_bf16_f32 v16, v116, v117
    v_lshlrev_b32 v116, 16, v16
    v_and_b32 v117, 0xffff0000, v16
    v_cvt_pk_bf16_f32 v16, v86, v87
    v_lshlrev_b32 v86, 16, v16
    v_and_b32 v87, 0xffff0000, v16
    v_cvt_pk_bf16_f32 v16, v118, v119
    v_lshlrev_b32 v118, 16, v16
    v_and_b32 v119, 0xffff0000, v16
    v_mul_f32 v17, 0xbfb8aa3b, v84
    v_exp_f32 v17, v17
    s_nop 0
    v_add_f32 v17, 1.0, v17
    v_rcp_f32 v17, v17
    s_nop 0
    v_mul_f32 v84, v84, v17
    v_mul_f32 v17, 0xbfb8aa3b, v85
    v_exp_f32 v17, v17
    s_nop 0
    v_add_f32 v17, 1.0, v17
    v_rcp_f32 v17, v17
    s_nop 0
    v_mul_f32 v85, v85, v17
    v_mul_f32 v17, 0xbfb8aa3b, v86
    v_exp_f32 v17, v17
    s_nop 0
    v_add_f32 v17, 1.0, v17
    v_rcp_f32 v17, v17
    s_nop 0
    v_mul_f32 v86, v86, v17
    v_mul_f32 v17, 0xbfb8aa3b, v87
    v_exp_f32 v17, v17
    s_nop 0
    v_add_f32 v17, 1.0, v17
    v_rcp_f32 v17, v17
    s_nop 0
    v_mul_f32 v87, v87, v17
    v_cvt_pk_bf16_f32 v16, v84, v85
    v_lshlrev_b32 v84, 16, v16
    v_and_b32 v85, 0xffff0000, v16
    v_cvt_pk_bf16_f32 v16, v86, v87
    v_lshlrev_b32 v86, 16, v16
    v_and_b32 v87, 0xffff0000, v16
    v_mul_f32 v84, v84, v116
    v_mul_f32 v85, v85, v117
    v_mul_f32 v86, v86, v118
    v_mul_f32 v87, v87, v119
    v_cvt_pk_bf16_f32 v20, v84, v85
    v_cvt_pk_bf16_f32 v21, v86, v87
    v_add_u32 v22, 176384, v12
    buffer_store_dwordx2 v[20:21], v22, s[20:23], 0 offen
    v_mov_b32 v24, v148
    v_mov_b32 v25, v149
    v_mov_b32 v26, v150
    v_mov_b32 v27, v151
    s_nop 1
    v_permlane32_swap_b32 v148, v24
    v_permlane32_swap_b32 v149, v25
    v_permlane32_swap_b32 v150, v26
    v_permlane32_swap_b32 v151, v27
    s_nop 1
    v_cvt_pk_bf16_f32 v16, v148, v149
    v_lshlrev_b32 v148, 16, v16
    v_and_b32 v149, 0xffff0000, v16
    v_cvt_pk_bf16_f32 v16, v24, v25
    v_lshlrev_b32 v24, 16, v16
    v_and_b32 v25, 0xffff0000, v16
    v_cvt_pk_bf16_f32 v16, v150, v151
    v_lshlrev_b32 v150, 16, v16
    v_and_b32 v151, 0xffff0000, v16
    v_cvt_pk_bf16_f32 v16, v26, v27
    v_lshlrev_b32 v26, 16, v16
    v_and_b32 v27, 0xffff0000, v16
    v_mul_f32 v17, 0xbfb8aa3b, v148
    v_exp_f32 v17, v17
    s_nop 0
    v_add_f32 v17, 1.0, v17
    v_rcp_f32 v17, v17
    s_nop 0
    v_mul_f32 v148, v148, v17
    v_mul_f32 v17, 0xbfb8aa3b, v149
    v_exp_f32 v17, v17
    s_nop 0
    v_add_f32 v17, 1.0, v17
    v_rcp_f32 v17, v17
    s_nop 0
    v_mul_f32 v149, v149, v17
    v_mul_f32 v17, 0xbfb8aa3b, v150
    v_exp_f32 v17, v17
    s_nop 0
    v_add_f32 v17, 1.0, v17
    v_rcp_f32 v17, v17
    s_nop 0
    v_mul_f32 v150, v150, v17
    v_mul_f32 v17, 0xbfb8aa3b, v151
    v_exp_f32 v17, v17
    s_nop 0
    v_add_f32 v17, 1.0, v17
    v_rcp_f32 v17, v17
    s_nop 0
    v_mul_f32 v151, v151, v17
    v_cvt_pk_bf16_f32 v16, v148, v149
    v_lshlrev_b32 v148, 16, v16
    v_and_b32 v149, 0xffff0000, v16
    v_cvt_pk_bf16_f32 v16, v150, v151
    v_lshlrev_b32 v150, 16, v16
    v_and_b32 v151, 0xffff0000, v16
    v_mul_f32 v148, v148, v24
    v_mul_f32 v149, v149, v25
    v_mul_f32 v150, v150, v26
    v_mul_f32 v151, v151, v27
    v_cvt_pk_bf16_f32 v20, v148, v149
    v_cvt_pk_bf16_f32 v21, v150, v151
    v_add_u32 v22, 176384, v13
    buffer_store_dwordx2 v[20:21], v22, s[20:23], 0 offen
    s_nop 1
    v_cvt_pk_bf16_f32 v16, v88, v89
    v_lshlrev_b32 v88, 16, v16
    v_and_b32 v89, 0xffff0000, v16
    v_cvt_pk_bf16_f32 v16, v120, v121
    v_lshlrev_b32 v120, 16, v16
    v_and_b32 v121, 0xffff0000, v16
    v_cvt_pk_bf16_f32 v16, v90, v91
    v_lshlrev_b32 v90, 16, v16
    v_and_b32 v91, 0xffff0000, v16
    v_cvt_pk_bf16_f32 v16, v122, v123
    v_lshlrev_b32 v122, 16, v16
    v_and_b32 v123, 0xffff0000, v16
    v_mul_f32 v17, 0xbfb8aa3b, v88
    v_exp_f32 v17, v17
    s_nop 0
    v_add_f32 v17, 1.0, v17
    v_rcp_f32 v17, v17
    s_nop 0
    v_mul_f32 v88, v88, v17
    v_mul_f32 v17, 0xbfb8aa3b, v89
    v_exp_f32 v17, v17
    s_nop 0
    v_add_f32 v17, 1.0, v17
    v_rcp_f32 v17, v17
    s_nop 0
    v_mul_f32 v89, v89, v17
    v_mul_f32 v17, 0xbfb8aa3b, v90
    v_exp_f32 v17, v17
    s_nop 0
    v_add_f32 v17, 1.0, v17
    v_rcp_f32 v17, v17
    s_nop 0
    v_mul_f32 v90, v90, v17
    v_mul_f32 v17, 0xbfb8aa3b, v91
    v_exp_f32 v17, v17
    s_nop 0
    v_add_f32 v17, 1.0, v17
    v_rcp_f32 v17, v17
    s_nop 0
    v_mul_f32 v91, v91, v17
    v_cvt_pk_bf16_f32 v16, v88, v89
    v_lshlrev_b32 v88, 16, v16
    v_and_b32 v89, 0xffff0000, v16
    v_cvt_pk_bf16_f32 v16, v90, v91
    v_lshlrev_b32 v90, 16, v16
    v_and_b32 v91, 0xffff0000, v16
    v_mul_f32 v88, v88, v120
    v_mul_f32 v89, v89, v121
    v_mul_f32 v90, v90, v122
    v_mul_f32 v91, v91, v123
    v_cvt_pk_bf16_f32 v20, v88, v89
    v_cvt_pk_bf16_f32 v21, v90, v91
    v_add_u32 v22, 264192, v12
    buffer_store_dwordx2 v[20:21], v22, s[20:23], 0 offen
    v_mov_b32 v24, v152
    v_mov_b32 v25, v153
    v_mov_b32 v26, v154
    v_mov_b32 v27, v155
    s_nop 1
    v_permlane32_swap_b32 v152, v24
    v_permlane32_swap_b32 v153, v25
    v_permlane32_swap_b32 v154, v26
    v_permlane32_swap_b32 v155, v27
    s_nop 1
    v_cvt_pk_bf16_f32 v16, v152, v153
    v_lshlrev_b32 v152, 16, v16
    v_and_b32 v153, 0xffff0000, v16
    v_cvt_pk_bf16_f32 v16, v24, v25
    v_lshlrev_b32 v24, 16, v16
    v_and_b32 v25, 0xffff0000, v16
    v_cvt_pk_bf16_f32 v16, v154, v155
    v_lshlrev_b32 v154, 16, v16
    v_and_b32 v155, 0xffff0000, v16
    v_cvt_pk_bf16_f32 v16, v26, v27
    v_lshlrev_b32 v26, 16, v16
    v_and_b32 v27, 0xffff0000, v16
    v_mul_f32 v17, 0xbfb8aa3b, v152
    v_exp_f32 v17, v17
    s_nop 0
    v_add_f32 v17, 1.0, v17
    v_rcp_f32 v17, v17
    s_nop 0
    v_mul_f32 v152, v152, v17
    v_mul_f32 v17, 0xbfb8aa3b, v153
    v_exp_f32 v17, v17
    s_nop 0
    v_add_f32 v17, 1.0, v17
    v_rcp_f32 v17, v17
    s_nop 0
    v_mul_f32 v153, v153, v17
    v_mul_f32 v17, 0xbfb8aa3b, v154
    v_exp_f32 v17, v17
    s_nop 0
    v_add_f32 v17, 1.0, v17
    v_rcp_f32 v17, v17
    s_nop 0
    v_mul_f32 v154, v154, v17
    v_mul_f32 v17, 0xbfb8aa3b, v155
    v_exp_f32 v17, v17
    s_nop 0
    v_add_f32 v17, 1.0, v17
    v_rcp_f32 v17, v17
    s_nop 0
    v_mul_f32 v155, v155, v17
    v_cvt_pk_bf16_f32 v16, v152, v153
    v_lshlrev_b32 v152, 16, v16
    v_and_b32 v153, 0xffff0000, v16
    v_cvt_pk_bf16_f32 v16, v154, v155
    v_lshlrev_b32 v154, 16, v16
    v_and_b32 v155, 0xffff0000, v16
    v_mul_f32 v152, v152, v24
    v_mul_f32 v153, v153, v25
    v_mul_f32 v154, v154, v26
    v_mul_f32 v155, v155, v27
    v_cvt_pk_bf16_f32 v20, v152, v153
    v_cvt_pk_bf16_f32 v21, v154, v155
    v_add_u32 v22, 264192, v13
    buffer_store_dwordx2 v[20:21], v22, s[20:23], 0 offen
    s_nop 1
    v_cvt_pk_bf16_f32 v16, v92, v93
    v_lshlrev_b32 v92, 16, v16
    v_and_b32 v93, 0xffff0000, v16
    v_cvt_pk_bf16_f32 v16, v124, v125
    v_lshlrev_b32 v124, 16, v16
    v_and_b32 v125, 0xffff0000, v16
    v_cvt_pk_bf16_f32 v16, v94, v95
    v_lshlrev_b32 v94, 16, v16
    v_and_b32 v95, 0xffff0000, v16
    v_cvt_pk_bf16_f32 v16, v126, v127
    v_lshlrev_b32 v126, 16, v16
    v_and_b32 v127, 0xffff0000, v16
    v_mul_f32 v17, 0xbfb8aa3b, v92
    v_exp_f32 v17, v17
    s_nop 0
    v_add_f32 v17, 1.0, v17
    v_rcp_f32 v17, v17
    s_nop 0
    v_mul_f32 v92, v92, v17
    v_mul_f32 v17, 0xbfb8aa3b, v93
    v_exp_f32 v17, v17
    s_nop 0
    v_add_f32 v17, 1.0, v17
    v_rcp_f32 v17, v17
    s_nop 0
    v_mul_f32 v93, v93, v17
    v_mul_f32 v17, 0xbfb8aa3b, v94
    v_exp_f32 v17, v17
    s_nop 0
    v_add_f32 v17, 1.0, v17
    v_rcp_f32 v17, v17
    s_nop 0
    v_mul_f32 v94, v94, v17
    v_mul_f32 v17, 0xbfb8aa3b, v95
    v_exp_f32 v17, v17
    s_nop 0
    v_add_f32 v17, 1.0, v17
    v_rcp_f32 v17, v17
    s_nop 0
    v_mul_f32 v95, v95, v17
    v_cvt_pk_bf16_f32 v16, v92, v93
    v_lshlrev_b32 v92, 16, v16
    v_and_b32 v93, 0xffff0000, v16
    v_cvt_pk_bf16_f32 v16, v94, v95
    v_lshlrev_b32 v94, 16, v16
    v_and_b32 v95, 0xffff0000, v16
    v_mul_f32 v92, v92, v124
    v_mul_f32 v93, v93, v125
    v_mul_f32 v94, v94, v126
    v_mul_f32 v95, v95, v127
    v_cvt_pk_bf16_f32 v20, v92, v93
    v_cvt_pk_bf16_f32 v21, v94, v95
    v_add_u32 v22, 264448, v12
    buffer_store_dwordx2 v[20:21], v22, s[20:23], 0 offen
    v_mov_b32 v24, v156
    v_mov_b32 v25, v157
    v_mov_b32 v26, v158
    v_mov_b32 v27, v159
    s_nop 1
    v_permlane32_swap_b32 v156, v24
    v_permlane32_swap_b32 v157, v25
    v_permlane32_swap_b32 v158, v26
    v_permlane32_swap_b32 v159, v27
    s_nop 1
    v_cvt_pk_bf16_f32 v16, v156, v157
    v_lshlrev_b32 v156, 16, v16
    v_and_b32 v157, 0xffff0000, v16
    v_cvt_pk_bf16_f32 v16, v24, v25
    v_lshlrev_b32 v24, 16, v16
    v_and_b32 v25, 0xffff0000, v16
    v_cvt_pk_bf16_f32 v16, v158, v159
    v_lshlrev_b32 v158, 16, v16
    v_and_b32 v159, 0xffff0000, v16
    v_cvt_pk_bf16_f32 v16, v26, v27
    v_lshlrev_b32 v26, 16, v16
    v_and_b32 v27, 0xffff0000, v16
    v_mul_f32 v17, 0xbfb8aa3b, v156
    v_exp_f32 v17, v17
    s_nop 0
    v_add_f32 v17, 1.0, v17
    v_rcp_f32 v17, v17
    s_nop 0
    v_mul_f32 v156, v156, v17
    v_mul_f32 v17, 0xbfb8aa3b, v157
    v_exp_f32 v17, v17
    s_nop 0
    v_add_f32 v17, 1.0, v17
    v_rcp_f32 v17, v17
    s_nop 0
    v_mul_f32 v157, v157, v17
    v_mul_f32 v17, 0xbfb8aa3b, v158
    v_exp_f32 v17, v17
    s_nop 0
    v_add_f32 v17, 1.0, v17
    v_rcp_f32 v17, v17
    s_nop 0
    v_mul_f32 v158, v158, v17
    v_mul_f32 v17, 0xbfb8aa3b, v159
    v_exp_f32 v17, v17
    s_nop 0
    v_add_f32 v17, 1.0, v17
    v_rcp_f32 v17, v17
    s_nop 0
    v_mul_f32 v159, v159, v17
    v_cvt_pk_bf16_f32 v16, v156, v157
    v_lshlrev_b32 v156, 16, v16
    v_and_b32 v157, 0xffff0000, v16
    v_cvt_pk_bf16_f32 v16, v158, v159
    v_lshlrev_b32 v158, 16, v16
    v_and_b32 v159, 0xffff0000, v16
    v_mul_f32 v156, v156, v24
    v_mul_f32 v157, v157, v25
    v_mul_f32 v158, v158, v26
    v_mul_f32 v159, v159, v27
    v_cvt_pk_bf16_f32 v20, v156, v157
    v_cvt_pk_bf16_f32 v21, v158, v159
    v_add_u32 v22, 264448, v13
    buffer_store_dwordx2 v[20:21], v22, s[20:23], 0 offen
    s_nop 1
    s_waitcnt vmcnt(0)
L_ffn1a_kernel_done:
    s_endpgm
.globl ffn2a_kernel
.p2align 8
.type ffn2a_kernel,@function
ffn2a_kernel:
    s_cmp_ge_u32 s2, 256
    s_cbranch_scc1 L_ffn2a_kernel_done
    s_load_dwordx2 s[4:5], s[0:1], 80
    s_load_dwordx2 s[8:9], s[0:1], 96
    s_lshr_b32 s25, s2, 3
    s_and_b32 s26, s2, 7
    s_waitcnt lgkmcnt(0)
    s_mov_b32 s20, s8
    s_mov_b32 s21, s9
    s_mov_b32 s22, 25165824
    s_mov_b32 s23, 0x00020000
    s_mov_b32 s12, s8
    s_mov_b32 s13, s9
    s_mov_b32 s14, 25165824
    s_mov_b32 s15, 0x00020000
    v_lshrrev_b32 v1, 6, v0
    s_nop 0
    v_readfirstlane_b32 s27, v1
    v_and_b32 v1, 63, v0
    s_nop 2
    s_mul_i32 s28, s27, 22
    s_cmp_eq_u32 s27, 3
    s_cselect_b32 s29, 1, 0
    s_sub_u32 s28, s28, s29
    s_cmp_ge_u32 s27, 2
    s_cselect_b32 s29, 21, 22
    s_lshl_b32 s30, s25, 1
    s_mul_i32 s30, s30, 86
    s_add_u32 s30, s30, s28
    s_lshl_b32 s30, s30, 10
    s_add_u32 s30, s30, 10485760
    v_lshl_add_u32 v2, v1, 4, s30
    v_add_u32 v3, 88064, v2
    s_lshl_b32 s30, s26, 1
    s_mul_i32 s30, s30, 86
    s_add_u32 s30, s30, s28
    s_lshl_b32 s30, s30, 10
    s_add_u32 s30, s30, 20971520
    v_lshl_add_u32 v4, v1, 4, s30
    v_add_u32 v5, 88064, v4
    v_mov_b32 v64, 0
    v_mov_b32 v65, 0
    v_mov_b32 v66, 0
    v_mov_b32 v67, 0
    v_mov_b32 v68, 0
    v_mov_b32 v69, 0
    v_mov_b32 v70, 0
    v_mov_b32 v71, 0
    v_mov_b32 v72, 0
    v_mov_b32 v73, 0
    v_mov_b32 v74, 0
    v_mov_b32 v75, 0
    v_mov_b32 v76, 0
    v_mov_b32 v77, 0
    v_mov_b32 v78, 0
    v_mov_b32 v79, 0
    v_mov_b32 v80, 0
    v_mov_b32 v81, 0
    v_mov_b32 v82, 0
    v_mov_b32 v83, 0
    v_mov_b32 v84, 0
    v_mov_b32 v85, 0
    v_mov_b32 v86, 0
    v_mov_b32 v87, 0
    v_mov_b32 v88, 0
    v_mov_b32 v89, 0
    v_mov_b32 v90, 0
    v_mov_b32 v91, 0
    v_mov_b32 v92, 0
    v_mov_b32 v93, 0
    v_mov_b32 v94, 0
    v_mov_b32 v95, 0
    v_mov_b32 v96, 0
    v_mov_b32 v97, 0
    v_mov_b32 v98, 0
    v_mov_b32 v99, 0
    v_mov_b32 v100, 0
    v_mov_b32 v101, 0
    v_mov_b32 v102, 0
    v_mov_b32 v103, 0
    v_mov_b32 v104, 0
    v_mov_b32 v105, 0
    v_mov_b32 v106, 0
    v_mov_b32 v107, 0
    v_mov_b32 v108, 0
    v_mov_b32 v109, 0
    v_mov_b32 v110, 0
    v_mov_b32 v111, 0
    v_mov_b32 v112, 0
    v_mov_b32 v113, 0
    v_mov_b32 v114, 0
    v_mov_b32 v115, 0
    v_mov_b32 v116, 0
    v_mov_b32 v117, 0
    v_mov_b32 v118, 0
    v_mov_b32 v119, 0
    v_mov_b32 v120, 0
    v_mov_b32 v121, 0
    v_mov_b32 v122, 0
    v_mov_b32 v123, 0
    v_mov_b32 v124, 0
    v_mov_b32 v125, 0
    v_mov_b32 v126, 0
    v_mov_b32 v127, 0
    buffer_load_dwordx4 v[128:131], v2, s[20:23], 0 offen offset:0
    buffer_load_dwordx4 v[132:135], v3, s[20:23], 0 offen offset:0
    buffer_load_dwordx4 v[136:139], v4, s[20:23], 0 offen offset:0
    buffer_load_dwordx4 v[140:143], v5, s[20:23], 0 offen offset:0
    buffer_load_dwordx4 v[144:147], v2, s[20:23], 0 offen offset:1024
    buffer_load_dwordx4 v[148:151], v3, s[20:23], 0 offen offset:1024
    buffer_load_dwordx4 v[152:155], v4, s[20:23], 0 offen offset:1024
    buffer_load_dwordx4 v[156:159], v5, s[20:23], 0 offen offset:1024
    buffer_load_dwordx4 v[160:163], v2, s[20:23], 0 offen offset:2048
    buffer_load_dwordx4 v[164:167], v3, s[20:23], 0 offen offset:2048
    buffer_load_dwordx4 v[168:171], v4, s[20:23], 0 offen offset:2048
    buffer_load_dwordx4 v[172:175], v5, s[20:23], 0 offen offset:2048
    buffer_load_dwordx4 v[176:179], v2, s[20:23], 0 offen offset:3072
    buffer_load_dwordx4 v[180:183], v3, s[20:23], 0 offen offset:3072
    buffer_load_dwordx4 v[184:187], v4, s[20:23], 0 offen offset:3072
    buffer_load_dwordx4 v[188:191], v5, s[20:23], 0 offen offset:3072
    v_add_u32 v2, 4096, v2
    v_add_u32 v3, 4096, v3
    v_add_u32 v4, 4096, v4
    v_add_u32 v5, 4096, v5
    buffer_load_dwordx4 v[192:195], v2, s[20:23], 0 offen offset:0
    buffer_load_dwordx4 v[196:199], v3, s[20:23], 0 offen offset:0
    buffer_load_dwordx4 v[200:203], v4, s[20:23], 0 offen offset:0
    buffer_load_dwordx4 v[204:207], v5, s[20:23], 0 offen offset:0
    s_waitcnt vmcnt(16)
    v_mfma_f32_32x32x16_bf16 v[64:79], v[136:139], v[128:131], v[64:79]
    v_mfma_f32_32x32x16_bf16 v[80:95], v[136:139], v[132:135], v[80:95]
    v_mfma_f32_32x32x16_bf16 v[96:111], v[140:143], v[128:131], v[96:111]
    v_mfma_f32_32x32x16_bf16 v[112:127], v[140:143], v[132:135], v[112:127]
    buffer_load_dwordx4 v[128:131], v2, s[20:23], 0 offen offset:1024
    buffer_load_dwordx4 v[132:135], v3, s[20:23], 0 offen offset:1024
    buffer_load_dwordx4 v[136:139], v4, s[20:23], 0 offen offset:1024
    buffer_load_dwordx4 v[140:143], v5, s[20:23], 0 offen offset:1024
    s_waitcnt vmcnt(16)
    v_mfma_f32_32x32x16_bf16 v[64:79], v[152:155], v[144:147], v[64:79]
    v_mfma_f32_32x32x16_bf16 v[80:95], v[152:155], v[148:151], v[80:95]
    v_mfma_f32_32x32x16_bf16 v[96:111], v[156:159], v[144:147], v[96:111]
    v_mfma_f32_32x32x16_bf16 v[112:127], v[156:159], v[148:151], v[112:127]
    buffer_load_dwordx4 v[144:147], v2, s[20:23], 0 offen offset:2048
    buffer_load_dwordx4 v[148:151], v3, s[20:23], 0 offen offset:2048
    buffer_load_dwordx4 v[152:155], v4, s[20:23], 0 offen offset:2048
    buffer_load_dwordx4 v[156:159], v5, s[20:23], 0 offen offset:2048
    s_waitcnt vmcnt(16)
    v_mfma_f32_32x32x16_bf16 v[64:79], v[168:171], v[160:163], v[64:79]
    v_mfma_f32_32x32x16_bf16 v[80:95], v[168:171], v[164:167], v[80:95]
    v_mfma_f32_32x32x16_bf16 v[96:111], v[172:175], v[160:163], v[96:111]
    v_mfma_f32_32x32x16_bf16 v[112:127], v[172:175], v[164:167], v[112:127]
    buffer_load_dwordx4 v[160:163], v2, s[20:23], 0 offen offset:3072
    buffer_load_dwordx4 v[164:167], v3, s[20:23], 0 offen offset:3072
    buffer_load_dwordx4 v[168:171], v4, s[20:23], 0 offen offset:3072
    buffer_load_dwordx4 v[172:175], v5, s[20:23], 0 offen offset:3072
    v_add_u32 v2, 4096, v2
    v_add_u32 v3, 4096, v3
    v_add_u32 v4, 4096, v4
    v_add_u32 v5, 4096, v5
    s_waitcnt vmcnt(16)
    v_mfma_f32_32x32x16_bf16 v[64:79], v[184:187], v[176:179], v[64:79]
    v_mfma_f32_32x32x16_bf16 v[80:95], v[184:187], v[180:183], v[80:95]
    v_mfma_f32_32x32x16_bf16 v[96:111], v[188:191], v[176:179], v[96:111]
    v_mfma_f32_32x32x16_bf16 v[112:127], v[188:191], v[180:183], v[112:127]
    buffer_load_dwordx4 v[176:179], v2, s[20:23], 0 offen offset:0
    buffer_load_dwordx4 v[180:183], v3, s[20:23], 0 offen offset:0
    buffer_load_dwordx4 v[184:187], v4, s[20:23], 0 offen offset:0
    buffer_load_dwordx4 v[188:191], v5, s[20:23], 0 offen offset:0
    s_waitcnt vmcnt(16)
    v_mfma_f32_32x32x16_bf16 v[64:79], v[200:203], v[192:195], v[64:79]
    v_mfma_f32_32x32x16_bf16 v[80:95], v[200:203], v[196:199], v[80:95]
    v_mfma_f32_32x32x16_bf16 v[96:111], v[204:207], v[192:195], v[96:111]
    v_mfma_f32_32x32x16_bf16 v[112:127], v[204:207], v[196:199], v[112:127]
    buffer_load_dwordx4 v[192:195], v2, s[20:23], 0 offen offset:1024
    buffer_load_dwordx4 v[196:199], v3, s[20:23], 0 offen offset:1024
    buffer_load_dwordx4 v[200:203], v4, s[20:23], 0 offen offset:1024
    buffer_load_dwordx4 v[204:207], v5, s[20:23], 0 offen offset:1024
    s_waitcnt vmcnt(16)
    v_mfma_f32_32x32x16_bf16 v[64:79], v[136:139], v[128:131], v[64:79]
    v_mfma_f32_32x32x16_bf16 v[80:95], v[136:139], v[132:135], v[80:95]
    v_mfma_f32_32x32x16_bf16 v[96:111], v[140:143], v[128:131], v[96:111]
    v_mfma_f32_32x32x16_bf16 v[112:127], v[140:143], v[132:135], v[112:127]
    buffer_load_dwordx4 v[128:131], v2, s[20:23], 0 offen offset:2048
    buffer_load_dwordx4 v[132:135], v3, s[20:23], 0 offen offset:2048
    buffer_load_dwordx4 v[136:139], v4, s[20:23], 0 offen offset:2048
    buffer_load_dwordx4 v[140:143], v5, s[20:23], 0 offen offset:2048
    s_waitcnt vmcnt(16)
    v_mfma_f32_32x32x16_bf16 v[64:79], v[152:155], v[144:147], v[64:79]
    v_mfma_f32_32x32x16_bf16 v[80:95], v[152:155], v[148:151], v[80:95]
    v_mfma_f32_32x32x16_bf16 v[96:111], v[156:159], v[144:147], v[96:111]
    v_mfma_f32_32x32x16_bf16 v[112:127], v[156:159], v[148:151], v[112:127]
    buffer_load_dwordx4 v[144:147], v2, s[20:23], 0 offen offset:3072
    buffer_load_dwordx4 v[148:151], v3, s[20:23], 0 offen offset:3072
    buffer_load_dwordx4 v[152:155], v4, s[20:23], 0 offen offset:3072
    buffer_load_dwordx4 v[156:159], v5, s[20:23], 0 offen offset:3072
    v_add_u32 v2, 4096, v2
    v_add_u32 v3, 4096, v3
    v_add_u32 v4, 4096, v4
    v_add_u32 v5, 4096, v5
    s_waitcnt vmcnt(16)
    v_mfma_f32_32x32x16_bf16 v[64:79], v[168:171], v[160:163], v[64:79]
    v_mfma_f32_32x32x16_bf16 v[80:95], v[168:171], v[164:167], v[80:95]
    v_mfma_f32_32x32x16_bf16 v[96:111], v[172:175], v[160:163], v[96:111]
    v_mfma_f32_32x32x16_bf16 v[112:127], v[172:175], v[164:167], v[112:127]
    buffer_load_dwordx4 v[160:163], v2, s[20:23], 0 offen offset:0
    buffer_load_dwordx4 v[164:167], v3, s[20:23], 0 offen offset:0
    buffer_load_dwordx4 v[168:171], v4, s[20:23], 0 offen offset:0
    buffer_load_dwordx4 v[172:175], v5, s[20:23], 0 offen offset:0
    s_waitcnt vmcnt(16)
    v_mfma_f32_32x32x16_bf16 v[64:79], v[184:187], v[176:179], v[64:79]
    v_mfma_f32_32x32x16_bf16 v[80:95], v[184:187], v[180:183], v[80:95]
    v_mfma_f32_32x32x16_bf16 v[96:111], v[188:191], v[176:179], v[96:111]
    v_mfma_f32_32x32x16_bf16 v[112:127], v[188:191], v[180:183], v[112:127]
    buffer_load_dwordx4 v[176:179], v2, s[20:23], 0 offen offset:1024
    buffer_load_dwordx4 v[180:183], v3, s[20:23], 0 offen offset:1024
    buffer_load_dwordx4 v[184:187], v4, s[20:23], 0 offen offset:1024
    buffer_load_dwordx4 v[188:191], v5, s[20:23], 0 offen offset:1024
    s_waitcnt vmcnt(16)
    v_mfma_f32_32x32x16_bf16 v[64:79], v[200:203], v[192:195], v[64:79]
    v_mfma_f32_32x32x16_bf16 v[80:95], v[200:203], v[196:199], v[80:95]
    v_mfma_f32_32x32x16_bf16 v[96:111], v[204:207], v[192:195], v[96:111]
    v_mfma_f32_32x32x16_bf16 v[112:127], v[204:207], v[196:199], v[112:127]
    buffer_load_dwordx4 v[192:195], v2, s[20:23], 0 offen offset:2048
    buffer_load_dwordx4 v[196:199], v3, s[20:23], 0 offen offset:2048
    buffer_load_dwordx4 v[200:203], v4, s[20:23], 0 offen offset:2048
    buffer_load_dwordx4 v[204:207], v5, s[20:23], 0 offen offset:2048
    s_waitcnt vmcnt(16)
    v_mfma_f32_32x32x16_bf16 v[64:79], v[136:139], v[128:131], v[64:79]
    v_mfma_f32_32x32x16_bf16 v[80:95], v[136:139], v[132:135], v[80:95]
    v_mfma_f32_32x32x16_bf16 v[96:111], v[140:143], v[128:131], v[96:111]
    v_mfma_f32_32x32x16_bf16 v[112:127], v[140:143], v[132:135], v[112:127]
    buffer_load_dwordx4 v[128:131], v2, s[20:23], 0 offen offset:3072
    buffer_load_dwordx4 v[132:135], v3, s[20:23], 0 offen offset:3072
    buffer_load_dwordx4 v[136:139], v4, s[20:23], 0 offen offset:3072
    buffer_load_dwordx4 v[140:143], v5, s[20:23], 0 offen offset:3072
    v_add_u32 v2, 4096, v2
    v_add_u32 v3, 4096, v3
    v_add_u32 v4, 4096, v4
    v_add_u32 v5, 4096, v5
    s_waitcnt vmcnt(16)
    v_mfma_f32_32x32x16_bf16 v[64:79], v[152:155], v[144:147], v[64:79]
    v_mfma_f32_32x32x16_bf16 v[80:95], v[152:155], v[148:151], v[80:95]
    v_mfma_f32_32x32x16_bf16 v[96:111], v[156:159], v[144:147], v[96:111]
    v_mfma_f32_32x32x16_bf16 v[112:127], v[156:159], v[148:151], v[112:127]
    buffer_load_dwordx4 v[144:147], v2, s[20:23], 0 offen offset:0
    buffer_load_dwordx4 v[148:151], v3, s[20:23], 0 offen offset:0
    buffer_load_dwordx4 v[152:155], v4, s[20:23], 0 offen offset:0
    buffer_load_dwordx4 v[156:159], v5, s[20:23], 0 offen offset:0
    s_waitcnt vmcnt(16)
    v_mfma_f32_32x32x16_bf16 v[64:79], v[168:171], v[160:163], v[64:79]
    v_mfma_f32_32x32x16_bf16 v[80:95], v[168:171], v[164:167], v[80:95]
    v_mfma_f32_32x32x16_bf16 v[96:111], v[172:175], v[160:163], v[96:111]
    v_mfma_f32_32x32x16_bf16 v[112:127], v[172:175], v[164:167], v[112:127]
    buffer_load_dwordx4 v[160:163], v2, s[20:23], 0 offen offset:1024
    buffer_load_dwordx4 v[164:167], v3, s[20:23], 0 offen offset:1024
    buffer_load_dwordx4 v[168:171], v4, s[20:23], 0 offen offset:1024
    buffer_load_dwordx4 v[172:175], v5, s[20:23], 0 offen offset:1024
    s_waitcnt vmcnt(16)
    v_mfma_f32_32x32x16_bf16 v[64:79], v[184:187], v[176:179], v[64:79]
    v_mfma_f32_32x32x16_bf16 v[80:95], v[184:187], v[180:183], v[80:95]
    v_mfma_f32_32x32x16_bf16 v[96:111], v[188:191], v[176:179], v[96:111]
    v_mfma_f32_32x32x16_bf16 v[112:127], v[188:191], v[180:183], v[112:127]
    buffer_load_dwordx4 v[176:179], v2, s[20:23], 0 offen offset:2048
    buffer_load_dwordx4 v[180:183], v3, s[20:23], 0 offen offset:2048
    buffer_load_dwordx4 v[184:187], v4, s[20:23], 0 offen offset:2048
    buffer_load_dwordx4 v[188:191], v5, s[20:23], 0 offen offset:2048
    s_waitcnt vmcnt(16)
    v_mfma_f32_32x32x16_bf16 v[64:79], v[200:203], v[192:195], v[64:79]
    v_mfma_f32_32x32x16_bf16 v[80:95], v[200:203], v[196:199], v[80:95]
    v_mfma_f32_32x32x16_bf16 v[96:111], v[204:207], v[192:195], v[96:111]
    v_mfma_f32_32x32x16_bf16 v[112:127], v[204:207], v[196:199], v[112:127]
    buffer_load_dwordx4 v[192:195], v2, s[20:23], 0 offen offset:3072
    buffer_load_dwordx4 v[196:199], v3, s[20:23], 0 offen offset:3072
    buffer_load_dwordx4 v[200:203], v4, s[20:23], 0 offen offset:3072
    buffer_load_dwordx4 v[204:207], v5, s[20:23], 0 offen offset:3072
    v_add_u32 v2, 4096, v2
    v_add_u32 v3, 4096, v3
    v_add_u32 v4, 4096, v4
    v_add_u32 v5, 4096, v5
    s_waitcnt vmcnt(16)
    v_mfma_f32_32x32x16_bf16 v[64:79], v[136:139], v[128:131], v[64:79]
    v_mfma_f32_32x32x16_bf16 v[80:95], v[136:139], v[132:135], v[80:95]
    v_mfma_f32_32x32x16_bf16 v[96:111], v[140:143], v[128:131], v[96:111]
    v_mfma_f32_32x32x16_bf16 v[112:127], v[140:143], v[132:135], v[112:127]
    buffer_load_dwordx4 v[128:131], v2, s[20:23], 0 offen offset:0
    buffer_load_dwordx4 v[132:135], v3, s[20:23], 0 offen offset:0
    buffer_load_dwordx4 v[136:139], v4, s[20:23], 0 offen offset:0
    buffer_load_dwordx4 v[140:143], v5, s[20:23], 0 offen offset:0
    s_waitcnt vmcnt(16)
    v_mfma_f32_32x32x16_bf16 v[64:79], v[152:155], v[144:147], v[64:79]
    v_mfma_f32_32x32x16_bf16 v[80:95], v[152:155], v[148:151], v[80:95]
    v_mfma_f32_32x32x16_bf16 v[96:111], v[156:159], v[144:147], v[96:111]
    v_mfma_f32_32x32x16_bf16 v[112:127], v[156:159], v[148:151], v[112:127]
    buffer_load_dwordx4 v[144:147], v2, s[20:23], 0 offen offset:1024
    buffer_load_dwordx4 v[148:151], v3, s[20:23], 0 offen offset:1024
    buffer_load_dwordx4 v[152:155], v4, s[20:23], 0 offen offset:1024
    buffer_load_dwordx4 v[156:159], v5, s[20:23], 0 offen offset:1024
    s_waitcnt vmcnt(16)
    v_mfma_f32_32x32x16_bf16 v[64:79], v[168:171], v[160:163], v[64:79]
    v_mfma_f32_32x32x16_bf16 v[80:95], v[168:171], v[164:167], v[80:95]
    v_mfma_f32_32x32x16_bf16 v[96:111], v[172:175], v[160:163], v[96:111]
    v_mfma_f32_32x32x16_bf16 v[112:127], v[172:175], v[164:167], v[112:127]
    s_waitcnt vmcnt(12)
    v_mfma_f32_32x32x16_bf16 v[64:79], v[184:187], v[176:179], v[64:79]
    v_mfma_f32_32x32x16_bf16 v[80:95], v[184:187], v[180:183], v[80:95]
    v_mfma_f32_32x32x16_bf16 v[96:111], v[188:191], v[176:179], v[96:111]
    v_mfma_f32_32x32x16_bf16 v[112:127], v[188:191], v[180:183], v[112:127]
    s_waitcnt vmcnt(8)
    v_mfma_f32_32x32x16_bf16 v[64:79], v[200:203], v[192:195], v[64:79]
    v_mfma_f32_32x32x16_bf16 v[80:95], v[200:203], v[196:199], v[80:95]
    v_mfma_f32_32x32x16_bf16 v[96:111], v[204:207], v[192:195], v[96:111]
    v_mfma_f32_32x32x16_bf16 v[112:127], v[204:207], v[196:199], v[112:127]
    s_waitcnt vmcnt(4)
    v_mfma_f32_32x32x16_bf16 v[64:79], v[136:139], v[128:131], v[64:79]
    v_mfma_f32_32x32x16_bf16 v[80:95], v[136:139], v[132:135], v[80:95]
    v_mfma_f32_32x32x16_bf16 v[96:111], v[140:143], v[128:131], v[96:111]
    v_mfma_f32_32x32x16_bf16 v[112:127], v[140:143], v[132:135], v[112:127]
    s_cmp_eq_u32 s29, 21
    s_cbranch_scc1 L_ffn2a_kernel_skip
    s_waitcnt vmcnt(0)
    v_mfma_f32_32x32x16_bf16 v[64:79], v[152:155], v[144:147], v[64:79]
    v_mfma_f32_32x32x16_bf16 v[80:95], v[152:155], v[148:151], v[80:95]
    v_mfma_f32_32x32x16_bf16 v[96:111], v[156:159], v[144:147], v[96:111]
    v_mfma_f32_32x32x16_bf16 v[112:127], v[156:159], v[148:151], v[112:127]
L_ffn2a_kernel_skip:
    s_nop 15
    s_lshl_b32 s30, s27, 14
    v_lshl_add_u32 v6, v1, 2, s30
    ds_write_b32 v6, v64 offset:0
    ds_write_b32 v6, v65 offset:256
    ds_write_b32 v6, v66 offset:512
    ds_write_b32 v6, v67 offset:768
    ds_write_b32 v6, v68 offset:1024
    ds_write_b32 v6, v69 offset:1280
    ds_write_b32 v6, v70 offset:1536
    ds_write_b32 v6, v71 offset:1792
    ds_write_b32 v6, v72 offset:2048
    ds_write_b32 v6, v73 offset:2304
    ds_write_b32 v6, v74 offset:2560
    ds_write_b32 v6, v75 offset:2816
    ds_write_b32 v6, v76 offset:3072
    ds_write_b32 v6, v77 offset:3328
    ds_write_b32 v6, v78 offset:3584
    ds_write_b32 v6, v79 offset:3840
    ds_write_b32 v6, v80 offset:4096
    ds_write_b32 v6, v81 offset:4352
    ds_write_b32 v6, v82 offset:4608
    ds_write_b32 v6, v83 offset:4864
    ds_write_b32 v6, v84 offset:5120
    ds_write_b32 v6, v85 offset:5376
    ds_write_b32 v6, v86 offset:5632
    ds_write_b32 v6, v87 offset:5888
    ds_write_b32 v6, v88 offset:6144
    ds_write_b32 v6, v89 offset:6400
    ds_write_b32 v6, v90 offset:6656
    ds_write_b32 v6, v91 offset:6912
    ds_write_b32 v6, v92 offset:7168
    ds_write_b32 v6, v93 offset:7424
    ds_write_b32 v6, v94 offset:7680
    ds_write_b32 v6, v95 offset:7936
    ds_write_b32 v6, v96 offset:8192
    ds_write_b32 v6, v97 offset:8448
    ds_write_b32 v6, v98 offset:8704
    ds_write_b32 v6, v99 offset:8960
    ds_write_b32 v6, v100 offset:9216
    ds_write_b32 v6, v101 offset:9472
    ds_write_b32 v6, v102 offset:9728
    ds_write_b32 v6, v103 offset:9984
    ds_write_b32 v6, v104 offset:10240
    ds_write_b32 v6, v105 offset:10496
    ds_write_b32 v6, v106 offset:10752
    ds_write_b32 v6, v107 offset:11008
    ds_write_b32 v6, v108 offset:11264
    ds_write_b32 v6, v109 offset:11520
    ds_write_b32 v6, v110 offset:11776
    ds_write_b32 v6, v111 offset:12032
    ds_write_b32 v6, v112 offset:12288
    ds_write_b32 v6, v113 offset:12544
    ds_write_b32 v6, v114 offset:12800
    ds_write_b32 v6, v115 offset:13056
    ds_write_b32 v6, v116 offset:13312
    ds_write_b32 v6, v117 offset:13568
    ds_write_b32 v6, v118 offset:13824
    ds_write_b32 v6, v119 offset:14080
    ds_write_b32 v6, v120 offset:14336
    ds_write_b32 v6, v121 offset:14592
    ds_write_b32 v6, v122 offset:14848
    ds_write_b32 v6, v123 offset:15104
    ds_write_b32 v6, v124 offset:15360
    ds_write_b32 v6, v125 offset:15616
    ds_write_b32 v6, v126 offset:15872
    ds_write_b32 v6, v127 offset:16128
    s_waitcnt lgkmcnt(0)
    s_barrier
    s_lshl_b32 s30, s27, 12
    v_lshl_add_u32 v6, v1, 2, s30
    ds_read_b32 v64, v6 offset:0
    ds_read_b32 v65, v6 offset:256
    ds_read_b32 v66, v6 offset:512
    ds_read_b32 v67, v6 offset:768
    ds_read_b32 v68, v6 offset:1024
    ds_read_b32 v69, v6 offset:1280
    ds_read_b32 v70, v6 offset:1536
    ds_read_b32 v71, v6 offset:1792
    ds_read_b32 v72, v6 offset:2048
    ds_read_b32 v73, v6 offset:2304
    ds_read_b32 v74, v6 offset:2560
    ds_read_b32 v75, v6 offset:2816
    ds_read_b32 v76, v6 offset:3072
    ds_read_b32 v77, v6 offset:3328
    ds_read_b32 v78, v6 offset:3584
    ds_read_b32 v79, v6 offset:3840
    ds_read_b32 v80, v6 offset:16384
    ds_read_b32 v81, v6 offset:16640
    ds_read_b32 v82, v6 offset:16896
    ds_read_b32 v83, v6 offset:17152
    ds_read_b32 v84, v6 offset:17408
    ds_read_b32 v85, v6 offset:17664
    ds_read_b32 v86, v6 offset:17920
    ds_read_b32 v87, v6 offset:18176
    ds_read_b32 v88, v6 offset:18432
    ds_read_b32 v89, v6 offset:18688
    ds_read_b32 v90, v6 offset:18944
    ds_read_b32 v91, v6 offset:19200
    ds_read_b32 v92, v6 offset:19456
    ds_read_b32 v93, v6 offset:19712
    ds_read_b32 v94, v6 offset:19968
    ds_read_b32 v95, v6 offset:20224
    ds_read_b32 v96, v6 offset:32768
    ds_read_b32 v97, v6 offset:33024
    ds_read_b32 v98, v6 offset:33280
    ds_read_b32 v99, v6 offset:33536
    ds_read_b32 v100, v6 offset:33792
    ds_read_b32 v101, v6 offset:34048
    ds_read_b32 v102, v6 offset:34304
    ds_read_b32 v103, v6 offset:34560
    ds_read_b32 v104, v6 offset:34816
    ds_read_b32 v105, v6 offset:35072
    ds_read_b32 v106, v6 offset:35328
    ds_read_b32 v107, v6 offset:35584
    ds_read_b32 v108, v6 offset:35840
    ds_read_b32 v109, v6 offset:36096
    ds_read_b32 v110, v6 offset:36352
    ds_read_b32 v111, v6 offset:36608
    ds_read_b32 v112, v6 offset:49152
    ds_read_b32 v113, v6 offset:49408
    ds_read_b32 v114, v6 offset:49664
    ds_read_b32 v115, v6 offset:49920
    ds_read_b32 v116, v6 offset:50176
    ds_read_b32 v117, v6 offset:50432
    ds_read_b32 v118, v6 offset:50688
    ds_read_b32 v119, v6 offset:50944
    ds_read_b32 v120, v6 offset:51200
    ds_read_b32 v121, v6 offset:51456
    ds_read_b32 v122, v6 offset:51712
    ds_read_b32 v123, v6 offset:51968
    ds_read_b32 v124, v6 offset:52224
    ds_read_b32 v125, v6 offset:52480
    ds_read_b32 v126, v6 offset:52736
    ds_read_b32 v127, v6 offset:52992
    s_and_b32 s30, s27, 1
    s_lshl_b32 s30, s30, 5
    s_lshl_b32 s31, s25, 6
    s_add_u32 s30, s30, s31
    v_and_b32 v7, 31, v1
    v_add_u32 v7, s30, v7
    v_lshlrev_b32 v7, 10, v7
    s_lshr_b32 s30, s27, 1
    s_lshl_b32 s30, s30, 5
    s_lshl_b32 s31, s26, 6
    s_add_u32 s30, s30, s31
    v_lshrrev_b32 v8, 5, v1
    v_lshl_add_u32 v8, v8, 2, s30
    v_lshl_add_u32 v7, v8, 1, v7
    v_add_u32 v9, 4194304, v7
    v_add_u32 v10, 6291456, v7
    buffer_load_dwordx2 v[16:17], v9, s[20:23], 0 offen offset:0
    buffer_load_dwordx2 v[18:19], v9, s[20:23], 0 offen offset:16
    buffer_load_dwordx2 v[20:21], v9, s[20:23], 0 offen offset:32
    buffer_load_dwordx2 v[22:23], v9, s[20:23], 0 offen offset:48
    s_waitcnt vmcnt(0) lgkmcnt(0)
    v_add_f32 v64, v64, v80
    v_add_f32 v96, v96, v112
    v_add_f32 v64, v64, v96
    v_cvt_pk_bf16_f32 v30, v64, v64
    v_lshlrev_b32 v64, 16, v30
    v_lshlrev_b32 v31, 16, v16
    v_add_f32 v64, v64, v31
    v_add_f32 v65, v65, v81
    v_add_f32 v97, v97, v113
    v_add_f32 v65, v65, v97
    v_cvt_pk_bf16_f32 v30, v65, v65
    v_lshlrev_b32 v65, 16, v30
    v_and_b32 v31, 0xffff0000, v16
    v_add_f32 v65, v65, v31
    v_add_f32 v66, v66, v82
    v_add_f32 v98, v98, v114
    v_add_f32 v66, v66, v98
    v_cvt_pk_bf16_f32 v30, v66, v66
    v_lshlrev_b32 v66, 16, v30
    v_lshlrev_b32 v31, 16, v17
    v_add_f32 v66, v66, v31
    v_add_f32 v67, v67, v83
    v_add_f32 v99, v99, v115
    v_add_f32 v67, v67, v99
    v_cvt_pk_bf16_f32 v30, v67, v67
    v_lshlrev_b32 v67, 16, v30
    v_and_b32 v31, 0xffff0000, v17
    v_add_f32 v67, v67, v31
    v_cvt_pk_bf16_f32 v32, v64, v65
    v_cvt_pk_bf16_f32 v33, v66, v67
    buffer_store_dwordx2 v[32:33], v10, s[12:15], 0 offen offset:0
    v_add_f32 v68, v68, v84
    v_add_f32 v100, v100, v116
    v_add_f32 v68, v68, v100
    v_cvt_pk_bf16_f32 v30, v68, v68
    v_lshlrev_b32 v68, 16, v30
    v_lshlrev_b32 v31, 16, v18
    v_add_f32 v68, v68, v31
    v_add_f32 v69, v69, v85
    v_add_f32 v101, v101, v117
    v_add_f32 v69, v69, v101
    v_cvt_pk_bf16_f32 v30, v69, v69
    v_lshlrev_b32 v69, 16, v30
    v_and_b32 v31, 0xffff0000, v18
    v_add_f32 v69, v69, v31
    v_add_f32 v70, v70, v86
    v_add_f32 v102, v102, v118
    v_add_f32 v70, v70, v102
    v_cvt_pk_bf16_f32 v30, v70, v70
    v_lshlrev_b32 v70, 16, v30
    v_lshlrev_b32 v31, 16, v19
    v_add_f32 v70, v70, v31
    v_add_f32 v71, v71, v87
    v_add_f32 v103, v103, v119
    v_add_f32 v71, v71, v103
    v_cvt_pk_bf16_f32 v30, v71, v71
    v_lshlrev_b32 v71, 16, v30
    v_and_b32 v31, 0xffff0000, v19
    v_add_f32 v71, v71, v31
    v_cvt_pk_bf16_f32 v34, v68, v69
    v_cvt_pk_bf16_f32 v35, v70, v71
    buffer_store_dwordx2 v[34:35], v10, s[12:15], 0 offen offset:16
    v_add_f32 v72, v72, v88
    v_add_f32 v104, v104, v120
    v_add_f32 v72, v72, v104
    v_cvt_pk_bf16_f32 v30, v72, v72
    v_lshlrev_b32 v72, 16, v30
    v_lshlrev_b32 v31, 16, v20
    v_add_f32 v72, v72, v31
    v_add_f32 v73, v73, v89
    v_add_f32 v105, v105, v121
    v_add_f32 v73, v73, v105
    v_cvt_pk_bf16_f32 v30, v73, v73
    v_lshlrev_b32 v73, 16, v30
    v_and_b32 v31, 0xffff0000, v20
    v_add_f32 v73, v73, v31
    v_add_f32 v74, v74, v90
    v_add_f32 v106, v106, v122
    v_add_f32 v74, v74, v106
    v_cvt_pk_bf16_f32 v30, v74, v74
    v_lshlrev_b32 v74, 16, v30
    v_lshlrev_b32 v31, 16, v21
    v_add_f32 v74, v74, v31
    v_add_f32 v75, v75, v91
    v_add_f32 v107, v107, v123
    v_add_f32 v75, v75, v107
    v_cvt_pk_bf16_f32 v30, v75, v75
    v_lshlrev_b32 v75, 16, v30
    v_and_b32 v31, 0xffff0000, v21
    v_add_f32 v75, v75, v31
    v_cvt_pk_bf16_f32 v36, v72, v73
    v_cvt_pk_bf16_f32 v37, v74, v75
    buffer_store_dwordx2 v[36:37], v10, s[12:15], 0 offen offset:32
    v_add_f32 v76, v76, v92
    v_add_f32 v108, v108, v124
    v_add_f32 v76, v76, v108
    v_cvt_pk_bf16_f32 v30, v76, v76
    v_lshlrev_b32 v76, 16, v30
    v_lshlrev_b32 v31, 16, v22
    v_add_f32 v76, v76, v31
    v_add_f32 v77, v77, v93
    v_add_f32 v109, v109, v125
    v_add_f32 v77, v77, v109
    v_cvt_pk_bf16_f32 v30, v77, v77
    v_lshlrev_b32 v77, 16, v30
    v_and_b32 v31, 0xffff0000, v22
    v_add_f32 v77, v77, v31
    v_add_f32 v78, v78, v94
    v_add_f32 v110, v110, v126
    v_add_f32 v78, v78, v110
    v_cvt_pk_bf16_f32 v30, v78, v78
    v_lshlrev_b32 v78, 16, v30
    v_lshlrev_b32 v31, 16, v23
    v_add_f32 v78, v78, v31
    v_add_f32 v79, v79, v95
    v_add_f32 v111, v111, v127
    v_add_f32 v79, v79, v111
    v_cvt_pk_bf16_f32 v30, v79, v79
    v_lshlrev_b32 v79, 16, v30
    v_and_b32 v31, 0xffff0000, v23
    v_add_f32 v79, v79, v31
    v_cvt_pk_bf16_f32 v38, v76, v77
    v_cvt_pk_bf16_f32 v39, v78, v79
    buffer_store_dwordx2 v[38:39], v10, s[12:15], 0 offen offset:48
    s_waitcnt vmcnt(0)
L_ffn2a_kernel_done:
    s_endpgm
.globl ffn1b_kernel
.p2align 8
.type ffn1b_kernel,@function
ffn1b_kernel:
    s_cmp_ge_u32 s2, 240
    s_cbranch_scc1 L_ffn1b_kernel_done
    s_load_dwordx2 s[4:5], s[0:1], 0
    s_load_dwordx2 s[8:9], s[0:1], 96
    s_mov_b32 s24, 0x11111112
    s_mul_hi_u32 s25, s2, s24
    s_mul_i32 s26, s25, 15
    s_sub_u32 s26, s2, s26
    s_waitcnt lgkmcnt(0)
    s_mov_b32 s20, s8
    s_mov_b32 s21, s9
    s_mov_b32 s22, 25165824
    s_mov_b32 s23, 0x00020000
    s_mov_b32 s12, s8
    s_mov_b32 s13, s9
    s_mov_b32 s14, 25165824
    s_mov_b32 s15, 0x00020000
    v_lshrrev_b32 v1, 6, v0
    s_nop 0
    v_readfirstlane_b32 s27, v1
    v_and_b32 v1, 63, v0
    s_lshl_b32 s28, s26, 2
    s_add_u32 s28, s28, s27
    s_mul_i32 s28, s28, 49152
    s_add_u32 s28, s28, 16777216
    v_lshl_add_u32 v2, v1, 4, s28
    buffer_load_dwordx4 v[208:211], v2, s[20:23], 0 offen offset:0
    v_add_u32 v3, 4096, v2
    v_add_u32 v4, 8192, v2
    buffer_load_dwordx4 v[212:215], v2, s[20:23], 0 offen offset:1024
    buffer_load_dwordx4 v[216:219], v2, s[20:23], 0 offen offset:2048
    buffer_load_dwordx4 v[220:223], v2, s[20:23], 0 offen offset:3072
    buffer_load_dwordx4 v[224:227], v3, s[20:23], 0 offen offset:0
    buffer_load_dwordx4 v[228:231], v3, s[20:23], 0 offen offset:1024
    buffer_load_dwordx4 v[232:235], v3, s[20:23], 0 offen offset:2048
    buffer_load_dwordx4 v[236:239], v3, s[20:23], 0 offen offset:3072
    buffer_load_dwordx4 v[240:243], v4, s[20:23], 0 offen offset:0
    buffer_load_dwordx4 v[244:247], v4, s[20:23], 0 offen offset:1024
    buffer_load_dwordx4 v[248:251], v4, s[20:23], 0 offen offset:2048
    buffer_load_dwordx4 v[252:255], v4, s[20:23], 0 offen offset:3072
    v_add_u32 v2, 12288, v2
    s_lshl_b32 s29, s25, 17
    s_lshl_b32 s30, s27, 15
    s_add_u32 s29, s29, s30
    s_add_u32 s29, s29, 23068672
    v_lshl_add_u32 v7, v1, 4, s29
    s_add_u32 s31, s30, 0
    s_mov_b32 m0, s31
    s_nop 0
    buffer_load_dwordx4 v7, s[20:23], 0 offen offset:0 lds
    buffer_load_dwordx4 v7, s[20:23], 0 offen offset:1024 lds
    buffer_load_dwordx4 v7, s[20:23], 0 offen offset:2048 lds
    buffer_load_dwordx4 v7, s[20:23], 0 offen offset:3072 lds
    v_add_u32 v7, 4096, v7
    s_add_u32 s31, s30, 4096
    s_mov_b32 m0, s31
    s_nop 0
    buffer_load_dwordx4 v7, s[20:23], 0 offen offset:0 lds
    buffer_load_dwordx4 v7, s[20:23], 0 offen offset:1024 lds
    buffer_load_dwordx4 v7, s[20:23], 0 offen offset:2048 lds
    buffer_load_dwordx4 v7, s[20:23], 0 offen offset:3072 lds
    v_add_u32 v7, 4096, v7
    s_add_u32 s31, s30, 8192
    s_mov_b32 m0, s31
    s_nop 0
    buffer_load_dwordx4 v7, s[20:23], 0 offen offset:0 lds
    buffer_load_dwordx4 v7, s[20:23], 0 offen offset:1024 lds
    buffer_load_dwordx4 v7, s[20:23], 0 offen offset:2048 lds
    buffer_load_dwordx4 v7, s[20:23], 0 offen offset:3072 lds
    v_add_u32 v7, 4096, v7
    s_add_u32 s31, s30, 12288
    s_mov_b32 m0, s31
    s_nop 0
    buffer_load_dwordx4 v7, s[20:23], 0 offen offset:0 lds
    buffer_load_dwordx4 v7, s[20:23], 0 offen offset:1024 lds
    buffer_load_dwordx4 v7, s[20:23], 0 offen offset:2048 lds
    buffer_load_dwordx4 v7, s[20:23], 0 offen offset:3072 lds
    v_add_u32 v7, 4096, v7
    s_add_u32 s31, s30, 16384
    s_mov_b32 m0, s31
    s_nop 0
    buffer_load_dwordx4 v7, s[20:23], 0 offen offset:0 lds
    buffer_load_dwordx4 v7, s[20:23], 0 offen offset:1024 lds
    buffer_load_dwordx4 v7, s[20:23], 0 offen offset:2048 lds
    buffer_load_dwordx4 v7, s[20:23], 0 offen offset:3072 lds
    v_add_u32 v7, 4096, v7
    s_add_u32 s31, s30, 20480
    s_mov_b32 m0, s31
    s_nop 0
    buffer_load_dwordx4 v7, s[20:23], 0 offen offset:0 lds
    buffer_load_dwordx4 v7, s[20:23], 0 offen offset:1024 lds
    buffer_load_dwordx4 v7, s[20:23], 0 offen offset:2048 lds
    buffer_load_dwordx4 v7, s[20:23], 0 offen offset:3072 lds
    v_add_u32 v7, 4096, v7
    s_add_u32 s31, s30, 24576
    s_mov_b32 m0, s31
    s_nop 0
    buffer_load_dwordx4 v7, s[20:23], 0 offen offset:0 lds
    buffer_load_dwordx4 v7, s[20:23], 0 offen offset:1024 lds
    buffer_load_dwordx4 v7, s[20:23], 0 offen offset:2048 lds
    buffer_load_dwordx4 v7, s[20:23], 0 offen offset:3072 lds
    v_add_u32 v7, 4096, v7
    s_add_u32 s31, s30, 28672
    s_mov_b32 m0, s31
    s_nop 0
    buffer_load_dwordx4 v7, s[20:23], 0 offen offset:0 lds
    buffer_load_dwordx4 v7, s[20:23], 0 offen offset:1024 lds
    buffer_load_dwordx4 v7, s[20:23], 0 offen offset:2048 lds
    buffer_load_dwordx4 v7, s[20:23], 0 offen offset:3072 lds
    v_add_u32 v7, 4096, v7
    s_waitcnt vmcnt(0)
    s_waitcnt lgkmcnt(0)
    s_barrier
    v_mov_b32 v64, 0
    v_mov_b32 v65, 0
    v_mov_b32 v66, 0
    v_mov_b32 v67, 0
    v_mov_b32 v68, 0
    v_mov_b32 v69, 0
    v_mov_b32 v70, 0
    v_mov_b32 v71, 0
    v_mov_b32 v72, 0
    v_mov_b32 v73, 0
    v_mov_b32 v74, 0
    v_mov_b32 v75, 0
    v_mov_b32 v76, 0
    v_mov_b32 v77, 0
    v_mov_b32 v78, 0
    v_mov_b32 v79, 0
    v_mov_b32 v80, 0
    v_mov_b32 v81, 0
    v_mov_b32 v82, 0
    v_mov_b32 v83, 0
    v_mov_b32 v84, 0
    v_mov_b32 v85, 0
    v_mov_b32 v86, 0
    v_mov_b32 v87, 0
    v_mov_b32 v88, 0
    v_mov_b32 v89, 0
    v_mov_b32 v90, 0
    v_mov_b32 v91, 0
    v_mov_b32 v92, 0
    v_mov_b32 v93, 0
    v_mov_b32 v94, 0
    v_mov_b32 v95, 0
    v_mov_b32 v96, 0
    v_mov_b32 v97, 0
    v_mov_b32 v98, 0
    v_mov_b32 v99, 0
    v_mov_b32 v100, 0
    v_mov_b32 v101, 0
    v_mov_b32 v102, 0
    v_mov_b32 v103, 0
    v_mov_b32 v104, 0
    v_mov_b32 v105, 0
    v_mov_b32 v106, 0
    v_mov_b32 v107, 0
    v_mov_b32 v108, 0
    v_mov_b32 v109, 0
    v_mov_b32 v110, 0
    v_mov_b32 v111, 0
    v_mov_b32 v112, 0
    v_mov_b32 v113, 0
    v_mov_b32 v114, 0
    v_mov_b32 v115, 0
    v_mov_b32 v116, 0
    v_mov_b32 v117, 0
    v_mov_b32 v118, 0
    v_mov_b32 v119, 0
    v_mov_b32 v120, 0
    v_mov_b32 v121, 0
    v_mov_b32 v122, 0
    v_mov_b32 v123, 0
    v_mov_b32 v124, 0
    v_mov_b32 v125, 0
    v_mov_b32 v126, 0
    v_mov_b32 v127, 0
    v_mov_b32 v128, 0
    v_mov_b32 v129, 0
    v_mov_b32 v130, 0
    v_mov_b32 v131, 0
    v_mov_b32 v132, 0
    v_mov_b32 v133, 0
    v_mov_b32 v134, 0
    v_mov_b32 v135, 0
    v_mov_b32 v136, 0
    v_mov_b32 v137, 0
    v_mov_b32 v138, 0
    v_mov_b32 v139, 0
    v_mov_b32 v140, 0
    v_mov_b32 v141, 0
    v_mov_b32 v142, 0
    v_mov_b32 v143, 0
    v_mov_b32 v144, 0
    v_mov_b32 v145, 0
    v_mov_b32 v146, 0
    v_mov_b32 v147, 0
    v_mov_b32 v148, 0
    v_mov_b32 v149, 0
    v_mov_b32 v150, 0
    v_mov_b32 v151, 0
    v_mov_b32 v152, 0
    v_mov_b32 v153, 0
    v_mov_b32 v154, 0
    v_mov_b32 v155, 0
    v_mov_b32 v156, 0
    v_mov_b32 v157, 0
    v_mov_b32 v158, 0
    v_mov_b32 v159, 0
    v_lshlrev_b32 v5, 4, v1
    v_add_u32 v14, 0x10000, v5
    s_mov_b32 s31, 4
L_ffn1b_kernel_main:
    ds_read_b128 v[160:163], v5 offset:0
    ds_read_b128 v[164:167], v5 offset:16384
    ds_read_b128 v[168:171], v5 offset:32768
    ds_read_b128 v[172:175], v5 offset:49152
    ds_read_b128 v[176:179], v14 offset:0
    ds_read_b128 v[180:183], v14 offset:16384
    ds_read_b128 v[184:187], v14 offset:32768
    ds_read_b128 v[188:191], v14 offset:49152
    s_waitcnt vmcnt(9) lgkmcnt(0)
    v_mfma_f32_16x16x32_bf16 v[64:67], v[208:211], v[160:163], v[64:67]
    v_mfma_f32_16x16x32_bf16 v[68:71], v[208:211], v[164:167], v[68:71]
    v_mfma_f32_16x16x32_bf16 v[72:75], v[208:211], v[168:171], v[72:75]
    v_mfma_f32_16x16x32_bf16 v[76:79], v[208:211], v[172:175], v[76:79]
    v_mfma_f32_16x16x32_bf16 v[80:83], v[208:211], v[176:179], v[80:83]
    v_mfma_f32_16x16x32_bf16 v[84:87], v[208:211], v[180:183], v[84:87]
    v_mfma_f32_16x16x32_bf16 v[88:91], v[208:211], v[184:187], v[88:91]
    v_mfma_f32_16x16x32_bf16 v[92:95], v[208:211], v[188:191], v[92:95]
    v_mfma_f32_16x16x32_bf16 v[96:99], v[212:215], v[160:163], v[96:99]
    v_mfma_f32_16x16x32_bf16 v[100:103], v[212:215], v[164:167], v[100:103]
    v_mfma_f32_16x16x32_bf16 v[104:107], v[212:215], v[168:171], v[104:107]
    v_mfma_f32_16x16x32_bf16 v[108:111], v[212:215], v[172:175], v[108:111]
    v_mfma_f32_16x16x32_bf16 v[112:115], v[212:215], v[176:179], v[112:115]
    v_mfma_f32_16x16x32_bf16 v[116:119], v[212:215], v[180:183], v[116:119]
    v_mfma_f32_16x16x32_bf16 v[120:123], v[212:215], v[184:187], v[120:123]
    v_mfma_f32_16x16x32_bf16 v[124:127], v[212:215], v[188:191], v[124:127]
    v_mfma_f32_16x16x32_bf16 v[128:131], v[216:219], v[160:163], v[128:131]
    v_mfma_f32_16x16x32_bf16 v[132:135], v[216:219], v[164:167], v[132:135]
    v_mfma_f32_16x16x32_bf16 v[136:139], v[216:219], v[168:171], v[136:139]
    v_mfma_f32_16x16x32_bf16 v[140:143], v[216:219], v[172:175], v[140:143]
    v_mfma_f32_16x16x32_bf16 v[144:147], v[216:219], v[176:179], v[144:147]
    v_mfma_f32_16x16x32_bf16 v[148:151], v[216:219], v[180:183], v[148:151]
    v_mfma_f32_16x16x32_bf16 v[152:155], v[216:219], v[184:187], v[152:155]
    v_mfma_f32_16x16x32_bf16 v[156:159], v[216:219], v[188:191], v[156:159]
    buffer_load_dwordx4 v[208:211], v2, s[20:23], 0 offen offset:0
    buffer_load_dwordx4 v[212:215], v2, s[20:23], 0 offen offset:1024
    buffer_load_dwordx4 v[216:219], v2, s[20:23], 0 offen offset:2048
    v_add_u32 v2, 3072, v2
    ds_read_b128 v[160:163], v5 offset:1024
    ds_read_b128 v[164:167], v5 offset:17408
    ds_read_b128 v[168:171], v5 offset:33792
    ds_read_b128 v[172:175], v5 offset:50176
    ds_read_b128 v[176:179], v14 offset:1024
    ds_read_b128 v[180:183], v14 offset:17408
    ds_read_b128 v[184:187], v14 offset:33792
    ds_read_b128 v[188:191], v14 offset:50176
    s_waitcnt vmcnt(9) lgkmcnt(0)
    v_mfma_f32_16x16x32_bf16 v[64:67], v[220:223], v[160:163], v[64:67]
    v_mfma_f32_16x16x32_bf16 v[68:71], v[220:223], v[164:167], v[68:71]
    v_mfma_f32_16x16x32_bf16 v[72:75], v[220:223], v[168:171], v[72:75]
    v_mfma_f32_16x16x32_bf16 v[76:79], v[220:223], v[172:175], v[76:79]
    v_mfma_f32_16x16x32_bf16 v[80:83], v[220:223], v[176:179], v[80:83]
    v_mfma_f32_16x16x32_bf16 v[84:87], v[220:223], v[180:183], v[84:87]
    v_mfma_f32_16x16x32_bf16 v[88:91], v[220:223], v[184:187], v[88:91]
    v_mfma_f32_16x16x32_bf16 v[92:95], v[220:223], v[188:191], v[92:95]
    v_mfma_f32_16x16x32_bf16 v[96:99], v[224:227], v[160:163], v[96:99]
    v_mfma_f32_16x16x32_bf16 v[100:103], v[224:227], v[164:167], v[100:103]
    v_mfma_f32_16x16x32_bf16 v[104:107], v[224:227], v[168:171], v[104:107]
    v_mfma_f32_16x16x32_bf16 v[108:111], v[224:227], v[172:175], v[108:111]
    v_mfma_f32_16x16x32_bf16 v[112:115], v[224:227], v[176:179], v[112:115]
    v_mfma_f32_16x16x32_bf16 v[116:119], v[224:227], v[180:183], v[116:119]
    v_mfma_f32_16x16x32_bf16 v[120:123], v[224:227], v[184:187], v[120:123]
    v_mfma_f32_16x16x32_bf16 v[124:127], v[224:227], v[188:191], v[124:127]
    v_mfma_f32_16x16x32_bf16 v[128:131], v[228:231], v[160:163], v[128:131]
    v_mfma_f32_16x16x32_bf16 v[132:135], v[228:231], v[164:167], v[132:135]
    v_mfma_f32_16x16x32_bf16 v[136:139], v[228:231], v[168:171], v[136:139]
    v_mfma_f32_16x16x32_bf16 v[140:143], v[228:231], v[172:175], v[140:143]
    v_mfma_f32_16x16x32_bf16 v[144:147], v[228:231], v[176:179], v[144:147]
    v_mfma_f32_16x16x32_bf16 v[148:151], v[228:231], v[180:183], v[148:151]
    v_mfma_f32_16x16x32_bf16 v[152:155], v[228:231], v[184:187], v[152:155]
    v_mfma_f32_16x16x32_bf16 v[156:159], v[228:231], v[188:191], v[156:159]
    buffer_load_dwordx4 v[220:223], v2, s[20:23], 0 offen offset:0
    buffer_load_dwordx4 v[224:227], v2, s[20:23], 0 offen offset:1024
    buffer_load_dwordx4 v[228:231], v2, s[20:23], 0 offen offset:2048
    v_add_u32 v2, 3072, v2
    ds_read_b128 v[160:163], v5 offset:2048
    ds_read_b128 v[164:167], v5 offset:18432
    ds_read_b128 v[168:171], v5 offset:34816
    ds_read_b128 v[172:175], v5 offset:51200
    ds_read_b128 v[176:179], v14 offset:2048
    ds_read_b128 v[180:183], v14 offset:18432
    ds_read_b128 v[184:187], v14 offset:34816
    ds_read_b128 v[188:191], v14 offset:51200
    s_waitcnt vmcnt(9) lgkmcnt(0)
    v_mfma_f32_16x16x32_bf16 v[64:67], v[232:235], v[160:163], v[64:67]
    v_mfma_f32_16x16x32_bf16 v[68:71], v[232:235], v[164:167], v[68:71]
    v_mfma_f32_16x16x32_bf16 v[72:75], v[232:235], v[168:171], v[72:75]
    v_mfma_f32_16x16x32_bf16 v[76:79], v[232:235], v[172:175], v[76:79]
    v_mfma_f32_16x16x32_bf16 v[80:83], v[232:235], v[176:179], v[80:83]
    v_mfma_f32_16x16x32_bf16 v[84:87], v[232:235], v[180:183], v[84:87]
    v_mfma_f32_16x16x32_bf16 v[88:91], v[232:235], v[184:187], v[88:91]
    v_mfma_f32_16x16x32_bf16 v[92:95], v[232:235], v[188:191], v[92:95]
    v_mfma_f32_16x16x32_bf16 v[96:99], v[236:239], v[160:163], v[96:99]
    v_mfma_f32_16x16x32_bf16 v[100:103], v[236:239], v[164:167], v[100:103]
    v_mfma_f32_16x16x32_bf16 v[104:107], v[236:239], v[168:171], v[104:107]
    v_mfma_f32_16x16x32_bf16 v[108:111], v[236:239], v[172:175], v[108:111]
    v_mfma_f32_16x16x32_bf16 v[112:115], v[236:239], v[176:179], v[112:115]
    v_mfma_f32_16x16x32_bf16 v[116:119], v[236:239], v[180:183], v[116:119]
    v_mfma_f32_16x16x32_bf16 v[120:123], v[236:239], v[184:187], v[120:123]
    v_mfma_f32_16x16x32_bf16 v[124:127], v[236:239], v[188:191], v[124:127]
    v_mfma_f32_16x16x32_bf16 v[128:131], v[240:243], v[160:163], v[128:131]
    v_mfma_f32_16x16x32_bf16 v[132:135], v[240:243], v[164:167], v[132:135]
    v_mfma_f32_16x16x32_bf16 v[136:139], v[240:243], v[168:171], v[136:139]
    v_mfma_f32_16x16x32_bf16 v[140:143], v[240:243], v[172:175], v[140:143]
    v_mfma_f32_16x16x32_bf16 v[144:147], v[240:243], v[176:179], v[144:147]
    v_mfma_f32_16x16x32_bf16 v[148:151], v[240:243], v[180:183], v[148:151]
    v_mfma_f32_16x16x32_bf16 v[152:155], v[240:243], v[184:187], v[152:155]
    v_mfma_f32_16x16x32_bf16 v[156:159], v[240:243], v[188:191], v[156:159]
    buffer_load_dwordx4 v[232:235], v2, s[20:23], 0 offen offset:0
    buffer_load_dwordx4 v[236:239], v2, s[20:23], 0 offen offset:1024
    buffer_load_dwordx4 v[240:243], v2, s[20:23], 0 offen offset:2048
    v_add_u32 v2, 3072, v2
    ds_read_b128 v[160:163], v5 offset:3072
    ds_read_b128 v[164:167], v5 offset:19456
    ds_read_b128 v[168:171], v5 offset:35840
    ds_read_b128 v[172:175], v5 offset:52224
    ds_read_b128 v[176:179], v14 offset:3072
    ds_read_b128 v[180:183], v14 offset:19456
    ds_read_b128 v[184:187], v14 offset:35840
    ds_read_b128 v[188:191], v14 offset:52224
    s_waitcnt vmcnt(9) lgkmcnt(0)
    v_mfma_f32_16x16x32_bf16 v[64:67], v[244:247], v[160:163], v[64:67]
    v_mfma_f32_16x16x32_bf16 v[68:71], v[244:247], v[164:167], v[68:71]
    v_mfma_f32_16x16x32_bf16 v[72:75], v[244:247], v[168:171], v[72:75]
    v_mfma_f32_16x16x32_bf16 v[76:79], v[244:247], v[172:175], v[76:79]
    v_mfma_f32_16x16x32_bf16 v[80:83], v[244:247], v[176:179], v[80:83]
    v_mfma_f32_16x16x32_bf16 v[84:87], v[244:247], v[180:183], v[84:87]
    v_mfma_f32_16x16x32_bf16 v[88:91], v[244:247], v[184:187], v[88:91]
    v_mfma_f32_16x16x32_bf16 v[92:95], v[244:247], v[188:191], v[92:95]
    v_mfma_f32_16x16x32_bf16 v[96:99], v[248:251], v[160:163], v[96:99]
    v_mfma_f32_16x16x32_bf16 v[100:103], v[248:251], v[164:167], v[100:103]
    v_mfma_f32_16x16x32_bf16 v[104:107], v[248:251], v[168:171], v[104:107]
    v_mfma_f32_16x16x32_bf16 v[108:111], v[248:251], v[172:175], v[108:111]
    v_mfma_f32_16x16x32_bf16 v[112:115], v[248:251], v[176:179], v[112:115]
    v_mfma_f32_16x16x32_bf16 v[116:119], v[248:251], v[180:183], v[116:119]
    v_mfma_f32_16x16x32_bf16 v[120:123], v[248:251], v[184:187], v[120:123]
    v_mfma_f32_16x16x32_bf16 v[124:127], v[248:251], v[188:191], v[124:127]
    v_mfma_f32_16x16x32_bf16 v[128:131], v[252:255], v[160:163], v[128:131]
    v_mfma_f32_16x16x32_bf16 v[132:135], v[252:255], v[164:167], v[132:135]
    v_mfma_f32_16x16x32_bf16 v[136:139], v[252:255], v[168:171], v[136:139]
    v_mfma_f32_16x16x32_bf16 v[140:143], v[252:255], v[172:175], v[140:143]
    v_mfma_f32_16x16x32_bf16 v[144:147], v[252:255], v[176:179], v[144:147]
    v_mfma_f32_16x16x32_bf16 v[148:151], v[252:255], v[180:183], v[148:151]
    v_mfma_f32_16x16x32_bf16 v[152:155], v[252:255], v[184:187], v[152:155]
    v_mfma_f32_16x16x32_bf16 v[156:159], v[252:255], v[188:191], v[156:159]
    buffer_load_dwordx4 v[244:247], v2, s[20:23], 0 offen offset:0
    buffer_load_dwordx4 v[248:251], v2, s[20:23], 0 offen offset:1024
    buffer_load_dwordx4 v[252:255], v2, s[20:23], 0 offen offset:2048
    v_add_u32 v2, 3072, v2
    v_add_u32 v5, 4096, v5
    v_add_u32 v14, 4096, v14
    s_sub_u32 s31, s31, 1
    s_cmp_lg_u32 s31, 0
    s_cbranch_scc1 L_ffn1b_kernel_main
    s_nop 7
    s_waitcnt vmcnt(0)
    s_mul_i32 s28, s26, 96
    s_mul_i32 s29, s27, 24
    s_add_u32 s28, s28, s29
    v_and_b32 v6, 15, v1
    v_lshrrev_b32 v7, 4, v1
    v_lshl_add_u32 v8, v7, 2, s28
    v_add_u32 v9, 16, v8
    v_lshrrev_b32 v10, 4, v8
    v_lshlrev_b32 v10, 6, v10
    v_bfe_u32 v11, v8, 3, 1
    v_lshl_add_u32 v10, v11, 5, v10
    v_add_u32 v10, v10, v6
    v_lshlrev_b32 v10, 4, v10
    v_and_b32 v11, 4, v8
    v_lshl_add_u32 v12, v11, 1, v10
    s_lshl_b32 s29, s25, 2
    s_mul_i32 s29, s29, 88064
    s_add_u32 s29, s29, 10485760
    v_add_u32 v12, s29, v12
    v_bfrev_b32 v11, 1
    v_cmp_gt_u32 vcc, 1376, v8
    s_nop 1
    v_cndmask_b32 v12, v11, v12, vcc
    v_lshrrev_b32 v10, 4, v9
    v_lshlrev_b32 v10, 6, v10
    v_bfe_u32 v11, v9, 3, 1
    v_lshl_add_u32 v10, v11, 5, v10
    v_add_u32 v10, v10, v6
    v_lshlrev_b32 v10, 4, v10
    v_and_b32 v11, 4, v9
    v_lshl_add_u32 v13, v11, 1, v10
    s_lshl_b32 s29, s25, 2
    s_mul_i32 s29, s29, 88064
    s_add_u32 s29, s29, 10485760
    v_add_u32 v13, s29, v13
    v_bfrev_b32 v11, 1
    v_cmp_gt_u32 vcc, 1376, v9
    s_nop 1
    v_cndmask_b32 v13, v11, v13, vcc
    v_cmp_gt_u32 vcc, 2, v7
    v_bfrev_b32 v11, 1
    s_nop 0
    v_cndmask_b32 v13, v11, v13, vcc
    v_cvt_pk_bf16_f32 v16, v64, v65
    v_lshlrev_b32 v64, 16, v16
    v_and_b32 v65, 0xffff0000, v16
    v_cvt_pk_bf16_f32 v16, v96, v97
    v_lshlrev_b32 v96, 16, v16
    v_and_b32 v97, 0xffff0000, v16
    v_cvt_pk_bf16_f32 v16, v66, v67
    v_lshlrev_b32 v66, 16, v16
    v_and_b32 v67, 0xffff0000, v16
    v_cvt_pk_bf16_f32 v16, v98, v99
    v_lshlrev_b32 v98, 16, v16
    v_and_b32 v99, 0xffff0000, v16
    v_mul_f32 v17, 0xbfb8aa3b, v64
    v_exp_f32 v17, v17
    s_nop 0
    v_add_f32 v17, 1.0, v17
    v_rcp_f32 v17, v17
    s_nop 0
    v_mul_f32 v64, v64, v17
    v_mul_f32 v17, 0xbfb8aa3b, v65
    v_exp_f32 v17, v17
    s_nop 0
    v_add_f32 v17, 1.0, v17
    v_rcp_f32 v17, v17
    s_nop 0
    v_mul_f32 v65, v65, v17
    v_mul_f32 v17, 0xbfb8aa3b, v66
    v_exp_f32 v17, v17
    s_nop 0
    v_add_f32 v17, 1.0, v17
    v_rcp_f32 v17, v17
    s_nop 0
    v_mul_f32 v66, v66, v17
    v_mul_f32 v17, 0xbfb8aa3b, v67
    v_exp_f32 v17, v17
    s_nop 0
    v_add_f32 v17, 1.0, v17
    v_rcp_f32 v17, v17
    s_nop 0
    v_mul_f32 v67, v67, v17
    v_cvt_pk_bf16_f32 v16, v64, v65
    v_lshlrev_b32 v64, 16, v16
    v_and_b32 v65, 0xffff0000, v16
    v_cvt_pk_bf16_f32 v16, v66, v67
    v_lshlrev_b32 v66, 16, v16
    v_and_b32 v67, 0xffff0000, v16
    v_mul_f32 v64, v64, v96
    v_mul_f32 v65, v65, v97
    v_mul_f32 v66, v66, v98
    v_mul_f32 v67, v67, v99
    v_cvt_pk_bf16_f32 v20, v64, v65
    v_cvt_pk_bf16_f32 v21, v66, v67
    v_add_u32 v22, 0, v12
    buffer_store_dwordx2 v[20:21], v22, s[20:23], 0 offen
    v_mov_b32 v24, v128
    v_mov_b32 v25, v129
    v_mov_b32 v26, v130
    v_mov_b32 v27, v131
    s_nop 1
    v_permlane32_swap_b32 v128, v24
    v_permlane32_swap_b32 v129, v25
    v_permlane32_swap_b32 v130, v26
    v_permlane32_swap_b32 v131, v27
    s_nop 1
    v_cvt_pk_bf16_f32 v16, v128, v129
    v_lshlrev_b32 v128, 16, v16
    v_and_b32 v129, 0xffff0000, v16
    v_cvt_pk_bf16_f32 v16, v24, v25
    v_lshlrev_b32 v24, 16, v16
    v_and_b32 v25, 0xffff0000, v16
    v_cvt_pk_bf16_f32 v16, v130, v131
    v_lshlrev_b32 v130, 16, v16
    v_and_b32 v131, 0xffff0000, v16
    v_cvt_pk_bf16_f32 v16, v26, v27
    v_lshlrev_b32 v26, 16, v16
    v_and_b32 v27, 0xffff0000, v16
    v_mul_f32 v17, 0xbfb8aa3b, v128
    v_exp_f32 v17, v17
    s_nop 0
    v_add_f32 v17, 1.0, v17
    v_rcp_f32 v17, v17
    s_nop 0
    v_mul_f32 v128, v128, v17
    v_mul_f32 v17, 0xbfb8aa3b, v129
    v_exp_f32 v17, v17
    s_nop 0
    v_add_f32 v17, 1.0, v17
    v_rcp_f32 v17, v17
    s_nop 0
    v_mul_f32 v129, v129, v17
    v_mul_f32 v17, 0xbfb8aa3b, v130
    v_exp_f32 v17, v17
    s_nop 0
    v_add_f32 v17, 1.0, v17
    v_rcp_f32 v17, v17
    s_nop 0
    v_mul_f32 v130, v130, v17
    v_mul_f32 v17, 0xbfb8aa3b, v131
    v_exp_f32 v17, v17
    s_nop 0
    v_add_f32 v17, 1.0, v17
    v_rcp_f32 v17, v17
    s_nop 0
    v_mul_f32 v131, v131, v17
    v_cvt_pk_bf16_f32 v16, v128, v129
    v_lshlrev_b32 v128, 16, v16
    v_and_b32 v129, 0xffff0000, v16
    v_cvt_pk_bf16_f32 v16, v130, v131
    v_lshlrev_b32 v130, 16, v16
    v_and_b32 v131, 0xffff0000, v16
    v_mul_f32 v128, v128, v24
    v_mul_f32 v129, v129, v25
    v_mul_f32 v130, v130, v26
    v_mul_f32 v131, v131, v27
    v_cvt_pk_bf16_f32 v20, v128, v129
    v_cvt_pk_bf16_f32 v21, v130, v131
    v_add_u32 v22, 0, v13
    buffer_store_dwordx2 v[20:21], v22, s[20:23], 0 offen
    s_nop 1
    v_cvt_pk_bf16_f32 v16, v68, v69
    v_lshlrev_b32 v68, 16, v16
    v_and_b32 v69, 0xffff0000, v16
    v_cvt_pk_bf16_f32 v16, v100, v101
    v_lshlrev_b32 v100, 16, v16
    v_and_b32 v101, 0xffff0000, v16
    v_cvt_pk_bf16_f32 v16, v70, v71
    v_lshlrev_b32 v70, 16, v16
    v_and_b32 v71, 0xffff0000, v16
    v_cvt_pk_bf16_f32 v16, v102, v103
    v_lshlrev_b32 v102, 16, v16
    v_and_b32 v103, 0xffff0000, v16
    v_mul_f32 v17, 0xbfb8aa3b, v68
    v_exp_f32 v17, v17
    s_nop 0
    v_add_f32 v17, 1.0, v17
    v_rcp_f32 v17, v17
    s_nop 0
    v_mul_f32 v68, v68, v17
    v_mul_f32 v17, 0xbfb8aa3b, v69
    v_exp_f32 v17, v17
    s_nop 0
    v_add_f32 v17, 1.0, v17
    v_rcp_f32 v17, v17
    s_nop 0
    v_mul_f32 v69, v69, v17
    v_mul_f32 v17, 0xbfb8aa3b, v70
    v_exp_f32 v17, v17
    s_nop 0
    v_add_f32 v17, 1.0, v17
    v_rcp_f32 v17, v17
    s_nop 0
    v_mul_f32 v70, v70, v17
    v_mul_f32 v17, 0xbfb8aa3b, v71
    v_exp_f32 v17, v17
    s_nop 0
    v_add_f32 v17, 1.0, v17
    v_rcp_f32 v17, v17
    s_nop 0
    v_mul_f32 v71, v71, v17
    v_cvt_pk_bf16_f32 v16, v68, v69
    v_lshlrev_b32 v68, 16, v16
    v_and_b32 v69, 0xffff0000, v16
    v_cvt_pk_bf16_f32 v16, v70, v71
    v_lshlrev_b32 v70, 16, v16
    v_and_b32 v71, 0xffff0000, v16
    v_mul_f32 v68, v68, v100
    v_mul_f32 v69, v69, v101
    v_mul_f32 v70, v70, v102
    v_mul_f32 v71, v71, v103
    v_cvt_pk_bf16_f32 v20, v68, v69
    v_cvt_pk_bf16_f32 v21, v70, v71
    v_add_u32 v22, 256, v12
    buffer_store_dwordx2 v[20:21], v22, s[20:23], 0 offen
    v_mov_b32 v24, v132
    v_mov_b32 v25, v133
    v_mov_b32 v26, v134
    v_mov_b32 v27, v135
    s_nop 1
    v_permlane32_swap_b32 v132, v24
    v_permlane32_swap_b32 v133, v25
    v_permlane32_swap_b32 v134, v26
    v_permlane32_swap_b32 v135, v27
    s_nop 1
    v_cvt_pk_bf16_f32 v16, v132, v133
    v_lshlrev_b32 v132, 16, v16
    v_and_b32 v133, 0xffff0000, v16
    v_cvt_pk_bf16_f32 v16, v24, v25
    v_lshlrev_b32 v24, 16, v16
    v_and_b32 v25, 0xffff0000, v16
    v_cvt_pk_bf16_f32 v16, v134, v135
    v_lshlrev_b32 v134, 16, v16
    v_and_b32 v135, 0xffff0000, v16
    v_cvt_pk_bf16_f32 v16, v26, v27
    v_lshlrev_b32 v26, 16, v16
    v_and_b32 v27, 0xffff0000, v16
    v_mul_f32 v17, 0xbfb8aa3b, v132
    v_exp_f32 v17, v17
    s_nop 0
    v_add_f32 v17, 1.0, v17
    v_rcp_f32 v17, v17
    s_nop 0
    v_mul_f32 v132, v132, v17
    v_mul_f32 v17, 0xbfb8aa3b, v133
    v_exp_f32 v17, v17
    s_nop 0
    v_add_f32 v17, 1.0, v17
    v_rcp_f32 v17, v17
    s_nop 0
    v_mul_f32 v133, v133, v17
    v_mul_f32 v17, 0xbfb8aa3b, v134
    v_exp_f32 v17, v17
    s_nop 0
    v_add_f32 v17, 1.0, v17
    v_rcp_f32 v17, v17
    s_nop 0
    v_mul_f32 v134, v134, v17
    v_mul_f32 v17, 0xbfb8aa3b, v135
    v_exp_f32 v17, v17
    s_nop 0
    v_add_f32 v17, 1.0, v17
    v_rcp_f32 v17, v17
    s_nop 0
    v_mul_f32 v135, v135, v17
    v_cvt_pk_bf16_f32 v16, v132, v133
    v_lshlrev_b32 v132, 16, v16
    v_and_b32 v133, 0xffff0000, v16
    v_cvt_pk_bf16_f32 v16, v134, v135
    v_lshlrev_b32 v134, 16, v16
    v_and_b32 v135, 0xffff0000, v16
    v_mul_f32 v132, v132, v24
    v_mul_f32 v133, v133, v25
    v_mul_f32 v134, v134, v26
    v_mul_f32 v135, v135, v27
    v_cvt_pk_bf16_f32 v20, v132, v133
    v_cvt_pk_bf16_f32 v21, v134, v135
    v_add_u32 v22, 256, v13
    buffer_store_dwordx2 v[20:21], v22, s[20:23], 0 offen
    s_nop 1
    v_cvt_pk_bf16_f32 v16, v72, v73
    v_lshlrev_b32 v72, 16, v16
    v_and_b32 v73, 0xffff0000, v16
    v_cvt_pk_bf16_f32 v16, v104, v105
    v_lshlrev_b32 v104, 16, v16
    v_and_b32 v105, 0xffff0000, v16
    v_cvt_pk_bf16_f32 v16, v74, v75
    v_lshlrev_b32 v74, 16, v16
    v_and_b32 v75, 0xffff0000, v16
    v_cvt_pk_bf16_f32 v16, v106, v107
    v_lshlrev_b32 v106, 16, v16
    v_and_b32 v107, 0xffff0000, v16
    v_mul_f32 v17, 0xbfb8aa3b, v72
    v_exp_f32 v17, v17
    s_nop 0
    v_add_f32 v17, 1.0, v17
    v_rcp_f32 v17, v17
    s_nop 0
    v_mul_f32 v72, v72, v17
    v_mul_f32 v17, 0xbfb8aa3b, v73
    v_exp_f32 v17, v17
    s_nop 0
    v_add_f32 v17, 1.0, v17
    v_rcp_f32 v17, v17
    s_nop 0
    v_mul_f32 v73, v73, v17
    v_mul_f32 v17, 0xbfb8aa3b, v74
    v_exp_f32 v17, v17
    s_nop 0
    v_add_f32 v17, 1.0, v17
    v_rcp_f32 v17, v17
    s_nop 0
    v_mul_f32 v74, v74, v17
    v_mul_f32 v17, 0xbfb8aa3b, v75
    v_exp_f32 v17, v17
    s_nop 0
    v_add_f32 v17, 1.0, v17
    v_rcp_f32 v17, v17
    s_nop 0
    v_mul_f32 v75, v75, v17
    v_cvt_pk_bf16_f32 v16, v72, v73
    v_lshlrev_b32 v72, 16, v16
    v_and_b32 v73, 0xffff0000, v16
    v_cvt_pk_bf16_f32 v16, v74, v75
    v_lshlrev_b32 v74, 16, v16
    v_and_b32 v75, 0xffff0000, v16
    v_mul_f32 v72, v72, v104
    v_mul_f32 v73, v73, v105
    v_mul_f32 v74, v74, v106
    v_mul_f32 v75, v75, v107
    v_cvt_pk_bf16_f32 v20, v72, v73
    v_cvt_pk_bf16_f32 v21, v74, v75
    v_add_u32 v22, 88064, v12
    buffer_store_dwordx2 v[20:21], v22, s[20:23], 0 offen
    v_mov_b32 v24, v136
    v_mov_b32 v25, v137
    v_mov_b32 v26, v138
    v_mov_b32 v27, v139
    s_nop 1
    v_permlane32_swap_b32 v136, v24
    v_permlane32_swap_b32 v137, v25
    v_permlane32_swap_b32 v138, v26
    v_permlane32_swap_b32 v139, v27
    s_nop 1
    v_cvt_pk_bf16_f32 v16, v136, v137
    v_lshlrev_b32 v136, 16, v16
    v_and_b32 v137, 0xffff0000, v16
    v_cvt_pk_bf16_f32 v16, v24, v25
    v_lshlrev_b32 v24, 16, v16
    v_and_b32 v25, 0xffff0000, v16
    v_cvt_pk_bf16_f32 v16, v138, v139
    v_lshlrev_b32 v138, 16, v16
    v_and_b32 v139, 0xffff0000, v16
    v_cvt_pk_bf16_f32 v16, v26, v27
    v_lshlrev_b32 v26, 16, v16
    v_and_b32 v27, 0xffff0000, v16
    v_mul_f32 v17, 0xbfb8aa3b, v136
    v_exp_f32 v17, v17
    s_nop 0
    v_add_f32 v17, 1.0, v17
    v_rcp_f32 v17, v17
    s_nop 0
    v_mul_f32 v136, v136, v17
    v_mul_f32 v17, 0xbfb8aa3b, v137
    v_exp_f32 v17, v17
    s_nop 0
    v_add_f32 v17, 1.0, v17
    v_rcp_f32 v17, v17
    s_nop 0
    v_mul_f32 v137, v137, v17
    v_mul_f32 v17, 0xbfb8aa3b, v138
    v_exp_f32 v17, v17
    s_nop 0
    v_add_f32 v17, 1.0, v17
    v_rcp_f32 v17, v17
    s_nop 0
    v_mul_f32 v138, v138, v17
    v_mul_f32 v17, 0xbfb8aa3b, v139
    v_exp_f32 v17, v17
    s_nop 0
    v_add_f32 v17, 1.0, v17
    v_rcp_f32 v17, v17
    s_nop 0
    v_mul_f32 v139, v139, v17
    v_cvt_pk_bf16_f32 v16, v136, v137
    v_lshlrev_b32 v136, 16, v16
    v_and_b32 v137, 0xffff0000, v16
    v_cvt_pk_bf16_f32 v16, v138, v139
    v_lshlrev_b32 v138, 16, v16
    v_and_b32 v139, 0xffff0000, v16
    v_mul_f32 v136, v136, v24
    v_mul_f32 v137, v137, v25
    v_mul_f32 v138, v138, v26
    v_mul_f32 v139, v139, v27
    v_cvt_pk_bf16_f32 v20, v136, v137
    v_cvt_pk_bf16_f32 v21, v138, v139
    v_add_u32 v22, 88064, v13
    buffer_store_dwordx2 v[20:21], v22, s[20:23], 0 offen
    s_nop 1
    v_cvt_pk_bf16_f32 v16, v76, v77
    v_lshlrev_b32 v76, 16, v16
    v_and_b32 v77, 0xffff0000, v16
    v_cvt_pk_bf16_f32 v16, v108, v109
    v_lshlrev_b32 v108, 16, v16
    v_and_b32 v109, 0xffff0000, v16
    v_cvt_pk_bf16_f32 v16, v78, v79
    v_lshlrev_b32 v78, 16, v16
    v_and_b32 v79, 0xffff0000, v16
    v_cvt_pk_bf16_f32 v16, v110, v111
    v_lshlrev_b32 v110, 16, v16
    v_and_b32 v111, 0xffff0000, v16
    v_mul_f32 v17, 0xbfb8aa3b, v76
    v_exp_f32 v17, v17
    s_nop 0
    v_add_f32 v17, 1.0, v17
    v_rcp_f32 v17, v17
    s_nop 0
    v_mul_f32 v76, v76, v17
    v_mul_f32 v17, 0xbfb8aa3b, v77
    v_exp_f32 v17, v17
    s_nop 0
    v_add_f32 v17, 1.0, v17
    v_rcp_f32 v17, v17
    s_nop 0
    v_mul_f32 v77, v77, v17
    v_mul_f32 v17, 0xbfb8aa3b, v78
    v_exp_f32 v17, v17
    s_nop 0
    v_add_f32 v17, 1.0, v17
    v_rcp_f32 v17, v17
    s_nop 0
    v_mul_f32 v78, v78, v17
    v_mul_f32 v17, 0xbfb8aa3b, v79
    v_exp_f32 v17, v17
    s_nop 0
    v_add_f32 v17, 1.0, v17
    v_rcp_f32 v17, v17
    s_nop 0
    v_mul_f32 v79, v79, v17
    v_cvt_pk_bf16_f32 v16, v76, v77
    v_lshlrev_b32 v76, 16, v16
    v_and_b32 v77, 0xffff0000, v16
    v_cvt_pk_bf16_f32 v16, v78, v79
    v_lshlrev_b32 v78, 16, v16
    v_and_b32 v79, 0xffff0000, v16
    v_mul_f32 v76, v76, v108
    v_mul_f32 v77, v77, v109
    v_mul_f32 v78, v78, v110
    v_mul_f32 v79, v79, v111
    v_cvt_pk_bf16_f32 v20, v76, v77
    v_cvt_pk_bf16_f32 v21, v78, v79
    v_add_u32 v22, 88320, v12
    buffer_store_dwordx2 v[20:21], v22, s[20:23], 0 offen
    v_mov_b32 v24, v140
    v_mov_b32 v25, v141
    v_mov_b32 v26, v142
    v_mov_b32 v27, v143
    s_nop 1
    v_permlane32_swap_b32 v140, v24
    v_permlane32_swap_b32 v141, v25
    v_permlane32_swap_b32 v142, v26
    v_permlane32_swap_b32 v143, v27
    s_nop 1
    v_cvt_pk_bf16_f32 v16, v140, v141
    v_lshlrev_b32 v140, 16, v16
    v_and_b32 v141, 0xffff0000, v16
    v_cvt_pk_bf16_f32 v16, v24, v25
    v_lshlrev_b32 v24, 16, v16
    v_and_b32 v25, 0xffff0000, v16
    v_cvt_pk_bf16_f32 v16, v142, v143
    v_lshlrev_b32 v142, 16, v16
    v_and_b32 v143, 0xffff0000, v16
    v_cvt_pk_bf16_f32 v16, v26, v27
    v_lshlrev_b32 v26, 16, v16
    v_and_b32 v27, 0xffff0000, v16
    v_mul_f32 v17, 0xbfb8aa3b, v140
    v_exp_f32 v17, v17
    s_nop 0
    v_add_f32 v17, 1.0, v17
    v_rcp_f32 v17, v17
    s_nop 0
    v_mul_f32 v140, v140, v17
    v_mul_f32 v17, 0xbfb8aa3b, v141
    v_exp_f32 v17, v17
    s_nop 0
    v_add_f32 v17, 1.0, v17
    v_rcp_f32 v17, v17
    s_nop 0
    v_mul_f32 v141, v141, v17
    v_mul_f32 v17, 0xbfb8aa3b, v142
    v_exp_f32 v17, v17
    s_nop 0
    v_add_f32 v17, 1.0, v17
    v_rcp_f32 v17, v17
    s_nop 0
    v_mul_f32 v142, v142, v17
    v_mul_f32 v17, 0xbfb8aa3b, v143
    v_exp_f32 v17, v17
    s_nop 0
    v_add_f32 v17, 1.0, v17
    v_rcp_f32 v17, v17
    s_nop 0
    v_mul_f32 v143, v143, v17
    v_cvt_pk_bf16_f32 v16, v140, v141
    v_lshlrev_b32 v140, 16, v16
    v_and_b32 v141, 0xffff0000, v16
    v_cvt_pk_bf16_f32 v16, v142, v143
    v_lshlrev_b32 v142, 16, v16
    v_and_b32 v143, 0xffff0000, v16
    v_mul_f32 v140, v140, v24
    v_mul_f32 v141, v141, v25
    v_mul_f32 v142, v142, v26
    v_mul_f32 v143, v143, v27
    v_cvt_pk_bf16_f32 v20, v140, v141
    v_cvt_pk_bf16_f32 v21, v142, v143
    v_add_u32 v22, 88320, v13
    buffer_store_dwordx2 v[20:21], v22, s[20:23], 0 offen
    s_nop 1
    v_cvt_pk_bf16_f32 v16, v80, v81
    v_lshlrev_b32 v80, 16, v16
    v_and_b32 v81, 0xffff0000, v16
    v_cvt_pk_bf16_f32 v16, v112, v113
    v_lshlrev_b32 v112, 16, v16
    v_and_b32 v113, 0xffff0000, v16
    v_cvt_pk_bf16_f32 v16, v82, v83
    v_lshlrev_b32 v82, 16, v16
    v_and_b32 v83, 0xffff0000, v16
    v_cvt_pk_bf16_f32 v16, v114, v115
    v_lshlrev_b32 v114, 16, v16
    v_and_b32 v115, 0xffff0000, v16
    v_mul_f32 v17, 0xbfb8aa3b, v80
    v_exp_f32 v17, v17
    s_nop 0
    v_add_f32 v17, 1.0, v17
    v_rcp_f32 v17, v17
    s_nop 0
    v_mul_f32 v80, v80, v17
    v_mul_f32 v17, 0xbfb8aa3b, v81
    v_exp_f32 v17, v17
    s_nop 0
    v_add_f32 v17, 1.0, v17
    v_rcp_f32 v17, v17
    s_nop 0
    v_mul_f32 v81, v81, v17
    v_mul_f32 v17, 0xbfb8aa3b, v82
    v_exp_f32 v17, v17
    s_nop 0
    v_add_f32 v17, 1.0, v17
    v_rcp_f32 v17, v17
    s_nop 0
    v_mul_f32 v82, v82, v17
    v_mul_f32 v17, 0xbfb8aa3b, v83
    v_exp_f32 v17, v17
    s_nop 0
    v_add_f32 v17, 1.0, v17
    v_rcp_f32 v17, v17
    s_nop 0
    v_mul_f32 v83, v83, v17
    v_cvt_pk_bf16_f32 v16, v80, v81
    v_lshlrev_b32 v80, 16, v16
    v_and_b32 v81, 0xffff0000, v16
    v_cvt_pk_bf16_f32 v16, v82, v83
    v_lshlrev_b32 v82, 16, v16
    v_and_b32 v83, 0xffff0000, v16
    v_mul_f32 v80, v80, v112
    v_mul_f32 v81, v81, v113
    v_mul_f32 v82, v82, v114
    v_mul_f32 v83, v83, v115
    v_cvt_pk_bf16_f32 v20, v80, v81
    v_cvt_pk_bf16_f32 v21, v82, v83
    v_add_u32 v22, 176128, v12
    buffer_store_dwordx2 v[20:21], v22, s[20:23], 0 offen
    v_mov_b32 v24, v144
    v_mov_b32 v25, v145
    v_mov_b32 v26, v146
    v_mov_b32 v27, v147
    s_nop 1
    v_permlane32_swap_b32 v144, v24
    v_permlane32_swap_b32 v145, v25
    v_permlane32_swap_b32 v146, v26
    v_permlane32_swap_b32 v147, v27
    s_nop 1
    v_cvt_pk_bf16_f32 v16, v144, v145
    v_lshlrev_b32 v144, 16, v16
    v_and_b32 v145, 0xffff0000, v16
    v_cvt_pk_bf16_f32 v16, v24, v25
    v_lshlrev_b32 v24, 16, v16
    v_and_b32 v25, 0xffff0000, v16
    v_cvt_pk_bf16_f32 v16, v146, v147
    v_lshlrev_b32 v146, 16, v16
    v_and_b32 v147, 0xffff0000, v16
    v_cvt_pk_bf16_f32 v16, v26, v27
    v_lshlrev_b32 v26, 16, v16
    v_and_b32 v27, 0xffff0000, v16
    v_mul_f32 v17, 0xbfb8aa3b, v144
    v_exp_f32 v17, v17
    s_nop 0
    v_add_f32 v17, 1.0, v17
    v_rcp_f32 v17, v17
    s_nop 0
    v_mul_f32 v144, v144, v17
    v_mul_f32 v17, 0xbfb8aa3b, v145
    v_exp_f32 v17, v17
    s_nop 0
    v_add_f32 v17, 1.0, v17
    v_rcp_f32 v17, v17
    s_nop 0
    v_mul_f32 v145, v145, v17
    v_mul_f32 v17, 0xbfb8aa3b, v146
    v_exp_f32 v17, v17
    s_nop 0
    v_add_f32 v17, 1.0, v17
    v_rcp_f32 v17, v17
    s_nop 0
    v_mul_f32 v146, v146, v17
    v_mul_f32 v17, 0xbfb8aa3b, v147
    v_exp_f32 v17, v17
    s_nop 0
    v_add_f32 v17, 1.0, v17
    v_rcp_f32 v17, v17
    s_nop 0
    v_mul_f32 v147, v147, v17
    v_cvt_pk_bf16_f32 v16, v144, v145
    v_lshlrev_b32 v144, 16, v16
    v_and_b32 v145, 0xffff0000, v16
    v_cvt_pk_bf16_f32 v16, v146, v147
    v_lshlrev_b32 v146, 16, v16
    v_and_b32 v147, 0xffff0000, v16
    v_mul_f32 v144, v144, v24
    v_mul_f32 v145, v145, v25
    v_mul_f32 v146, v146, v26
    v_mul_f32 v147, v147, v27
    v_cvt_pk_bf16_f32 v20, v144, v145
    v_cvt_pk_bf16_f32 v21, v146, v147
    v_add_u32 v22, 176128, v13
    buffer_store_dwordx2 v[20:21], v22, s[20:23], 0 offen
    s_nop 1
    v_cvt_pk_bf16_f32 v16, v84, v85
    v_lshlrev_b32 v84, 16, v16
    v_and_b32 v85, 0xffff0000, v16
    v_cvt_pk_bf16_f32 v16, v116, v117
    v_lshlrev_b32 v116, 16, v16
    v_and_b32 v117, 0xffff0000, v16
    v_cvt_pk_bf16_f32 v16, v86, v87
    v_lshlrev_b32 v86, 16, v16
    v_and_b32 v87, 0xffff0000, v16
    v_cvt_pk_bf16_f32 v16, v118, v119
    v_lshlrev_b32 v118, 16, v16
    v_and_b32 v119, 0xffff0000, v16
    v_mul_f32 v17, 0xbfb8aa3b, v84
    v_exp_f32 v17, v17
    s_nop 0
    v_add_f32 v17, 1.0, v17
    v_rcp_f32 v17, v17
    s_nop 0
    v_mul_f32 v84, v84, v17
    v_mul_f32 v17, 0xbfb8aa3b, v85
    v_exp_f32 v17, v17
    s_nop 0
    v_add_f32 v17, 1.0, v17
    v_rcp_f32 v17, v17
    s_nop 0
    v_mul_f32 v85, v85, v17
    v_mul_f32 v17, 0xbfb8aa3b, v86
    v_exp_f32 v17, v17
    s_nop 0
    v_add_f32 v17, 1.0, v17
    v_rcp_f32 v17, v17
    s_nop 0
    v_mul_f32 v86, v86, v17
    v_mul_f32 v17, 0xbfb8aa3b, v87
    v_exp_f32 v17, v17
    s_nop 0
    v_add_f32 v17, 1.0, v17
    v_rcp_f32 v17, v17
    s_nop 0
    v_mul_f32 v87, v87, v17
    v_cvt_pk_bf16_f32 v16, v84, v85
    v_lshlrev_b32 v84, 16, v16
    v_and_b32 v85, 0xffff0000, v16
    v_cvt_pk_bf16_f32 v16, v86, v87
    v_lshlrev_b32 v86, 16, v16
    v_and_b32 v87, 0xffff0000, v16
    v_mul_f32 v84, v84, v116
    v_mul_f32 v85, v85, v117
    v_mul_f32 v86, v86, v118
    v_mul_f32 v87, v87, v119
    v_cvt_pk_bf16_f32 v20, v84, v85
    v_cvt_pk_bf16_f32 v21, v86, v87
    v_add_u32 v22, 176384, v12
    buffer_store_dwordx2 v[20:21], v22, s[20:23], 0 offen
    v_mov_b32 v24, v148
    v_mov_b32 v25, v149
    v_mov_b32 v26, v150
    v_mov_b32 v27, v151
    s_nop 1
    v_permlane32_swap_b32 v148, v24
    v_permlane32_swap_b32 v149, v25
    v_permlane32_swap_b32 v150, v26
    v_permlane32_swap_b32 v151, v27
    s_nop 1
    v_cvt_pk_bf16_f32 v16, v148, v149
    v_lshlrev_b32 v148, 16, v16
    v_and_b32 v149, 0xffff0000, v16
    v_cvt_pk_bf16_f32 v16, v24, v25
    v_lshlrev_b32 v24, 16, v16
    v_and_b32 v25, 0xffff0000, v16
    v_cvt_pk_bf16_f32 v16, v150, v151
    v_lshlrev_b32 v150, 16, v16
    v_and_b32 v151, 0xffff0000, v16
    v_cvt_pk_bf16_f32 v16, v26, v27
    v_lshlrev_b32 v26, 16, v16
    v_and_b32 v27, 0xffff0000, v16
    v_mul_f32 v17, 0xbfb8aa3b, v148
    v_exp_f32 v17, v17
    s_nop 0
    v_add_f32 v17, 1.0, v17
    v_rcp_f32 v17, v17
    s_nop 0
    v_mul_f32 v148, v148, v17
    v_mul_f32 v17, 0xbfb8aa3b, v149
    v_exp_f32 v17, v17
    s_nop 0
    v_add_f32 v17, 1.0, v17
    v_rcp_f32 v17, v17
    s_nop 0
    v_mul_f32 v149, v149, v17
    v_mul_f32 v17, 0xbfb8aa3b, v150
    v_exp_f32 v17, v17
    s_nop 0
    v_add_f32 v17, 1.0, v17
    v_rcp_f32 v17, v17
    s_nop 0
    v_mul_f32 v150, v150, v17
    v_mul_f32 v17, 0xbfb8aa3b, v151
    v_exp_f32 v17, v17
    s_nop 0
    v_add_f32 v17, 1.0, v17
    v_rcp_f32 v17, v17
    s_nop 0
    v_mul_f32 v151, v151, v17
    v_cvt_pk_bf16_f32 v16, v148, v149
    v_lshlrev_b32 v148, 16, v16
    v_and_b32 v149, 0xffff0000, v16
    v_cvt_pk_bf16_f32 v16, v150, v151
    v_lshlrev_b32 v150, 16, v16
    v_and_b32 v151, 0xffff0000, v16
    v_mul_f32 v148, v148, v24
    v_mul_f32 v149, v149, v25
    v_mul_f32 v150, v150, v26
    v_mul_f32 v151, v151, v27
    v_cvt_pk_bf16_f32 v20, v148, v149
    v_cvt_pk_bf16_f32 v21, v150, v151
    v_add_u32 v22, 176384, v13
    buffer_store_dwordx2 v[20:21], v22, s[20:23], 0 offen
    s_nop 1
    v_cvt_pk_bf16_f32 v16, v88, v89
    v_lshlrev_b32 v88, 16, v16
    v_and_b32 v89, 0xffff0000, v16
    v_cvt_pk_bf16_f32 v16, v120, v121
    v_lshlrev_b32 v120, 16, v16
    v_and_b32 v121, 0xffff0000, v16
    v_cvt_pk_bf16_f32 v16, v90, v91
    v_lshlrev_b32 v90, 16, v16
    v_and_b32 v91, 0xffff0000, v16
    v_cvt_pk_bf16_f32 v16, v122, v123
    v_lshlrev_b32 v122, 16, v16
    v_and_b32 v123, 0xffff0000, v16
    v_mul_f32 v17, 0xbfb8aa3b, v88
    v_exp_f32 v17, v17
    s_nop 0
    v_add_f32 v17, 1.0, v17
    v_rcp_f32 v17, v17
    s_nop 0
    v_mul_f32 v88, v88, v17
    v_mul_f32 v17, 0xbfb8aa3b, v89
    v_exp_f32 v17, v17
    s_nop 0
    v_add_f32 v17, 1.0, v17
    v_rcp_f32 v17, v17
    s_nop 0
    v_mul_f32 v89, v89, v17
    v_mul_f32 v17, 0xbfb8aa3b, v90
    v_exp_f32 v17, v17
    s_nop 0
    v_add_f32 v17, 1.0, v17
    v_rcp_f32 v17, v17
    s_nop 0
    v_mul_f32 v90, v90, v17
    v_mul_f32 v17, 0xbfb8aa3b, v91
    v_exp_f32 v17, v17
    s_nop 0
    v_add_f32 v17, 1.0, v17
    v_rcp_f32 v17, v17
    s_nop 0
    v_mul_f32 v91, v91, v17
    v_cvt_pk_bf16_f32 v16, v88, v89
    v_lshlrev_b32 v88, 16, v16
    v_and_b32 v89, 0xffff0000, v16
    v_cvt_pk_bf16_f32 v16, v90, v91
    v_lshlrev_b32 v90, 16, v16
    v_and_b32 v91, 0xffff0000, v16
    v_mul_f32 v88, v88, v120
    v_mul_f32 v89, v89, v121
    v_mul_f32 v90, v90, v122
    v_mul_f32 v91, v91, v123
    v_cvt_pk_bf16_f32 v20, v88, v89
    v_cvt_pk_bf16_f32 v21, v90, v91
    v_add_u32 v22, 264192, v12
    buffer_store_dwordx2 v[20:21], v22, s[20:23], 0 offen
    v_mov_b32 v24, v152
    v_mov_b32 v25, v153
    v_mov_b32 v26, v154
    v_mov_b32 v27, v155
    s_nop 1
    v_permlane32_swap_b32 v152, v24
    v_permlane32_swap_b32 v153, v25
    v_permlane32_swap_b32 v154, v26
    v_permlane32_swap_b32 v155, v27
    s_nop 1
    v_cvt_pk_bf16_f32 v16, v152, v153
    v_lshlrev_b32 v152, 16, v16
    v_and_b32 v153, 0xffff0000, v16
    v_cvt_pk_bf16_f32 v16, v24, v25
    v_lshlrev_b32 v24, 16, v16
    v_and_b32 v25, 0xffff0000, v16
    v_cvt_pk_bf16_f32 v16, v154, v155
    v_lshlrev_b32 v154, 16, v16
    v_and_b32 v155, 0xffff0000, v16
    v_cvt_pk_bf16_f32 v16, v26, v27
    v_lshlrev_b32 v26, 16, v16
    v_and_b32 v27, 0xffff0000, v16
    v_mul_f32 v17, 0xbfb8aa3b, v152
    v_exp_f32 v17, v17
    s_nop 0
    v_add_f32 v17, 1.0, v17
    v_rcp_f32 v17, v17
    s_nop 0
    v_mul_f32 v152, v152, v17
    v_mul_f32 v17, 0xbfb8aa3b, v153
    v_exp_f32 v17, v17
    s_nop 0
    v_add_f32 v17, 1.0, v17
    v_rcp_f32 v17, v17
    s_nop 0
    v_mul_f32 v153, v153, v17
    v_mul_f32 v17, 0xbfb8aa3b, v154
    v_exp_f32 v17, v17
    s_nop 0
    v_add_f32 v17, 1.0, v17
    v_rcp_f32 v17, v17
    s_nop 0
    v_mul_f32 v154, v154, v17
    v_mul_f32 v17, 0xbfb8aa3b, v155
    v_exp_f32 v17, v17
    s_nop 0
    v_add_f32 v17, 1.0, v17
    v_rcp_f32 v17, v17
    s_nop 0
    v_mul_f32 v155, v155, v17
    v_cvt_pk_bf16_f32 v16, v152, v153
    v_lshlrev_b32 v152, 16, v16
    v_and_b32 v153, 0xffff0000, v16
    v_cvt_pk_bf16_f32 v16, v154, v155
    v_lshlrev_b32 v154, 16, v16
    v_and_b32 v155, 0xffff0000, v16
    v_mul_f32 v152, v152, v24
    v_mul_f32 v153, v153, v25
    v_mul_f32 v154, v154, v26
    v_mul_f32 v155, v155, v27
    v_cvt_pk_bf16_f32 v20, v152, v153
    v_cvt_pk_bf16_f32 v21, v154, v155
    v_add_u32 v22, 264192, v13
    buffer_store_dwordx2 v[20:21], v22, s[20:23], 0 offen
    s_nop 1
    v_cvt_pk_bf16_f32 v16, v92, v93
    v_lshlrev_b32 v92, 16, v16
    v_and_b32 v93, 0xffff0000, v16
    v_cvt_pk_bf16_f32 v16, v124, v125
    v_lshlrev_b32 v124, 16, v16
    v_and_b32 v125, 0xffff0000, v16
    v_cvt_pk_bf16_f32 v16, v94, v95
    v_lshlrev_b32 v94, 16, v16
    v_and_b32 v95, 0xffff0000, v16
    v_cvt_pk_bf16_f32 v16, v126, v127
    v_lshlrev_b32 v126, 16, v16
    v_and_b32 v127, 0xffff0000, v16
    v_mul_f32 v17, 0xbfb8aa3b, v92
    v_exp_f32 v17, v17
    s_nop 0
    v_add_f32 v17, 1.0, v17
    v_rcp_f32 v17, v17
    s_nop 0
    v_mul_f32 v92, v92, v17
    v_mul_f32 v17, 0xbfb8aa3b, v93
    v_exp_f32 v17, v17
    s_nop 0
    v_add_f32 v17, 1.0, v17
    v_rcp_f32 v17, v17
    s_nop 0
    v_mul_f32 v93, v93, v17
    v_mul_f32 v17, 0xbfb8aa3b, v94
    v_exp_f32 v17, v17
    s_nop 0
    v_add_f32 v17, 1.0, v17
    v_rcp_f32 v17, v17
    s_nop 0
    v_mul_f32 v94, v94, v17
    v_mul_f32 v17, 0xbfb8aa3b, v95
    v_exp_f32 v17, v17
    s_nop 0
    v_add_f32 v17, 1.0, v17
    v_rcp_f32 v17, v17
    s_nop 0
    v_mul_f32 v95, v95, v17
    v_cvt_pk_bf16_f32 v16, v92, v93
    v_lshlrev_b32 v92, 16, v16
    v_and_b32 v93, 0xffff0000, v16
    v_cvt_pk_bf16_f32 v16, v94, v95
    v_lshlrev_b32 v94, 16, v16
    v_and_b32 v95, 0xffff0000, v16
    v_mul_f32 v92, v92, v124
    v_mul_f32 v93, v93, v125
    v_mul_f32 v94, v94, v126
    v_mul_f32 v95, v95, v127
    v_cvt_pk_bf16_f32 v20, v92, v93
    v_cvt_pk_bf16_f32 v21, v94, v95
    v_add_u32 v22, 264448, v12
    buffer_store_dwordx2 v[20:21], v22, s[20:23], 0 offen
    v_mov_b32 v24, v156
    v_mov_b32 v25, v157
    v_mov_b32 v26, v158
    v_mov_b32 v27, v159
    s_nop 1
    v_permlane32_swap_b32 v156, v24
    v_permlane32_swap_b32 v157, v25
    v_permlane32_swap_b32 v158, v26
    v_permlane32_swap_b32 v159, v27
    s_nop 1
    v_cvt_pk_bf16_f32 v16, v156, v157
    v_lshlrev_b32 v156, 16, v16
    v_and_b32 v157, 0xffff0000, v16
    v_cvt_pk_bf16_f32 v16, v24, v25
    v_lshlrev_b32 v24, 16, v16
    v_and_b32 v25, 0xffff0000, v16
    v_cvt_pk_bf16_f32 v16, v158, v159
    v_lshlrev_b32 v158, 16, v16
    v_and_b32 v159, 0xffff0000, v16
    v_cvt_pk_bf16_f32 v16, v26, v27
    v_lshlrev_b32 v26, 16, v16
    v_and_b32 v27, 0xffff0000, v16
    v_mul_f32 v17, 0xbfb8aa3b, v156
    v_exp_f32 v17, v17
    s_nop 0
    v_add_f32 v17, 1.0, v17
    v_rcp_f32 v17, v17
    s_nop 0
    v_mul_f32 v156, v156, v17
    v_mul_f32 v17, 0xbfb8aa3b, v157
    v_exp_f32 v17, v17
    s_nop 0
    v_add_f32 v17, 1.0, v17
    v_rcp_f32 v17, v17
    s_nop 0
    v_mul_f32 v157, v157, v17
    v_mul_f32 v17, 0xbfb8aa3b, v158
    v_exp_f32 v17, v17
    s_nop 0
    v_add_f32 v17, 1.0, v17
    v_rcp_f32 v17, v17
    s_nop 0
    v_mul_f32 v158, v158, v17
    v_mul_f32 v17, 0xbfb8aa3b, v159
    v_exp_f32 v17, v17
    s_nop 0
    v_add_f32 v17, 1.0, v17
    v_rcp_f32 v17, v17
    s_nop 0
    v_mul_f32 v159, v159, v17
    v_cvt_pk_bf16_f32 v16, v156, v157
    v_lshlrev_b32 v156, 16, v16
    v_and_b32 v157, 0xffff0000, v16
    v_cvt_pk_bf16_f32 v16, v158, v159
    v_lshlrev_b32 v158, 16, v16
    v_and_b32 v159, 0xffff0000, v16
    v_mul_f32 v156, v156, v24
    v_mul_f32 v157, v157, v25
    v_mul_f32 v158, v158, v26
    v_mul_f32 v159, v159, v27
    v_cvt_pk_bf16_f32 v20, v156, v157
    v_cvt_pk_bf16_f32 v21, v158, v159
    v_add_u32 v22, 264448, v13
    buffer_store_dwordx2 v[20:21], v22, s[20:23], 0 offen
    s_nop 1
    s_waitcnt vmcnt(0)
L_ffn1b_kernel_done:
    s_endpgm
.globl ffn2b_kernel
.p2align 8
.type ffn2b_kernel,@function
ffn2b_kernel:
    s_cmp_ge_u32 s2, 256
    s_cbranch_scc1 L_ffn2b_kernel_done
    s_load_dwordx2 s[4:5], s[0:1], 80
    s_load_dwordx2 s[8:9], s[0:1], 96
    s_lshr_b32 s25, s2, 3
    s_and_b32 s26, s2, 7
    s_waitcnt lgkmcnt(0)
    s_mov_b32 s20, s8
    s_mov_b32 s21, s9
    s_mov_b32 s22, 25165824
    s_mov_b32 s23, 0x00020000
    s_mov_b32 s12, s4
    s_mov_b32 s13, s5
    s_mov_b32 s14, 2097152
    s_mov_b32 s15, 0x00020000
    v_lshrrev_b32 v1, 6, v0
    s_nop 0
    v_readfirstlane_b32 s27, v1
    v_and_b32 v1, 63, v0
    s_nop 2
    s_mul_i32 s28, s27, 22
    s_cmp_eq_u32 s27, 3
    s_cselect_b32 s29, 1, 0
    s_sub_u32 s28, s28, s29
    s_cmp_ge_u32 s27, 2
    s_cselect_b32 s29, 21, 22
    s_lshl_b32 s30, s25, 1
    s_mul_i32 s30, s30, 86
    s_add_u32 s30, s30, s28
    s_lshl_b32 s30, s30, 10
    s_add_u32 s30, s30, 10485760
    v_lshl_add_u32 v2, v1, 4, s30
    v_add_u32 v3, 88064, v2
    s_lshl_b32 s30, s26, 1
    s_mul_i32 s30, s30, 86
    s_add_u32 s30, s30, s28
    s_lshl_b32 s30, s30, 10
    s_add_u32 s30, s30, 20971520
    v_lshl_add_u32 v4, v1, 4, s30
    v_add_u32 v5, 88064, v4
    v_mov_b32 v64, 0
    v_mov_b32 v65, 0
    v_mov_b32 v66, 0
    v_mov_b32 v67, 0
    v_mov_b32 v68, 0
    v_mov_b32 v69, 0
    v_mov_b32 v70, 0
    v_mov_b32 v71, 0
    v_mov_b32 v72, 0
    v_mov_b32 v73, 0
    v_mov_b32 v74, 0
    v_mov_b32 v75, 0
    v_mov_b32 v76, 0
    v_mov_b32 v77, 0
    v_mov_b32 v78, 0
    v_mov_b32 v79, 0
    v_mov_b32 v80, 0
    v_mov_b32 v81, 0
    v_mov_b32 v82, 0
    v_mov_b32 v83, 0
    v_mov_b32 v84, 0
    v_mov_b32 v85, 0
    v_mov_b32 v86, 0
    v_mov_b32 v87, 0
    v_mov_b32 v88, 0
    v_mov_b32 v89, 0
    v_mov_b32 v90, 0
    v_mov_b32 v91, 0
    v_mov_b32 v92, 0
    v_mov_b32 v93, 0
    v_mov_b32 v94, 0
    v_mov_b32 v95, 0
    v_mov_b32 v96, 0
    v_mov_b32 v97, 0
    v_mov_b32 v98, 0
    v_mov_b32 v99, 0
    v_mov_b32 v100, 0
    v_mov_b32 v101, 0
    v_mov_b32 v102, 0
    v_mov_b32 v103, 0
    v_mov_b32 v104, 0
    v_mov_b32 v105, 0
    v_mov_b32 v106, 0
    v_mov_b32 v107, 0
    v_mov_b32 v108, 0
    v_mov_b32 v109, 0
    v_mov_b32 v110, 0
    v_mov_b32 v111, 0
    v_mov_b32 v112, 0
    v_mov_b32 v113, 0
    v_mov_b32 v114, 0
    v_mov_b32 v115, 0
    v_mov_b32 v116, 0
    v_mov_b32 v117, 0
    v_mov_b32 v118, 0
    v_mov_b32 v119, 0
    v_mov_b32 v120, 0
    v_mov_b32 v121, 0
    v_mov_b32 v122, 0
    v_mov_b32 v123, 0
    v_mov_b32 v124, 0
    v_mov_b32 v125, 0
    v_mov_b32 v126, 0
    v_mov_b32 v127, 0
    buffer_load_dwordx4 v[128:131], v2, s[20:23], 0 offen offset:0
    buffer_load_dwordx4 v[132:135], v3, s[20:23], 0 offen offset:0
    buffer_load_dwordx4 v[136:139], v4, s[20:23], 0 offen offset:0
    buffer_load_dwordx4 v[140:143], v5, s[20:23], 0 offen offset:0
    buffer_load_dwordx4 v[144:147], v2, s[20:23], 0 offen offset:1024
    buffer_load_dwordx4 v[148:151], v3, s[20:23], 0 offen offset:1024
    buffer_load_dwordx4 v[152:155], v4, s[20:23], 0 offen offset:1024
    buffer_load_dwordx4 v[156:159], v5, s[20:23], 0 offen offset:1024
    buffer_load_dwordx4 v[160:163], v2, s[20:23], 0 offen offset:2048
    buffer_load_dwordx4 v[164:167], v3, s[20:23], 0 offen offset:2048
    buffer_load_dwordx4 v[168:171], v4, s[20:23], 0 offen offset:2048
    buffer_load_dwordx4 v[172:175], v5, s[20:23], 0 offen offset:2048
    buffer_load_dwordx4 v[176:179], v2, s[20:23], 0 offen offset:3072
    buffer_load_dwordx4 v[180:183], v3, s[20:23], 0 offen offset:3072
    buffer_load_dwordx4 v[184:187], v4, s[20:23], 0 offen offset:3072
    buffer_load_dwordx4 v[188:191], v5, s[20:23], 0 offen offset:3072
    v_add_u32 v2, 4096, v2
    v_add_u32 v3, 4096, v3
    v_add_u32 v4, 4096, v4
    v_add_u32 v5, 4096, v5
    buffer_load_dwordx4 v[192:195], v2, s[20:23], 0 offen offset:0
    buffer_load_dwordx4 v[196:199], v3, s[20:23], 0 offen offset:0
    buffer_load_dwordx4 v[200:203], v4, s[20:23], 0 offen offset:0
    buffer_load_dwordx4 v[204:207], v5, s[20:23], 0 offen offset:0
    s_waitcnt vmcnt(16)
    v_mfma_f32_32x32x16_bf16 v[64:79], v[136:139], v[128:131], v[64:79]
    v_mfma_f32_32x32x16_bf16 v[80:95], v[136:139], v[132:135], v[80:95]
    v_mfma_f32_32x32x16_bf16 v[96:111], v[140:143], v[128:131], v[96:111]
    v_mfma_f32_32x32x16_bf16 v[112:127], v[140:143], v[132:135], v[112:127]
    buffer_load_dwordx4 v[128:131], v2, s[20:23], 0 offen offset:1024
    buffer_load_dwordx4 v[132:135], v3, s[20:23], 0 offen offset:1024
    buffer_load_dwordx4 v[136:139], v4, s[20:23], 0 offen offset:1024
    buffer_load_dwordx4 v[140:143], v5, s[20:23], 0 offen offset:1024
    s_waitcnt vmcnt(16)
    v_mfma_f32_32x32x16_bf16 v[64:79], v[152:155], v[144:147], v[64:79]
    v_mfma_f32_32x32x16_bf16 v[80:95], v[152:155], v[148:151], v[80:95]
    v_mfma_f32_32x32x16_bf16 v[96:111], v[156:159], v[144:147], v[96:111]
    v_mfma_f32_32x32x16_bf16 v[112:127], v[156:159], v[148:151], v[112:127]
    buffer_load_dwordx4 v[144:147], v2, s[20:23], 0 offen offset:2048
    buffer_load_dwordx4 v[148:151], v3, s[20:23], 0 offen offset:2048
    buffer_load_dwordx4 v[152:155], v4, s[20:23], 0 offen offset:2048
    buffer_load_dwordx4 v[156:159], v5, s[20:23], 0 offen offset:2048
    s_waitcnt vmcnt(16)
    v_mfma_f32_32x32x16_bf16 v[64:79], v[168:171], v[160:163], v[64:79]
    v_mfma_f32_32x32x16_bf16 v[80:95], v[168:171], v[164:167], v[80:95]
    v_mfma_f32_32x32x16_bf16 v[96:111], v[172:175], v[160:163], v[96:111]
    v_mfma_f32_32x32x16_bf16 v[112:127], v[172:175], v[164:167], v[112:127]
    buffer_load_dwordx4 v[160:163], v2, s[20:23], 0 offen offset:3072
    buffer_load_dwordx4 v[164:167], v3, s[20:23], 0 offen offset:3072
    buffer_load_dwordx4 v[168:171], v4, s[20:23], 0 offen offset:3072
    buffer_load_dwordx4 v[172:175], v5, s[20:23], 0 offen offset:3072
    v_add_u32 v2, 4096, v2
    v_add_u32 v3, 4096, v3
    v_add_u32 v4, 4096, v4
    v_add_u32 v5, 4096, v5
    s_waitcnt vmcnt(16)
    v_mfma_f32_32x32x16_bf16 v[64:79], v[184:187], v[176:179], v[64:79]
    v_mfma_f32_32x32x16_bf16 v[80:95], v[184:187], v[180:183], v[80:95]
    v_mfma_f32_32x32x16_bf16 v[96:111], v[188:191], v[176:179], v[96:111]
    v_mfma_f32_32x32x16_bf16 v[112:127], v[188:191], v[180:183], v[112:127]
    buffer_load_dwordx4 v[176:179], v2, s[20:23], 0 offen offset:0
    buffer_load_dwordx4 v[180:183], v3, s[20:23], 0 offen offset:0
    buffer_load_dwordx4 v[184:187], v4, s[20:23], 0 offen offset:0
    buffer_load_dwordx4 v[188:191], v5, s[20:23], 0 offen offset:0
    s_waitcnt vmcnt(16)
    v_mfma_f32_32x32x16_bf16 v[64:79], v[200:203], v[192:195], v[64:79]
    v_mfma_f32_32x32x16_bf16 v[80:95], v[200:203], v[196:199], v[80:95]
    v_mfma_f32_32x32x16_bf16 v[96:111], v[204:207], v[192:195], v[96:111]
    v_mfma_f32_32x32x16_bf16 v[112:127], v[204:207], v[196:199], v[112:127]
    buffer_load_dwordx4 v[192:195], v2, s[20:23], 0 offen offset:1024
    buffer_load_dwordx4 v[196:199], v3, s[20:23], 0 offen offset:1024
    buffer_load_dwordx4 v[200:203], v4, s[20:23], 0 offen offset:1024
    buffer_load_dwordx4 v[204:207], v5, s[20:23], 0 offen offset:1024
    s_waitcnt vmcnt(16)
    v_mfma_f32_32x32x16_bf16 v[64:79], v[136:139], v[128:131], v[64:79]
    v_mfma_f32_32x32x16_bf16 v[80:95], v[136:139], v[132:135], v[80:95]
    v_mfma_f32_32x32x16_bf16 v[96:111], v[140:143], v[128:131], v[96:111]
    v_mfma_f32_32x32x16_bf16 v[112:127], v[140:143], v[132:135], v[112:127]
    buffer_load_dwordx4 v[128:131], v2, s[20:23], 0 offen offset:2048
    buffer_load_dwordx4 v[132:135], v3, s[20:23], 0 offen offset:2048
    buffer_load_dwordx4 v[136:139], v4, s[20:23], 0 offen offset:2048
    buffer_load_dwordx4 v[140:143], v5, s[20:23], 0 offen offset:2048
    s_waitcnt vmcnt(16)
    v_mfma_f32_32x32x16_bf16 v[64:79], v[152:155], v[144:147], v[64:79]
    v_mfma_f32_32x32x16_bf16 v[80:95], v[152:155], v[148:151], v[80:95]
    v_mfma_f32_32x32x16_bf16 v[96:111], v[156:159], v[144:147], v[96:111]
    v_mfma_f32_32x32x16_bf16 v[112:127], v[156:159], v[148:151], v[112:127]
    buffer_load_dwordx4 v[144:147], v2, s[20:23], 0 offen offset:3072
    buffer_load_dwordx4 v[148:151], v3, s[20:23], 0 offen offset:3072
    buffer_load_dwordx4 v[152:155], v4, s[20:23], 0 offen offset:3072
    buffer_load_dwordx4 v[156:159], v5, s[20:23], 0 offen offset:3072
    v_add_u32 v2, 4096, v2
    v_add_u32 v3, 4096, v3
    v_add_u32 v4, 4096, v4
    v_add_u32 v5, 4096, v5
    s_waitcnt vmcnt(16)
    v_mfma_f32_32x32x16_bf16 v[64:79], v[168:171], v[160:163], v[64:79]
    v_mfma_f32_32x32x16_bf16 v[80:95], v[168:171], v[164:167], v[80:95]
    v_mfma_f32_32x32x16_bf16 v[96:111], v[172:175], v[160:163], v[96:111]
    v_mfma_f32_32x32x16_bf16 v[112:127], v[172:175], v[164:167], v[112:127]
    buffer_load_dwordx4 v[160:163], v2, s[20:23], 0 offen offset:0
    buffer_load_dwordx4 v[164:167], v3, s[20:23], 0 offen offset:0
    buffer_load_dwordx4 v[168:171], v4, s[20:23], 0 offen offset:0
    buffer_load_dwordx4 v[172:175], v5, s[20:23], 0 offen offset:0
    s_waitcnt vmcnt(16)
    v_mfma_f32_32x32x16_bf16 v[64:79], v[184:187], v[176:179], v[64:79]
    v_mfma_f32_32x32x16_bf16 v[80:95], v[184:187], v[180:183], v[80:95]
    v_mfma_f32_32x32x16_bf16 v[96:111], v[188:191], v[176:179], v[96:111]
    v_mfma_f32_32x32x16_bf16 v[112:127], v[188:191], v[180:183], v[112:127]
    buffer_load_dwordx4 v[176:179], v2, s[20:23], 0 offen offset:1024
    buffer_load_dwordx4 v[180:183], v3, s[20:23], 0 offen offset:1024
    buffer_load_dwordx4 v[184:187], v4, s[20:23], 0 offen offset:1024
    buffer_load_dwordx4 v[188:191], v5, s[20:23], 0 offen offset:1024
    s_waitcnt vmcnt(16)
    v_mfma_f32_32x32x16_bf16 v[64:79], v[200:203], v[192:195], v[64:79]
    v_mfma_f32_32x32x16_bf16 v[80:95], v[200:203], v[196:199], v[80:95]
    v_mfma_f32_32x32x16_bf16 v[96:111], v[204:207], v[192:195], v[96:111]
    v_mfma_f32_32x32x16_bf16 v[112:127], v[204:207], v[196:199], v[112:127]
    buffer_load_dwordx4 v[192:195], v2, s[20:23], 0 offen offset:2048
    buffer_load_dwordx4 v[196:199], v3, s[20:23], 0 offen offset:2048
    buffer_load_dwordx4 v[200:203], v4, s[20:23], 0 offen offset:2048
    buffer_load_dwordx4 v[204:207], v5, s[20:23], 0 offen offset:2048
    s_waitcnt vmcnt(16)
    v_mfma_f32_32x32x16_bf16 v[64:79], v[136:139], v[128:131], v[64:79]
    v_mfma_f32_32x32x16_bf16 v[80:95], v[136:139], v[132:135], v[80:95]
    v_mfma_f32_32x32x16_bf16 v[96:111], v[140:143], v[128:131], v[96:111]
    v_mfma_f32_32x32x16_bf16 v[112:127], v[140:143], v[132:135], v[112:127]
    buffer_load_dwordx4 v[128:131], v2, s[20:23], 0 offen offset:3072
    buffer_load_dwordx4 v[132:135], v3, s[20:23], 0 offen offset:3072
    buffer_load_dwordx4 v[136:139], v4, s[20:23], 0 offen offset:3072
    buffer_load_dwordx4 v[140:143], v5, s[20:23], 0 offen offset:3072
    v_add_u32 v2, 4096, v2
    v_add_u32 v3, 4096, v3
    v_add_u32 v4, 4096, v4
    v_add_u32 v5, 4096, v5
    s_waitcnt vmcnt(16)
    v_mfma_f32_32x32x16_bf16 v[64:79], v[152:155], v[144:147], v[64:79]
    v_mfma_f32_32x32x16_bf16 v[80:95], v[152:155], v[148:151], v[80:95]
    v_mfma_f32_32x32x16_bf16 v[96:111], v[156:159], v[144:147], v[96:111]
    v_mfma_f32_32x32x16_bf16 v[112:127], v[156:159], v[148:151], v[112:127]
    buffer_load_dwordx4 v[144:147], v2, s[20:23], 0 offen offset:0
    buffer_load_dwordx4 v[148:151], v3, s[20:23], 0 offen offset:0
    buffer_load_dwordx4 v[152:155], v4, s[20:23], 0 offen offset:0
    buffer_load_dwordx4 v[156:159], v5, s[20:23], 0 offen offset:0
    s_waitcnt vmcnt(16)
    v_mfma_f32_32x32x16_bf16 v[64:79], v[168:171], v[160:163], v[64:79]
    v_mfma_f32_32x32x16_bf16 v[80:95], v[168:171], v[164:167], v[80:95]
    v_mfma_f32_32x32x16_bf16 v[96:111], v[172:175], v[160:163], v[96:111]
    v_mfma_f32_32x32x16_bf16 v[112:127], v[172:175], v[164:167], v[112:127]
    buffer_load_dwordx4 v[160:163], v2, s[20:23], 0 offen offset:1024
    buffer_load_dwordx4 v[164:167], v3, s[20:23], 0 offen offset:1024
    buffer_load_dwordx4 v[168:171], v4, s[20:23], 0 offen offset:1024
    buffer_load_dwordx4 v[172:175], v5, s[20:23], 0 offen offset:1024
    s_waitcnt vmcnt(16)
    v_mfma_f32_32x32x16_bf16 v[64:79], v[184:187], v[176:179], v[64:79]
    v_mfma_f32_32x32x16_bf16 v[80:95], v[184:187], v[180:183], v[80:95]
    v_mfma_f32_32x32x16_bf16 v[96:111], v[188:191], v[176:179], v[96:111]
    v_mfma_f32_32x32x16_bf16 v[112:127], v[188:191], v[180:183], v[112:127]
    buffer_load_dwordx4 v[176:179], v2, s[20:23], 0 offen offset:2048
    buffer_load_dwordx4 v[180:183], v3, s[20:23], 0 offen offset:2048
    buffer_load_dwordx4 v[184:187], v4, s[20:23], 0 offen offset:2048
    buffer_load_dwordx4 v[188:191], v5, s[20:23], 0 offen offset:2048
    s_waitcnt vmcnt(16)
    v_mfma_f32_32x32x16_bf16 v[64:79], v[200:203], v[192:195], v[64:79]
    v_mfma_f32_32x32x16_bf16 v[80:95], v[200:203], v[196:199], v[80:95]
    v_mfma_f32_32x32x16_bf16 v[96:111], v[204:207], v[192:195], v[96:111]
    v_mfma_f32_32x32x16_bf16 v[112:127], v[204:207], v[196:199], v[112:127]
    buffer_load_dwordx4 v[192:195], v2, s[20:23], 0 offen offset:3072
    buffer_load_dwordx4 v[196:199], v3, s[20:23], 0 offen offset:3072
    buffer_load_dwordx4 v[200:203], v4, s[20:23], 0 offen offset:3072
    buffer_load_dwordx4 v[204:207], v5, s[20:23], 0 offen offset:3072
    v_add_u32 v2, 4096, v2
    v_add_u32 v3, 4096, v3
    v_add_u32 v4, 4096, v4
    v_add_u32 v5, 4096, v5
    s_waitcnt vmcnt(16)
    v_mfma_f32_32x32x16_bf16 v[64:79], v[136:139], v[128:131], v[64:79]
    v_mfma_f32_32x32x16_bf16 v[80:95], v[136:139], v[132:135], v[80:95]
    v_mfma_f32_32x32x16_bf16 v[96:111], v[140:143], v[128:131], v[96:111]
    v_mfma_f32_32x32x16_bf16 v[112:127], v[140:143], v[132:135], v[112:127]
    buffer_load_dwordx4 v[128:131], v2, s[20:23], 0 offen offset:0
    buffer_load_dwordx4 v[132:135], v3, s[20:23], 0 offen offset:0
    buffer_load_dwordx4 v[136:139], v4, s[20:23], 0 offen offset:0
    buffer_load_dwordx4 v[140:143], v5, s[20:23], 0 offen offset:0
    s_waitcnt vmcnt(16)
    v_mfma_f32_32x32x16_bf16 v[64:79], v[152:155], v[144:147], v[64:79]
    v_mfma_f32_32x32x16_bf16 v[80:95], v[152:155], v[148:151], v[80:95]
    v_mfma_f32_32x32x16_bf16 v[96:111], v[156:159], v[144:147], v[96:111]
    v_mfma_f32_32x32x16_bf16 v[112:127], v[156:159], v[148:151], v[112:127]
    buffer_load_dwordx4 v[144:147], v2, s[20:23], 0 offen offset:1024
    buffer_load_dwordx4 v[148:151], v3, s[20:23], 0 offen offset:1024
    buffer_load_dwordx4 v[152:155], v4, s[20:23], 0 offen offset:1024
    buffer_load_dwordx4 v[156:159], v5, s[20:23], 0 offen offset:1024
    s_waitcnt vmcnt(16)
    v_mfma_f32_32x32x16_bf16 v[64:79], v[168:171], v[160:163], v[64:79]
    v_mfma_f32_32x32x16_bf16 v[80:95], v[168:171], v[164:167], v[80:95]
    v_mfma_f32_32x32x16_bf16 v[96:111], v[172:175], v[160:163], v[96:111]
    v_mfma_f32_32x32x16_bf16 v[112:127], v[172:175], v[164:167], v[112:127]
    s_waitcnt vmcnt(12)
    v_mfma_f32_32x32x16_bf16 v[64:79], v[184:187], v[176:179], v[64:79]
    v_mfma_f32_32x32x16_bf16 v[80:95], v[184:187], v[180:183], v[80:95]
    v_mfma_f32_32x32x16_bf16 v[96:111], v[188:191], v[176:179], v[96:111]
    v_mfma_f32_32x32x16_bf16 v[112:127], v[188:191], v[180:183], v[112:127]
    s_waitcnt vmcnt(8)
    v_mfma_f32_32x32x16_bf16 v[64:79], v[200:203], v[192:195], v[64:79]
    v_mfma_f32_32x32x16_bf16 v[80:95], v[200:203], v[196:199], v[80:95]
    v_mfma_f32_32x32x16_bf16 v[96:111], v[204:207], v[192:195], v[96:111]
    v_mfma_f32_32x32x16_bf16 v[112:127], v[204:207], v[196:199], v[112:127]
    s_waitcnt vmcnt(4)
    v_mfma_f32_32x32x16_bf16 v[64:79], v[136:139], v[128:131], v[64:79]
    v_mfma_f32_32x32x16_bf16 v[80:95], v[136:139], v[132:135], v[80:95]
    v_mfma_f32_32x32x16_bf16 v[96:111], v[140:143], v[128:131], v[96:111]
    v_mfma_f32_32x32x16_bf16 v[112:127], v[140:143], v[132:135], v[112:127]
    s_cmp_eq_u32 s29, 21
    s_cbranch_scc1 L_ffn2b_kernel_skip
    s_waitcnt vmcnt(0)
    v_mfma_f32_32x32x16_bf16 v[64:79], v[152:155], v[144:147], v[64:79]
    v_mfma_f32_32x32x16_bf16 v[80:95], v[152:155], v[148:151], v[80:95]
    v_mfma_f32_32x32x16_bf16 v[96:111], v[156:159], v[144:147], v[96:111]
    v_mfma_f32_32x32x16_bf16 v[112:127], v[156:159], v[148:151], v[112:127]
L_ffn2b_kernel_skip:
    s_nop 15
    s_lshl_b32 s30, s27, 14
    v_lshl_add_u32 v6, v1, 2, s30
    ds_write_b32 v6, v64 offset:0
    ds_write_b32 v6, v65 offset:256
    ds_write_b32 v6, v66 offset:512
    ds_write_b32 v6, v67 offset:768
    ds_write_b32 v6, v68 offset:1024
    ds_write_b32 v6, v69 offset:1280
    ds_write_b32 v6, v70 offset:1536
    ds_write_b32 v6, v71 offset:1792
    ds_write_b32 v6, v72 offset:2048
    ds_write_b32 v6, v73 offset:2304
    ds_write_b32 v6, v74 offset:2560
    ds_write_b32 v6, v75 offset:2816
    ds_write_b32 v6, v76 offset:3072
    ds_write_b32 v6, v77 offset:3328
    ds_write_b32 v6, v78 offset:3584
    ds_write_b32 v6, v79 offset:3840
    ds_write_b32 v6, v80 offset:4096
    ds_write_b32 v6, v81 offset:4352
    ds_write_b32 v6, v82 offset:4608
    ds_write_b32 v6, v83 offset:4864
    ds_write_b32 v6, v84 offset:5120
    ds_write_b32 v6, v85 offset:5376
    ds_write_b32 v6, v86 offset:5632
    ds_write_b32 v6, v87 offset:5888
    ds_write_b32 v6, v88 offset:6144
    ds_write_b32 v6, v89 offset:6400
    ds_write_b32 v6, v90 offset:6656
    ds_write_b32 v6, v91 offset:6912
    ds_write_b32 v6, v92 offset:7168
    ds_write_b32 v6, v93 offset:7424
    ds_write_b32 v6, v94 offset:7680
    ds_write_b32 v6, v95 offset:7936
    ds_write_b32 v6, v96 offset:8192
    ds_write_b32 v6, v97 offset:8448
    ds_write_b32 v6, v98 offset:8704
    ds_write_b32 v6, v99 offset:8960
    ds_write_b32 v6, v100 offset:9216
    ds_write_b32 v6, v101 offset:9472
    ds_write_b32 v6, v102 offset:9728
    ds_write_b32 v6, v103 offset:9984
    ds_write_b32 v6, v104 offset:10240
    ds_write_b32 v6, v105 offset:10496
    ds_write_b32 v6, v106 offset:10752
    ds_write_b32 v6, v107 offset:11008
    ds_write_b32 v6, v108 offset:11264
    ds_write_b32 v6, v109 offset:11520
    ds_write_b32 v6, v110 offset:11776
    ds_write_b32 v6, v111 offset:12032
    ds_write_b32 v6, v112 offset:12288
    ds_write_b32 v6, v113 offset:12544
    ds_write_b32 v6, v114 offset:12800
    ds_write_b32 v6, v115 offset:13056
    ds_write_b32 v6, v116 offset:13312
    ds_write_b32 v6, v117 offset:13568
    ds_write_b32 v6, v118 offset:13824
    ds_write_b32 v6, v119 offset:14080
    ds_write_b32 v6, v120 offset:14336
    ds_write_b32 v6, v121 offset:14592
    ds_write_b32 v6, v122 offset:14848
    ds_write_b32 v6, v123 offset:15104
    ds_write_b32 v6, v124 offset:15360
    ds_write_b32 v6, v125 offset:15616
    ds_write_b32 v6, v126 offset:15872
    ds_write_b32 v6, v127 offset:16128
    s_waitcnt lgkmcnt(0)
    s_barrier
    s_lshl_b32 s30, s27, 12
    v_lshl_add_u32 v6, v1, 2, s30
    ds_read_b32 v64, v6 offset:0
    ds_read_b32 v65, v6 offset:256
    ds_read_b32 v66, v6 offset:512
    ds_read_b32 v67, v6 offset:768
    ds_read_b32 v68, v6 offset:1024
    ds_read_b32 v69, v6 offset:1280
    ds_read_b32 v70, v6 offset:1536
    ds_read_b32 v71, v6 offset:1792
    ds_read_b32 v72, v6 offset:2048
    ds_read_b32 v73, v6 offset:2304
    ds_read_b32 v74, v6 offset:2560
    ds_read_b32 v75, v6 offset:2816
    ds_read_b32 v76, v6 offset:3072
    ds_read_b32 v77, v6 offset:3328
    ds_read_b32 v78, v6 offset:3584
    ds_read_b32 v79, v6 offset:3840
    ds_read_b32 v80, v6 offset:16384
    ds_read_b32 v81, v6 offset:16640
    ds_read_b32 v82, v6 offset:16896
    ds_read_b32 v83, v6 offset:17152
    ds_read_b32 v84, v6 offset:17408
    ds_read_b32 v85, v6 offset:17664
    ds_read_b32 v86, v6 offset:17920
    ds_read_b32 v87, v6 offset:18176
    ds_read_b32 v88, v6 offset:18432
    ds_read_b32 v89, v6 offset:18688
    ds_read_b32 v90, v6 offset:18944
    ds_read_b32 v91, v6 offset:19200
    ds_read_b32 v92, v6 offset:19456
    ds_read_b32 v93, v6 offset:19712
    ds_read_b32 v94, v6 offset:19968
    ds_read_b32 v95, v6 offset:20224
    ds_read_b32 v96, v6 offset:32768
    ds_read_b32 v97, v6 offset:33024
    ds_read_b32 v98, v6 offset:33280
    ds_read_b32 v99, v6 offset:33536
    ds_read_b32 v100, v6 offset:33792
    ds_read_b32 v101, v6 offset:34048
    ds_read_b32 v102, v6 offset:34304
    ds_read_b32 v103, v6 offset:34560
    ds_read_b32 v104, v6 offset:34816
    ds_read_b32 v105, v6 offset:35072
    ds_read_b32 v106, v6 offset:35328
    ds_read_b32 v107, v6 offset:35584
    ds_read_b32 v108, v6 offset:35840
    ds_read_b32 v109, v6 offset:36096
    ds_read_b32 v110, v6 offset:36352
    ds_read_b32 v111, v6 offset:36608
    ds_read_b32 v112, v6 offset:49152
    ds_read_b32 v113, v6 offset:49408
    ds_read_b32 v114, v6 offset:49664
    ds_read_b32 v115, v6 offset:49920
    ds_read_b32 v116, v6 offset:50176
    ds_read_b32 v117, v6 offset:50432
    ds_read_b32 v118, v6 offset:50688
    ds_read_b32 v119, v6 offset:50944
    ds_read_b32 v120, v6 offset:51200
    ds_read_b32 v121, v6 offset:51456
    ds_read_b32 v122, v6 offset:51712
    ds_read_b32 v123, v6 offset:51968
    ds_read_b32 v124, v6 offset:52224
    ds_read_b32 v125, v6 offset:52480
    ds_read_b32 v126, v6 offset:52736
    ds_read_b32 v127, v6 offset:52992
    s_and_b32 s30, s27, 1
    s_lshl_b32 s30, s30, 5
    s_lshl_b32 s31, s25, 6
    s_add_u32 s30, s30, s31
    v_and_b32 v7, 31, v1
    v_add_u32 v7, s30, v7
    v_lshlrev_b32 v7, 10, v7
    s_lshr_b32 s30, s27, 1
    s_lshl_b32 s30, s30, 5
    s_lshl_b32 s31, s26, 6
    s_add_u32 s30, s30, s31
    v_lshrrev_b32 v8, 5, v1
    v_lshl_add_u32 v8, v8, 2, s30
    v_lshl_add_u32 v7, v8, 1, v7
    v_add_u32 v9, 8388608, v7
    v_add_u32 v10, 0, v7
    buffer_load_dwordx2 v[16:17], v9, s[20:23], 0 offen offset:0
    buffer_load_dwordx2 v[18:19], v9, s[20:23], 0 offen offset:16
    buffer_load_dwordx2 v[20:21], v9, s[20:23], 0 offen offset:32
    buffer_load_dwordx2 v[22:23], v9, s[20:23], 0 offen offset:48
    s_waitcnt vmcnt(0) lgkmcnt(0)
    v_add_f32 v64, v64, v80
    v_add_f32 v96, v96, v112
    v_add_f32 v64, v64, v96
    v_cvt_pk_bf16_f32 v30, v64, v64
    v_lshlrev_b32 v64, 16, v30
    v_lshlrev_b32 v31, 16, v16
    v_add_f32 v64, v64, v31
    v_add_f32 v65, v65, v81
    v_add_f32 v97, v97, v113
    v_add_f32 v65, v65, v97
    v_cvt_pk_bf16_f32 v30, v65, v65
    v_lshlrev_b32 v65, 16, v30
    v_and_b32 v31, 0xffff0000, v16
    v_add_f32 v65, v65, v31
    v_add_f32 v66, v66, v82
    v_add_f32 v98, v98, v114
    v_add_f32 v66, v66, v98
    v_cvt_pk_bf16_f32 v30, v66, v66
    v_lshlrev_b32 v66, 16, v30
    v_lshlrev_b32 v31, 16, v17
    v_add_f32 v66, v66, v31
    v_add_f32 v67, v67, v83
    v_add_f32 v99, v99, v115
    v_add_f32 v67, v67, v99
    v_cvt_pk_bf16_f32 v30, v67, v67
    v_lshlrev_b32 v67, 16, v30
    v_and_b32 v31, 0xffff0000, v17
    v_add_f32 v67, v67, v31
    v_cvt_pk_bf16_f32 v32, v64, v65
    v_cvt_pk_bf16_f32 v33, v66, v67
    buffer_store_dwordx2 v[32:33], v10, s[12:15], 0 offen offset:0
    v_add_f32 v68, v68, v84
    v_add_f32 v100, v100, v116
    v_add_f32 v68, v68, v100
    v_cvt_pk_bf16_f32 v30, v68, v68
    v_lshlrev_b32 v68, 16, v30
    v_lshlrev_b32 v31, 16, v18
    v_add_f32 v68, v68, v31
    v_add_f32 v69, v69, v85
    v_add_f32 v101, v101, v117
    v_add_f32 v69, v69, v101
    v_cvt_pk_bf16_f32 v30, v69, v69
    v_lshlrev_b32 v69, 16, v30
    v_and_b32 v31, 0xffff0000, v18
    v_add_f32 v69, v69, v31
    v_add_f32 v70, v70, v86
    v_add_f32 v102, v102, v118
    v_add_f32 v70, v70, v102
    v_cvt_pk_bf16_f32 v30, v70, v70
    v_lshlrev_b32 v70, 16, v30
    v_lshlrev_b32 v31, 16, v19
    v_add_f32 v70, v70, v31
    v_add_f32 v71, v71, v87
    v_add_f32 v103, v103, v119
    v_add_f32 v71, v71, v103
    v_cvt_pk_bf16_f32 v30, v71, v71
    v_lshlrev_b32 v71, 16, v30
    v_and_b32 v31, 0xffff0000, v19
    v_add_f32 v71, v71, v31
    v_cvt_pk_bf16_f32 v34, v68, v69
    v_cvt_pk_bf16_f32 v35, v70, v71
    buffer_store_dwordx2 v[34:35], v10, s[12:15], 0 offen offset:16
    v_add_f32 v72, v72, v88
    v_add_f32 v104, v104, v120
    v_add_f32 v72, v72, v104
    v_cvt_pk_bf16_f32 v30, v72, v72
    v_lshlrev_b32 v72, 16, v30
    v_lshlrev_b32 v31, 16, v20
    v_add_f32 v72, v72, v31
    v_add_f32 v73, v73, v89
    v_add_f32 v105, v105, v121
    v_add_f32 v73, v73, v105
    v_cvt_pk_bf16_f32 v30, v73, v73
    v_lshlrev_b32 v73, 16, v30
    v_and_b32 v31, 0xffff0000, v20
    v_add_f32 v73, v73, v31
    v_add_f32 v74, v74, v90
    v_add_f32 v106, v106, v122
    v_add_f32 v74, v74, v106
    v_cvt_pk_bf16_f32 v30, v74, v74
    v_lshlrev_b32 v74, 16, v30
    v_lshlrev_b32 v31, 16, v21
    v_add_f32 v74, v74, v31
    v_add_f32 v75, v75, v91
    v_add_f32 v107, v107, v123
    v_add_f32 v75, v75, v107
    v_cvt_pk_bf16_f32 v30, v75, v75
    v_lshlrev_b32 v75, 16, v30
    v_and_b32 v31, 0xffff0000, v21
    v_add_f32 v75, v75, v31
    v_cvt_pk_bf16_f32 v36, v72, v73
    v_cvt_pk_bf16_f32 v37, v74, v75
    buffer_store_dwordx2 v[36:37], v10, s[12:15], 0 offen offset:32
    v_add_f32 v76, v76, v92
    v_add_f32 v108, v108, v124
    v_add_f32 v76, v76, v108
    v_cvt_pk_bf16_f32 v30, v76, v76
    v_lshlrev_b32 v76, 16, v30
    v_lshlrev_b32 v31, 16, v22
    v_add_f32 v76, v76, v31
    v_add_f32 v77, v77, v93
    v_add_f32 v109, v109, v125
    v_add_f32 v77, v77, v109
    v_cvt_pk_bf16_f32 v30, v77, v77
    v_lshlrev_b32 v77, 16, v30
    v_and_b32 v31, 0xffff0000, v22
    v_add_f32 v77, v77, v31
    v_add_f32 v78, v78, v94
    v_add_f32 v110, v110, v126
    v_add_f32 v78, v78, v110
    v_cvt_pk_bf16_f32 v30, v78, v78
    v_lshlrev_b32 v78, 16, v30
    v_lshlrev_b32 v31, 16, v23
    v_add_f32 v78, v78, v31
    v_add_f32 v79, v79, v95
    v_add_f32 v111, v111, v127
    v_add_f32 v79, v79, v111
    v_cvt_pk_bf16_f32 v30, v79, v79
    v_lshlrev_b32 v79, 16, v30
    v_and_b32 v31, 0xffff0000, v23
    v_add_f32 v79, v79, v31
    v_cvt_pk_bf16_f32 v38, v76, v77
    v_cvt_pk_bf16_f32 v39, v78, v79
    buffer_store_dwordx2 v[38:39], v10, s[12:15], 0 offen offset:48
    s_waitcnt vmcnt(0)
L_ffn2b_kernel_done:
    s_endpgm
.section .rodata,"a"
.p2align 6
.amdhsa_kernel prep_kernel
  .amdhsa_next_free_vgpr 128
  .amdhsa_next_free_sgpr 102
  .amdhsa_accum_offset 128
  .amdhsa_group_segment_fixed_size 0
  .amdhsa_kernarg_size 104
  .amdhsa_user_sgpr_count 2
  .amdhsa_user_sgpr_kernarg_segment_ptr 1
  .amdhsa_system_sgpr_workgroup_id_x 1
  .amdhsa_float_denorm_mode_32 3
.end_amdhsa_kernel
.p2align 6
.amdhsa_kernel conv_kernel
  .amdhsa_next_free_vgpr 128
  .amdhsa_next_free_sgpr 102
  .amdhsa_accum_offset 128
  .amdhsa_group_segment_fixed_size 0
  .amdhsa_kernarg_size 104
  .amdhsa_user_sgpr_count 2
  .amdhsa_user_sgpr_kernarg_segment_ptr 1
  .amdhsa_system_sgpr_workgroup_id_x 1
  .amdhsa_float_denorm_mode_32 3
.end_amdhsa_kernel
.p2align 6
.amdhsa_kernel ln1_kernel
  .amdhsa_next_free_vgpr 160
  .amdhsa_next_free_sgpr 102
  .amdhsa_accum_offset 160
  .amdhsa_group_segment_fixed_size 0
  .amdhsa_kernarg_size 104
  .amdhsa_user_sgpr_count 2
  .amdhsa_user_sgpr_kernarg_segment_ptr 1
  .amdhsa_system_sgpr_workgroup_id_x 1
  .amdhsa_float_denorm_mode_32 3
.end_amdhsa_kernel
.p2align 6
.amdhsa_kernel ln2_kernel
  .amdhsa_next_free_vgpr 160
  .amdhsa_next_free_sgpr 102
  .amdhsa_accum_offset 160
  .amdhsa_group_segment_fixed_size 0
  .amdhsa_kernarg_size 104
  .amdhsa_user_sgpr_count 2
  .amdhsa_user_sgpr_kernarg_segment_ptr 1
  .amdhsa_system_sgpr_workgroup_id_x 1
  .amdhsa_float_denorm_mode_32 3
.end_amdhsa_kernel
.p2align 6
.amdhsa_kernel ffn1a_kernel
  .amdhsa_next_free_vgpr 256
  .amdhsa_next_free_sgpr 102
  .amdhsa_accum_offset 256
  .amdhsa_group_segment_fixed_size 0
  .amdhsa_kernarg_size 104
  .amdhsa_user_sgpr_count 2
  .amdhsa_user_sgpr_kernarg_segment_ptr 1
  .amdhsa_system_sgpr_workgroup_id_x 1
  .amdhsa_float_denorm_mode_32 3
.end_amdhsa_kernel
.p2align 6
.amdhsa_kernel ffn2a_kernel
  .amdhsa_next_free_vgpr 208
  .amdhsa_next_free_sgpr 102
  .amdhsa_accum_offset 208
  .amdhsa_group_segment_fixed_size 0
  .amdhsa_kernarg_size 104
  .amdhsa_user_sgpr_count 2
  .amdhsa_user_sgpr_kernarg_segment_ptr 1
  .amdhsa_system_sgpr_workgroup_id_x 1
  .amdhsa_float_denorm_mode_32 3
.end_amdhsa_kernel
.p2align 6
.amdhsa_kernel ffn1b_kernel
  .amdhsa_next_free_vgpr 256
  .amdhsa_next_free_sgpr 102
  .amdhsa_accum_offset 256
  .amdhsa_group_segment_fixed_size 0
  .amdhsa_kernarg_size 104
  .amdhsa_user_sgpr_count 2
  .amdhsa_user_sgpr_kernarg_segment_ptr 1
  .amdhsa_system_sgpr_workgroup_id_x 1
  .amdhsa_float_denorm_mode_32 3
.end_amdhsa_kernel
.p2align 6
.amdhsa_kernel ffn2b_kernel
  .amdhsa_next_free_vgpr 208
  .amdhsa_next_free_sgpr 102
  .amdhsa_accum_offset 208
  .amdhsa_group_segment_fixed_size 0
  .amdhsa_kernarg_size 104
  .amdhsa_user_sgpr_count 2
  .amdhsa_user_sgpr_kernarg_segment_ptr 1
  .amdhsa_system_sgpr_workgroup_id_x 1
  .amdhsa_float_denorm_mode_32 3
.end_amdhsa_kernel
```
